```python
import torch

def _softmax(x, axis=-1):
    return torch.softmax(x, dim=axis)
def _gelu(x):
    return torch.nn.functional.gelu(x, approximate="tanh")
def _silu(x):
    return torch.nn.functional.silu(x)
def _sigmoid(x):
    return torch.sigmoid(x)
def _layernorm(x, axis=-1, eps=1e-5):
    m = x.mean(dim=axis, keepdim=True)
    v = x.var(dim=axis, keepdim=True, unbiased=False)
    return (x - m) / torch.sqrt(v + eps)
def _scatter_add(tgt, idx, src, axis=0):
    return tgt.clone().index_add_(axis, idx, src)
def _segment_sum(src, seg, n):
    out = torch.zeros((n,) + src.shape[1:], dtype=src.dtype)
    return out.index_add_(0, seg, src)
def _pad(x, pw):
    flat = tuple(v for pair in reversed(pw) for v in pair)
    return torch.nn.functional.pad(x, flat)

kernel_name = 'parallel_sum__linear_kernel_hedgehog__glu_gated_glu__prompt'

def setup_inputs():

    _w = (lambda a: (lambda t: t.to(torch.bfloat16) if t.is_floating_point() else t)(torch.as_tensor(a)))
    def _A_setup():
        B, S, D, H = 1, 2048, 512, 32
        Dh = D // H
        return {
            "x": _w((lambda *s: torch.randn(*s, dtype=torch.bfloat16) * 0.05)(B, S, D)),
            "wqkv": _w((lambda *s: torch.randn(*s, dtype=torch.bfloat16) * 0.4)(D, 3 * D)),
            "w_phi": _w((lambda *s: torch.randn(*s, dtype=torch.bfloat16) * 0.4)(H, Dh, Dh) * (Dh ** -0.5)),
            "wo": _w((lambda *s: torch.randn(*s, dtype=torch.bfloat16) * 0.1)(D, D)),
        }
    _A_in = _A_setup()

    def _B_setup():
        B, S, D, F = 1, 2048, 512, 1376
        return {
            "x": _w((lambda *s: torch.randn(*s, dtype=torch.bfloat16) * 0.05)(B, S, D)),
            "w_gate": _w((lambda *s: torch.randn(*s, dtype=torch.bfloat16) * 0.05)(D, F)),
            "w_up": _w((lambda *s: torch.randn(*s, dtype=torch.bfloat16) * 0.05)(D, F)),
            "w_down": _w((lambda *s: torch.randn(*s, dtype=torch.bfloat16) * 0.05)(F, D)),
        }
    _B_in = _B_setup()

    return {
        "A_x": _A_in["x"],
        "A_wqkv": _A_in["wqkv"],
        "A_w_phi": _A_in["w_phi"],
        "A_wo": _A_in["wo"],
        "B_x": _B_in["x"],
        "B_w_gate": _B_in["w_gate"],
        "B_w_up": _B_in["w_up"],
        "B_w_down": _B_in["w_down"],
    }

def reference(A_x, A_wqkv, A_w_phi, A_wo, B_x, B_w_gate, B_w_up, B_w_down):
    def _A_ref(x, wqkv, w_phi, wo):
        B, S, D = x.shape
        H = 32; Dh = D // H
        qkv = (lambda x, *d: x.permute(*d))((x @ wqkv).reshape(B, S, 3, H, Dh), 2, 0, 3, 1, 4)
        q, k, v = qkv[0], qkv[1], qkv[2]
        pq = torch.einsum("bhsd,hdf->bhsf", q, w_phi)
        pk = torch.einsum("bhsd,hdf->bhsf", k, w_phi)
        phi_q = torch.concatenate([_softmax(pq, axis=-1), _softmax(-pq, axis=-1)], axis=-1)
        phi_k = torch.concatenate([_softmax(pk, axis=-1), _softmax(-pk, axis=-1)], axis=-1)
        kv = torch.einsum("bhsf,bhsd->bhfd", phi_k, v)
        z  = torch.einsum("bhsf->bhf", phi_k)
        num = torch.einsum("bhqf,bhfd->bhqd", phi_q, kv)
        den = torch.einsum("bhqf,bhf->bhq", phi_q, z)[..., None] + 1e-6
        o = num / den
        return (lambda x, *d: x.permute(*d))(o, 0, 2, 1, 3).reshape(B, S, D) @ wo

    def _B_ref(x, w_gate, w_up, w_down):
        g = torch.einsum("bsd,df->bsf", x, w_gate)
        u = torch.einsum("bsd,df->bsf", x, w_up)
        h = _sigmoid(g) * u
        return torch.einsum("bsf,fd->bsd", h, w_down)

    x = A_x
    xn = _layernorm(x, axis=-1)
    return x + _A_ref(xn, A_wqkv, A_w_phi, A_wo) + _B_ref(xn, B_w_gate, B_w_up, B_w_down)
```

```asm
; @launch grid=(256,1,1) block=(512,1,1) lds=163840
.amdgcn_target "amdgcn-amd-amdhsa--gfx950"
.text
.globl parallel_sum__linear_kernel_hedgehog__glu_gated_glu__prompt_kernel
.p2align 8
.type parallel_sum__linear_kernel_hedgehog__glu_gated_glu__prompt_kernel,@function
parallel_sum__linear_kernel_hedgehog__glu_gated_glu__prompt_kernel:
    s_cmp_ge_u32 s2, 256
    s_cbranch_scc1 L_parallel_sum__linear_kernel_hedgehog__glu_gated_glu__prompt_kernel_end
    s_load_dwordx4 s[8:11], s[0:1], 0
    s_getpc_b64 s[4:5]
L_parallel_sum__linear_kernel_hedgehog__glu_gated_glu__prompt_kernel_pc:
    s_lshr_b32 s3, s2, 3
    s_lshl_b32 s3, s3, 11
    v_lshrrev_b32 v1, 5, v0
    v_lshl_add_u32 v1, v1, 7, s3
    s_mov_b32 s6, L_parallel_sum__linear_kernel_hedgehog__glu_gated_glu__prompt_kernel_end-L_parallel_sum__linear_kernel_hedgehog__glu_gated_glu__prompt_kernel_pc
    s_mov_b32 s7, 0x20000
    buffer_load_dword v127, v1, s[4:7], 0 offen
    v_lshrrev_b32 v1, 6, v0
    v_and_b32 v82, 63, v0
    v_readfirstlane_b32 s32, v1
    s_and_b32 s56, s2, 1
    s_bfe_u32 s57, s2, 0x30003
    s_lshl3_add_u32 s33, s56, s57
    s_lshr_b32 s58, s2, 6
    s_and_b32 s56, s2, 6
    s_and_b32 s57, s58, 1
    s_add_u32 s34, s56, s57
    s_lshl1_add_u32 s36, s58, s33
    s_and_b32 s56, s2, 7
    s_bfe_u32 s57, s2, 0x10006
    s_lshl1_add_u32 s33, s56, s57
    s_bfe_u32 s34, s2, 0x30003
    s_add_u32 s36, s56, s34
    v_lshrrev_b32 v2, 4, v82
    v_lshrrev_b32 v3, 3, v82
    v_and_b32 v4, 7, v82
    s_and_b32 s56, s32, 1
    s_lshr_b32 s57, s32, 1
    s_lshl2_add_u32 s57, s57, s56
    s_lshl_b32 s38, s57, 10
    s_lshl4_add_u32 s57, s33, s57
    s_lshl_b32 s57, s57, 13
    s_lshl_b32 s56, s56, 2
    v_or_b32 v5, s56, v2
    v_xor_b32 v5, v5, v4
    v_lshlrev_b32 v5, 4, v5
    v_lshl_add_u32 v5, v3, 10, v5
    v_add_u32 v80, s57, v5
    s_lshl_b32 s39, s32, 10
    s_mul_i32 s56, s32, 24576
    s_lshl_b32 s57, s34, 7
    s_add_u32 s56, s56, s57
    s_and_b32 s41, s36, 7
    s_lshl_b32 s42, s41, 7
    s_mul_i32 s43, s41, 196608
    s_cmp_lt_u32 s2, 128
    s_cselect_b32 s57, 1024, 0
    s_cselect_b32 s59, 0, 28672
    s_cselect_b32 s58, 0, 53248
    s_add_u32 s59, s59, 20608
    s_add_u32 s58, s58, 12416
    s_add_u32 s56, s56, s57
    v_and_b32 v5, 1, v2
    v_lshlrev_b32 v5, 2, v5
    v_xor_b32 v5, v5, v4
    v_lshlrev_b32 v5, 4, v5
    v_mul_u32_u24 v6, 3072, v3
    v_add3_u32 v81, v5, v6, s56
    s_add_u32 m0, s38, s59
    s_add_u32 s57, s42, 14336
    s_mov_b32 s14, 1572864
    s_mov_b32 s15, 0x20000
    s_waitcnt lgkmcnt(0)
    s_mov_b32 s12, s10
    s_mov_b32 s13, s11
    s_mov_b32 s10, 2097152
    s_mov_b32 s11, 0x20000
    buffer_load_dwordx4 v80, s[8:11], s42 offen lds
    buffer_load_dwordx4 v80, s[8:11], s57 offen offset:2048 lds
    s_add_u32 m0, s39, s58
    s_nop 0
    buffer_load_dwordx4 v81, s[12:15], s43 offen lds
    s_load_dwordx2 s[28:29], s[0:1], 16
    s_load_dwordx2 s[16:17], s[0:1], 40
    s_load_dwordx2 s[20:21], s[0:1], 48
    s_load_dwordx2 s[24:25], s[0:1], 80
    s_load_dwordx2 s[4:5], s[0:1], 72
    s_load_dwordx2 s[44:45], s[0:1], 24
    s_load_dwordx2 s[48:49], s[0:1], 56
    s_load_dwordx2 s[46:47], s[0:1], 64
    s_and_b32 s37, s32, 3
    s_lshr_b32 s56, s32, 2
    s_lshr_b32 s57, s2, 7
    s_lshl1_add_u32 s56, s57, s56
    s_cmp_eq_u32 s56, 1
    s_cbranch_scc1 L_parallel_sum__linear_kernel_hedgehog__glu_gated_glu__prompt_kernel_r1
    s_cmp_eq_u32 s56, 2
    s_cbranch_scc1 L_parallel_sum__linear_kernel_hedgehog__glu_gated_glu__prompt_kernel_r2
    s_cmp_eq_u32 s56, 3
    s_cbranch_scc1 L_parallel_sum__linear_kernel_hedgehog__glu_gated_glu__prompt_kernel_r3
    s_mov_b32 s30, 16384
    s_mov_b32 s31, 0x20000
    s_mov_b32 s18, 1409024
    s_mov_b32 s19, 0x20000
    s_mov_b32 s26, 16777216
    s_mov_b32 s27, 0x20000
    s_mov_b32 s6, 256
    s_mov_b32 s7, 0x20000
    s_mov_b32 s50, 1409024
    s_mov_b32 s51, 0x20000
    s_mov_b32 s55, 0xffff0000
    s_getreg_b32 s100, hwreg(HW_REG_XCC_ID, 0, 4)
    s_mul_i32 s101, s100, s100
    s_lshl_b32 s101, s101, 9
    s_add_u32 s100, s100, s101
    s_lshl_b32 s100, s100, 8
    s_add_u32 s100, s100, 1
    s_lshl_b32 s3, s37, 2
    v_mov_b32 v121, v2
    v_lshrrev_b32 v116, 5, v82
    v_and_b32 v117, 1, v2
    v_bfe_u32 v118, v82, 2, 2
    v_bfe_u32 v112, v82, 1, 1
    v_and_b32 v113, 1, v82
    v_lshl_or_b32 v119, v113, 1, v112
    v_lshlrev_b32 v119, 3, v119
    v_lshl_add_u32 v120, v116, 3, v118
    v_lshl_or_b32 v114, v117, 1, v112
    v_lshlrev_b32 v114, 3, v114
    v_lshl_add_u32 v114, v120, 5, v114
    v_lshl_add_u32 v114, v113, 11, v114
    v_add_u32 v27, 152192, v114
    v_bfe_u32 v114, v82, 2, 3
    v_lshl_add_u32 v114, v116, 4, v114
    v_mul_u32_u24 v114, 96, v114
    v_lshl_add_u32 v114, v113, 3, v114
    s_lshr_b32 s56, s37, 1
    s_mul_i32 s56, s56, 12288
    s_add_u32 s56, s56, 103040
    s_and_b32 s57, s37, 1
    s_lshl_b32 s57, s57, 5
    s_add_u32 s57, s57, s56
    v_xor_b32 v115, v112, v117
    v_lshlrev_b32 v115, 4, v115
    v_add3_u32 v29, v114, v115, s57
    v_and_b32 v113, 2, v118
    v_or_b32 v113, v113, v117
    v_lshl_add_u32 v113, v113, 5, v119
    v_lshl_add_u32 v113, v120, 7, v113
    s_lshl_b32 s56, s37, 11
    v_xor_b32 v104, s56, v113
    v_and_b32 v112, 31, v82
    v_bfe_u32 v113, v82, 1, 3
    v_xor_b32 v113, v113, v116
    v_lshlrev_b32 v113, 4, v113
    v_lshl_add_u32 v113, v112, 7, v113
    s_mul_i32 s56, s37, 4128
    v_xor_b32 v96, s56, v113
    v_xor_b32 v97, 32, v96
    v_xor_b32 v105, 2048, v104
    v_xor_b32 v98, 64, v96
    v_xor_b32 v106, 4096, v104
    v_xor_b32 v99, 96, v96
    v_xor_b32 v107, 6144, v104
    v_add_u32 v100, 103040, v96
    v_add_u32 v108, 82432, v104
    v_add_u32 v96, 20608, v96
    v_add_u32 v104, 12416, v104
    v_add_u32 v101, 103040, v97
    v_add_u32 v109, 82432, v105
    v_add_u32 v97, 20608, v97
    v_add_u32 v105, 12416, v105
    v_add_u32 v102, 103040, v98
    v_add_u32 v110, 82432, v106
    v_add_u32 v98, 20608, v98
    v_add_u32 v106, 12416, v106
    v_add_u32 v103, 103040, v99
    v_add_u32 v111, 82432, v107
    v_add_u32 v99, 20608, v99
    v_add_u32 v107, 12416, v107
    s_lshl_b32 s56, s37, 9
    s_add_u32 s56, s56, 98816
    v_lshlrev_b32 v113, 4, v112
    v_add_u32 v90, s56, v113
    v_lshl_add_u32 v89, v116, 2, v90
    v_lshl_add_u32 v89, v117, 3, v89
    v_mul_u32_u24 v113, 96, v112
    v_and_b32 v114, 4, v112
    v_lshlrev_b32 v114, 2, v114
    s_mul_i32 s56, s37, 3072
    s_add_u32 s56, s56, 103040
    v_add3_u32 v113, v113, v114, s56
    v_lshl_add_u32 v28, v116, 5, v113
    v_lshlrev_b32 v114, 4, v116
    v_xor_b32 v30, v113, v114
    v_mul_u32_u24 v113, 160, v120
    v_mul_u32_u24 v114, 10368, v117
    v_add3_u32 v113, v113, v114, v119
    s_xor_b32 s56, s37, 0
    s_mul_i32 s56, s56, 2560
    v_add_u32 v4, s56, v113
    s_xor_b32 s56, s37, 1
    s_mul_i32 s56, s56, 2560
    v_add_u32 v5, s56, v113
    s_xor_b32 s56, s37, 2
    s_mul_i32 s56, s56, 2560
    v_add_u32 v6, s56, v113
    s_xor_b32 s56, s37, 3
    s_mul_i32 s56, s56, 2560
    v_add_u32 v7, s56, v113
    s_mul_i32 s40, s37, 2560
    s_mul_i32 s58, s34, 5
    s_min_u32 s58, s58, 33
    s_add_u32 s58, s58, 48
    s_mul_i32 s56, s37, 44032
    s_lshl_b32 s57, s58, 5
    s_add_u32 s56, s56, s57
    s_mov_b32 s57, 2592
    v_lshlrev_b32 v112, 4, v82
    v_add_u32 v0, 122880, v112
    v_add_u32 v112, s56, v112
    v_mul_u32_u24 v113, 205, v82
    v_lshrrev_b32 v114, 11, v113
    v_mad_u32_u24 v1, v114, s57, v112
    s_cmp_eq_u32 s34, 7
    s_cselect_b32 s59, 820, 0
    v_and_b32 v114, 0x7ff, v113
    v_cmp_gt_u32 vcc, s59, v114
    s_nop 1
    v_cndmask_b32 v1, v1, 2.0, vcc
    v_add_u32 v113, 13120, v113
    v_lshrrev_b32 v114, 11, v113
    v_mad_u32_u24 v2, v114, s57, v112
    v_and_b32 v114, 0x7ff, v113
    v_cmp_gt_u32 vcc, s59, v114
    s_nop 1
    v_cndmask_b32 v2, v2, 2.0, vcc
    v_add_u32 v113, 13120, v113
    v_lshrrev_b32 v114, 11, v113
    v_mad_u32_u24 v3, v114, s57, v112
    v_and_b32 v114, 0x7ff, v113
    v_cmp_gt_u32 vcc, s59, v114
    s_nop 1
    v_cndmask_b32 v3, v3, 2.0, vcc
    v_and_b32 v112, 15, v82
    v_lshlrev_b32 v113, 2, v121
    v_mov_b32 v114, 0x3f803f80
    v_cmp_eq_u32 vcc, v112, v113
    s_nop 1
    v_cndmask_b32 v12, 0, v114, vcc
    v_cndmask_b32 v13, 0, v114, vcc
    v_cndmask_b32 v14, 0, v114, vcc
    v_cndmask_b32 v15, 0, v114, vcc
    v_xor_b32 v113, s3, v113
    v_or_b32 v94, v113, v0
    s_lshl2_add_u32 s56, s33, s37
    s_mul_i32 s56, s56, 118
    s_add_u32 s57, s56, s58
    s_add_u32 s57, s57, 32
    s_lshl_b32 s52, s57, 10
    s_lshr_b32 s57, s32, 1
    s_lshl2_add_u32 s57, s34, s57
    s_mul_i32 s57, s57, 17408
    s_and_b32 s58, s32, 1
    s_lshl4_add_u32 s59, s58, s33
    s_lshl_b32 s59, s59, 9
    s_add_u32 s53, s57, s59
    s_add_u32 s53, s53, 12521472
    s_lshl1_add_u32 s59, s33, s58
    s_lshl_b32 s59, s59, 5
    s_add_u32 s54, s57, s59
    s_add_u32 s54, s54, 12595456
    s_lshl_b32 s35, s37, 11
    s_sub_u32 s35, s35, 61056
    v_lshlrev_b32 v112, 2, v82
    s_lshl_b32 s56, s32, 8
    s_lshl_b32 s57, s34, 11
    s_add_u32 s57, s57, s56
    s_add_u32 s56, s56, 152192
    v_add_u32 v92, s56, v112
    s_lshr_b32 s56, s37, 1
    s_lshl1_add_u32 s56, s33, s56
    s_lshl3_add_u32 s56, s56, s34
    s_lshl_b32 s56, s56, 7
    s_and_b32 s58, s37, 1
    s_lshl2_add_u32 s56, s58, s56
    s_add_u32 s33, s56, 13631488
    s_cmp_eq_u32 s34, 7
    s_cselect_b32 s34, 2.0, s52
    v_mov_b32 v113, 0
    v_lshlrev_b32 v93, 7, v82
    v_mov_b32 v116, -1
    v_mov_b32 v117, -1
    v_lshrrev_b32 v114, 1, v0
    v_lshrrev_b32 v115, 5, v0
    s_waitcnt lgkmcnt(0)
    s_add_u32 s41, s36, 1
    s_and_b32 s41, s41, 7
    s_add_u32 m0, s38, 41216
    s_lshl_b32 s42, s41, 7
    buffer_load_dwordx4 v80, s[8:11], s42 offen lds
    s_add_u32 s42, s42, 14336
    buffer_load_dwordx4 v80, s[8:11], s42 offen offset:2048 lds
    buffer_load_dword v91, v112, s[28:31], s57 offen
    s_add_u32 s41, s36, 1
    s_and_b32 s41, s41, 7
    s_add_u32 m0, s39, 57600
    s_mul_i32 s43, s41, 196608
    buffer_load_dwordx4 v81, s[12:15], s43 offen lds
    s_add_u32 s41, s36, 2
    s_and_b32 s41, s41, 7
    s_add_u32 m0, s38, 119424
    s_lshl_b32 s42, s41, 7
    buffer_load_dwordx4 v80, s[8:11], s42 offen lds
    s_add_u32 s42, s42, 14336
    buffer_load_dwordx4 v80, s[8:11], s42 offen offset:2048 lds
    s_lshr_b32 s56, s2, 3
    s_lshl2_add_u32 s56, s56, s37
    s_mul_i32 s56, s56, 12288
    v_lshlrev_b32 v112, 3, v93
    s_mov_b64 exec, 0xfff
    buffer_load_dword v26, v112, s[12:15], s56 offen offset:896
    s_mov_b64 exec, 1
    buffer_store_dword v113, off, s[24:27], s33 sc1
    s_mov_b64 exec, -1
    buffer_store_dwordx2 v[116:117], v114, s[24:27], s53 offen sc1
    s_mov_b32 exec_lo, 0x10001
    s_mov_b32 exec_hi, 0x10001
    buffer_store_dwordx2 v[116:117], v115, s[24:27], s54 offen sc1
    s_mov_b64 exec, -1
    s_mov_b32 s0, 0xaaaaaaaa
    s_mov_b32 s1, 0xaaaaaaaa
    s_mov_b32 s28, 0xcccccccc
    s_mov_b32 s29, 0xcccccccc
    s_mov_b32 s30, 0xff00ff00
    s_mov_b32 s31, 0xff00ff00
    s_mov_b32 s20, 0xffff0000
    s_mov_b32 s21, 0xffff0000
    s_mov_b32 s22, 0xf0f0f0f
    s_mov_b32 s23, 0xf0f0f0f0
    s_waitcnt vmcnt(11)
    s_waitcnt vmcnt(10)
    s_barrier
    ds_read_b128 v[128:131], v96 offset:0
    ds_read_b64_tr_b16 v[32:33], v104 offset:0
    ds_read_b64_tr_b16 v[34:35], v104 offset:512
    ds_read_b128 v[132:135], v97 offset:0
    ds_read_b128 v[136:139], v98 offset:0
    ds_read_b128 v[140:143], v99 offset:0
    ds_read_b64_tr_b16 v[36:37], v105 offset:0
    ds_read_b64_tr_b16 v[38:39], v105 offset:512
    ds_read_b64_tr_b16 v[40:41], v106 offset:0
    ds_read_b64_tr_b16 v[42:43], v106 offset:512
    ds_read_b64_tr_b16 v[44:45], v107 offset:0
    ds_read_b64_tr_b16 v[46:47], v107 offset:512
    s_waitcnt lgkmcnt(9)
    v_mfma_f32_16x16x32_bf16 v[16:19], v[12:15], v[32:35], 0
    v_mfma_f32_32x32x16_bf16 v[48:63], v[32:35], v[128:131], 0
    s_waitcnt lgkmcnt(4)
    v_mfma_f32_16x16x32_bf16 v[20:23], v[12:15], v[128:131], 0
    v_mfma_f32_32x32x16_bf16 v[48:63], v[36:39], v[132:135], v[48:63]
    s_waitcnt lgkmcnt(2)
    v_mfma_f32_16x16x32_bf16 v[20:23], v[12:15], v[132:135], v[20:23]
    v_mfma_f32_32x32x16_bf16 v[48:63], v[40:43], v[136:139], v[48:63]
    s_add_u32 s41, s36, 2
    s_and_b32 s41, s41, 7
    s_add_u32 m0, s39, 144000
    s_mul_i32 s43, s41, 196608
    buffer_load_dwordx4 v81, s[12:15], s43 offen lds
    s_add_u32 s41, s36, 3
    s_and_b32 s41, s41, 7
    s_add_u32 m0, s38, 103040
    s_lshl_b32 s42, s41, 7
    buffer_load_dwordx4 v80, s[8:11], s42 offen lds
    s_add_u32 s42, s42, 14336
    buffer_load_dwordx4 v80, s[8:11], s42 offen offset:2048 lds
    s_waitcnt vmcnt(11)
    s_waitcnt vmcnt(9)
    s_waitcnt vmcnt(7)
    s_barrier
    ds_read_b128 v[144:147], v96 offset:20608
    ds_read_b64_tr_b16 v[40:41], v104 offset:45184
    ds_read_b64_tr_b16 v[42:43], v104 offset:45696
    ds_read_b128 v[148:151], v97 offset:20608
    ds_read_b128 v[152:155], v98 offset:20608
    ds_read_b128 v[156:159], v99 offset:20608
    s_waitcnt lgkmcnt(6)
    v_mfma_f32_32x32x16_bf16 v[48:63], v[44:47], v[140:143], v[48:63]
    s_add_u32 s41, s36, 3
    s_and_b32 s41, s41, 7
    s_add_u32 m0, s39, 135808
    s_mul_i32 s43, s41, 196608
    buffer_load_dwordx4 v81, s[12:15], s43 offen lds
    ds_read_b128 v[160:163], v100 offset:16384
    ds_read_b128 v[164:167], v101 offset:16384
    ds_read_b64_tr_b16 v[44:45], v105 offset:45184
    ds_read_b64_tr_b16 v[46:47], v105 offset:45696
    v_mfma_f32_32x32x16_bf16 v[112:127], v[128:131], v[128:131], 0
    s_add_u32 s41, s36, 4
    s_and_b32 s41, s41, 7
    s_add_u32 m0, s38, 66048
    s_lshl_b32 s42, s41, 7
    buffer_load_dwordx4 v80, s[8:11], s42 offen lds
    ds_read_b128 v[168:171], v102 offset:16384
    ds_read_b128 v[172:175], v103 offset:16384
    ds_read_b64_tr_b16 v[32:33], v106 offset:45184
    ds_read_b64_tr_b16 v[34:35], v106 offset:45696
    v_mfma_f32_32x32x16_bf16 v[112:127], v[132:135], v[132:135], v[112:127]
    s_add_u32 s42, s42, 14336
    buffer_load_dwordx4 v80, s[8:11], s42 offen offset:2048 lds
    ds_read_b64_tr_b16 v[36:37], v107 offset:45184
    ds_read_b64_tr_b16 v[38:39], v107 offset:45696
    s_waitcnt lgkmcnt(13)
    v_mfma_f32_16x16x32_bf16 v[16:19], v[12:15], v[40:43], v[16:19]
    v_mfma_f32_32x32x16_bf16 v[48:63], v[40:43], v[144:147], v[48:63]
    s_waitcnt lgkmcnt(6)
    v_mfma_f32_16x16x32_bf16 v[20:23], v[12:15], v[144:147], v[20:23]
    v_mfma_f32_32x32x16_bf16 v[48:63], v[44:47], v[148:151], v[48:63]
    s_waitcnt lgkmcnt(2)
    v_mfma_f32_16x16x32_bf16 v[20:23], v[12:15], v[148:151], v[20:23]
    v_mfma_f32_32x32x16_bf16 v[48:63], v[32:35], v[152:155], v[48:63]
    s_waitcnt vmcnt(5)
    s_waitcnt vmcnt(3)
    s_barrier
    ds_read_b64_tr_b16 v[32:33], v108 offset:61568
    ds_read_b64_tr_b16 v[34:35], v108 offset:62080
    s_waitcnt lgkmcnt(2)
    v_mfma_f32_16x16x32_bf16 v[20:23], v[12:15], v[160:163], v[20:23]
    v_mfma_f32_32x32x16_bf16 v[48:63], v[36:39], v[156:159], v[48:63]
    s_add_u32 s41, s36, 4
    s_and_b32 s41, s41, 7
    s_add_u32 m0, s39, 12416
    s_mul_i32 s43, s41, 196608
    buffer_load_dwordx4 v81, s[12:15], s43 offen lds
    ds_read_b128 v[176:179], v100 offset:0
    ds_read_b128 v[180:183], v101 offset:0
    ds_read_b64_tr_b16 v[36:37], v109 offset:61568
    ds_read_b64_tr_b16 v[38:39], v109 offset:62080
    v_mfma_f32_16x16x32_bf16 v[20:23], v[12:15], v[164:167], v[20:23]
    v_mfma_f32_32x32x16_bf16 v[112:127], v[144:147], v[144:147], v[112:127]
    s_add_u32 s41, s36, 5
    s_and_b32 s41, s41, 7
    s_add_u32 m0, s38, 82432
    s_lshl_b32 s42, s41, 7
    buffer_load_dwordx4 v80, s[8:11], s42 offen lds
    ds_read_b128 v[184:187], v102 offset:0
    ds_read_b128 v[188:191], v103 offset:0
    ds_read_b64_tr_b16 v[40:41], v110 offset:61568
    ds_read_b64_tr_b16 v[42:43], v110 offset:62080
    s_waitcnt lgkmcnt(7)
    v_mfma_f32_16x16x32_bf16 v[20:23], v[12:15], v[176:179], v[20:23]
    v_mfma_f32_32x32x16_bf16 v[112:127], v[148:151], v[148:151], v[112:127]
    s_add_u32 s42, s42, 14336
    buffer_load_dwordx4 v80, s[8:11], s42 offen offset:2048 lds
    ds_write_b32 v92, v91
    ds_read_b64_tr_b16 v[44:45], v111 offset:61568
    ds_read_b64_tr_b16 v[46:47], v111 offset:62080
    v_mfma_f32_16x16x32_bf16 v[16:19], v[12:15], v[32:35], v[16:19]
    v_mfma_f32_32x32x16_bf16 v[48:63], v[32:35], v[160:163], v[48:63]
    v_xor_b32 v91, 0x80008000, v91
    ds_write_b32 v92, v91 offset:2048
    s_waitcnt lgkmcnt(8)
    v_mfma_f32_16x16x32_bf16 v[20:23], v[12:15], v[180:183], v[20:23]
    v_mfma_f32_32x32x16_bf16 v[48:63], v[36:39], v[164:167], v[48:63]
    s_waitcnt lgkmcnt(4)
    v_mfma_f32_32x32x16_bf16 v[48:63], v[40:43], v[168:171], v[48:63]
    s_waitcnt lgkmcnt(1)
    v_mfma_f32_32x32x16_bf16 v[48:63], v[44:47], v[172:175], v[48:63]
    v_mfma_f32_32x32x16_bf16 v[112:127], v[160:163], v[160:163], v[112:127]
    s_waitcnt vmcnt(5)
    s_waitcnt vmcnt(3)
    s_barrier
    ds_read_b64_tr_b16 v[32:33], v108 offset:53376
    ds_read_b64_tr_b16 v[34:35], v108 offset:53888
    v_mfma_f32_32x32x16_bf16 v[112:127], v[164:167], v[164:167], v[112:127]
    s_add_u32 s41, s36, 5
    s_and_b32 s41, s41, 7
    s_add_u32 m0, s39, 57600
    s_mul_i32 s43, s41, 196608
    buffer_load_dwordx4 v81, s[12:15], s43 offen lds
    ds_read_b128 v[192:195], v96 offset:45440
    ds_read_b128 v[196:199], v97 offset:45440
    ds_read_b64_tr_b16 v[36:37], v109 offset:53376
    ds_read_b64_tr_b16 v[38:39], v109 offset:53888
    v_mfma_f32_32x32x16_bf16 v[112:127], v[176:179], v[176:179], v[112:127]
    s_add_u32 s41, s36, 6
    s_and_b32 s41, s41, 7
    s_add_u32 m0, s38, 119424
    s_lshl_b32 s42, s41, 7
    buffer_load_dwordx4 v80, s[8:11], s42 offen lds
    ds_read_b128 v[200:203], v98 offset:45440
    ds_read_b128 v[204:207], v99 offset:45440
    ds_read_b64_tr_b16 v[40:41], v110 offset:53376
    ds_read_b64_tr_b16 v[42:43], v110 offset:53888
    s_waitcnt lgkmcnt(7)
    v_mfma_f32_16x16x32_bf16 v[20:23], v[12:15], v[192:195], v[20:23]
    v_mfma_f32_32x32x16_bf16 v[112:127], v[180:183], v[180:183], v[112:127]
    s_add_u32 s42, s42, 14336
    buffer_load_dwordx4 v80, s[8:11], s42 offen offset:2048 lds
    ds_read_b64_tr_b16 v[44:45], v111 offset:53376
    ds_read_b64_tr_b16 v[46:47], v111 offset:53888
    v_mfma_f32_16x16x32_bf16 v[16:19], v[12:15], v[32:35], v[16:19]
    v_mfma_f32_32x32x16_bf16 v[48:63], v[32:35], v[176:179], v[48:63]
    s_waitcnt lgkmcnt(6)
    v_mfma_f32_16x16x32_bf16 v[20:23], v[12:15], v[196:199], v[20:23]
    v_mfma_f32_32x32x16_bf16 v[48:63], v[36:39], v[180:183], v[48:63]
    s_waitcnt lgkmcnt(2)
    v_mfma_f32_32x32x16_bf16 v[48:63], v[40:43], v[184:187], v[48:63]
    s_waitcnt vmcnt(5)
    s_waitcnt vmcnt(3)
    s_barrier
    ds_read_b64_tr_b16 v[40:41], v104 offset:0
    ds_read_b64_tr_b16 v[42:43], v104 offset:512
    s_waitcnt lgkmcnt(2)
    v_mfma_f32_32x32x16_bf16 v[48:63], v[44:47], v[188:191], v[48:63]
    s_add_u32 s41, s36, 6
    s_and_b32 s41, s41, 7
    s_add_u32 m0, s39, 144000
    s_mul_i32 s43, s41, 196608
    buffer_load_dwordx4 v81, s[12:15], s43 offen lds
    ds_read_b128 v[208:211], v96 offset:61824
    ds_read_b128 v[212:215], v97 offset:61824
    ds_read_b64_tr_b16 v[44:45], v105 offset:0
    ds_read_b64_tr_b16 v[46:47], v105 offset:512
    v_mfma_f32_32x32x16_bf16 v[112:127], v[192:195], v[192:195], v[112:127]
    s_add_u32 s41, s36, 7
    s_and_b32 s41, s41, 7
    s_add_u32 m0, s38, 103040
    s_lshl_b32 s42, s41, 7
    buffer_load_dwordx4 v80, s[8:11], s42 offen lds
    ds_read_b128 v[216:219], v98 offset:61824
    ds_read_b128 v[220:223], v99 offset:61824
    ds_read_b64_tr_b16 v[32:33], v106 offset:0
    ds_read_b64_tr_b16 v[34:35], v106 offset:512
    s_waitcnt lgkmcnt(7)
    v_mfma_f32_16x16x32_bf16 v[20:23], v[12:15], v[208:211], v[20:23]
    v_mfma_f32_32x32x16_bf16 v[112:127], v[196:199], v[196:199], v[112:127]
    s_add_u32 s42, s42, 14336
    buffer_load_dwordx4 v80, s[8:11], s42 offen offset:2048 lds
    ds_read_b64_tr_b16 v[36:37], v107 offset:0
    ds_read_b64_tr_b16 v[38:39], v107 offset:512
    v_mfma_f32_16x16x32_bf16 v[16:19], v[12:15], v[40:43], v[16:19]
    v_mfma_f32_32x32x16_bf16 v[48:63], v[40:43], v[192:195], v[48:63]
    s_add_u32 s41, s36, 0
    s_and_b32 s41, s41, 7
    s_add_u32 m0, s39, 19584
    s_mul_i32 s43, s41, 196608
    buffer_load_dwordx4 v81, s[12:15], s43 offen offset:1024 lds
    s_waitcnt lgkmcnt(6)
    v_mfma_f32_16x16x32_bf16 v[20:23], v[12:15], v[212:215], v[20:23]
    v_mfma_f32_32x32x16_bf16 v[48:63], v[44:47], v[196:199], v[48:63]
    s_waitcnt lgkmcnt(2)
    v_mfma_f32_32x32x16_bf16 v[48:63], v[32:35], v[200:203], v[48:63]
    s_waitcnt vmcnt(6)
    s_waitcnt vmcnt(4)
    s_barrier
    ds_read_b64_tr_b16 v[32:33], v104 offset:45184
    ds_read_b64_tr_b16 v[34:35], v104 offset:45696
    s_waitcnt lgkmcnt(2)
    v_mfma_f32_32x32x16_bf16 v[48:63], v[36:39], v[204:207], v[48:63]
    s_add_u32 s41, s36, 7
    s_and_b32 s41, s41, 7
    s_add_u32 m0, s39, 135808
    s_mul_i32 s43, s41, 196608
    buffer_load_dwordx4 v81, s[12:15], s43 offen lds
    ds_read_b128 v[224:227], v100 offset:16384
    ds_read_b128 v[228:231], v101 offset:16384
    ds_read_b64_tr_b16 v[36:37], v105 offset:45184
    ds_read_b64_tr_b16 v[38:39], v105 offset:45696
    v_mfma_f32_32x32x16_bf16 v[112:127], v[208:211], v[208:211], v[112:127]
    s_add_u32 s41, s36, 1
    s_and_b32 s41, s41, 7
    s_add_u32 m0, s39, 27776
    s_mul_i32 s43, s41, 196608
    buffer_load_dwordx4 v81, s[12:15], s43 offen offset:1024 lds
    ds_read_b128 v[232:235], v102 offset:16384
    ds_read_b128 v[236:239], v103 offset:16384
    ds_read_b64_tr_b16 v[40:41], v106 offset:45184
    ds_read_b64_tr_b16 v[42:43], v106 offset:45696
    s_waitcnt lgkmcnt(7)
    v_mfma_f32_16x16x32_bf16 v[20:23], v[12:15], v[224:227], v[20:23]
    v_mfma_f32_32x32x16_bf16 v[112:127], v[212:215], v[212:215], v[112:127]
    s_add_u32 s41, s36, 2
    s_and_b32 s41, s41, 7
    s_add_u32 m0, s39, 40192
    s_mul_i32 s43, s41, 196608
    buffer_load_dwordx4 v81, s[12:15], s43 offen offset:1024 lds
    ds_read_b64_tr_b16 v[44:45], v107 offset:45184
    ds_read_b64_tr_b16 v[46:47], v107 offset:45696
    v_mfma_f32_16x16x32_bf16 v[16:19], v[12:15], v[32:35], v[16:19]
    v_mfma_f32_32x32x16_bf16 v[48:63], v[32:35], v[208:211], v[48:63]
    s_waitcnt lgkmcnt(6)
    v_mfma_f32_16x16x32_bf16 v[20:23], v[12:15], v[228:231], v[20:23]
    v_mfma_f32_32x32x16_bf16 v[48:63], v[36:39], v[212:215], v[48:63]
    s_waitcnt lgkmcnt(2)
    v_mfma_f32_32x32x16_bf16 v[48:63], v[40:43], v[216:219], v[48:63]
    s_waitcnt vmcnt(6)
    s_waitcnt vmcnt(4)
    s_barrier
    ds_read_b64_tr_b16 v[40:41], v108 offset:61568
    ds_read_b64_tr_b16 v[42:43], v108 offset:62080
    s_waitcnt lgkmcnt(2)
    v_mfma_f32_32x32x16_bf16 v[48:63], v[44:47], v[220:223], v[48:63]
    s_add_u32 s41, s36, 3
    s_and_b32 s41, s41, 7
    s_add_u32 m0, s39, 48384
    s_mul_i32 s43, s41, 196608
    buffer_load_dwordx4 v81, s[12:15], s43 offen offset:1024 lds
    ds_read_b128 v[240:243], v100 offset:0
    ds_read_b128 v[244:247], v101 offset:0
    v_mfma_f32_32x32x16_bf16 v[112:127], v[224:227], v[224:227], v[112:127]
    s_add_u32 s41, s36, 4
    s_and_b32 s41, s41, 7
    s_add_u32 m0, s39, 65024
    s_mul_i32 s43, s41, 196608
    buffer_load_dwordx4 v81, s[12:15], s43 offen offset:1024 lds
    ds_read_b128 v[248:251], v102 offset:0
    ds_read_b128 v[252:255], v103 offset:0
    s_waitcnt lgkmcnt(3)
    v_mfma_f32_16x16x32_bf16 v[20:23], v[12:15], v[240:243], v[20:23]
    v_mfma_f32_32x32x16_bf16 v[112:127], v[228:231], v[228:231], v[112:127]
    s_add_u32 s41, s36, 5
    s_and_b32 s41, s41, 7
    s_add_u32 m0, s39, 73216
    s_mul_i32 s43, s41, 196608
    buffer_load_dwordx4 v81, s[12:15], s43 offen offset:1024 lds
    ds_read_b64_tr_b16 v[36:37], v109 offset:61568
    ds_read_b64_tr_b16 v[38:39], v109 offset:62080
    v_mfma_f32_16x16x32_bf16 v[16:19], v[12:15], v[40:43], v[16:19]
    v_mfma_f32_32x32x16_bf16 v[48:63], v[40:43], v[224:227], v[48:63]
    ds_read_b64_tr_b16 v[40:41], v110 offset:61568
    ds_read_b64_tr_b16 v[42:43], v110 offset:62080
    s_waitcnt lgkmcnt(6)
    v_mfma_f32_16x16x32_bf16 v[20:23], v[12:15], v[244:247], v[20:23]
    v_mfma_f32_32x32x16_bf16 v[112:127], v[240:243], v[240:243], v[112:127]
    ds_read_b64_tr_b16 v[44:45], v111 offset:61568
    ds_read_b64_tr_b16 v[46:47], v111 offset:62080
    v_mfma_f32_32x32x16_bf16 v[112:127], v[244:247], v[244:247], v[112:127]
    s_nop 3
    v_mov_b32 v83, v20
    s_waitcnt vmcnt(5)
    s_barrier
    ds_read_b64_tr_b16 v[32:33], v108 offset:53376
    ds_read_b64_tr_b16 v[34:35], v108 offset:53888
    s_waitcnt lgkmcnt(6)
    v_mfma_f32_32x32x16_bf16 v[48:63], v[36:39], v[228:231], v[48:63]
    s_add_u32 s41, s36, 6
    s_and_b32 s41, s41, 7
    s_add_u32 m0, s39, 81408
    s_mul_i32 s43, s41, 196608
    buffer_load_dwordx4 v81, s[12:15], s43 offen offset:1024 lds
    ds_read_b64_tr_b16 v[36:37], v109 offset:53376
    ds_read_b64_tr_b16 v[38:39], v109 offset:53888
    s_waitcnt lgkmcnt(6)
    v_mfma_f32_32x32x16_bf16 v[48:63], v[40:43], v[232:235], v[48:63]
    v_cndmask_b32 v112, v112, v113, s[0:1]
    v_cndmask_b32 v114, v114, v115, s[0:1]
    v_cndmask_b32 v116, v116, v117, s[0:1]
    v_cndmask_b32 v118, v118, v119, s[0:1]
    v_cndmask_b32 v120, v120, v121, s[0:1]
    v_cndmask_b32 v122, v122, v123, s[0:1]
    s_add_u32 s41, s36, 7
    s_and_b32 s41, s41, 7
    s_add_u32 m0, s39, 89600
    s_mul_i32 s43, s41, 196608
    buffer_load_dwordx4 v81, s[12:15], s43 offen offset:1024 lds
    s_mov_b32 s12, s46
    s_mov_b32 s13, s47
    s_mov_b32 s14, 2097152
    s_mov_b32 s46, 524288
    s_mov_b32 s47, 0x20000
    ds_read_b64_tr_b16 v[40:41], v110 offset:53376
    ds_read_b64_tr_b16 v[42:43], v110 offset:53888
    s_waitcnt lgkmcnt(6)
    v_mfma_f32_32x32x16_bf16 v[48:63], v[44:47], v[236:239], v[48:63]
    v_cndmask_b32 v124, v124, v125, s[0:1]
    v_cndmask_b32 v126, v126, v127, s[0:1]
    v_cndmask_b32 v112, v112, v114, s[28:29]
    v_cndmask_b32 v116, v116, v118, s[28:29]
    v_cndmask_b32 v120, v120, v122, s[28:29]
    v_cndmask_b32 v124, v124, v126, s[28:29]
    s_add_u32 s41, s36, 8
    s_and_b32 s41, s41, 7
    s_add_u32 m0, s40, 0
    s_mul_i32 s43, s41, 176128
    buffer_load_dwordx4 v1, s[16:19], s43 offen lds
    ds_read_b64_tr_b16 v[44:45], v111 offset:53376
    ds_read_b64_tr_b16 v[46:47], v111 offset:53888
    s_waitcnt lgkmcnt(6)
    v_mfma_f32_16x16x32_bf16 v[16:19], v[12:15], v[32:35], v[16:19]
    v_mfma_f32_32x32x16_bf16 v[48:63], v[32:35], v[240:243], v[48:63]
    v_cndmask_b32 v112, v112, v116, s[30:31]
    v_cndmask_b32 v120, v120, v124, s[30:31]
    v_cndmask_b32 v112, v112, v120, s[20:21]
    v_cndmask_b32 v84, 0, v112, s[22:23]
    s_nop 1
    v_permlane32_swap_b32 v83, v84
    v_add_f32 v83, v83, v84
    buffer_load_dwordx4 v2, s[16:19], s43 offen offset:1024 lds
    ds_write_b32 v89, v83
    ds_read_b64_tr_b16 v[32:33], v104 offset:8192
    ds_read_b64_tr_b16 v[34:35], v104 offset:8704
    s_waitcnt lgkmcnt(7)
    v_mfma_f32_32x32x16_bf16 v[48:63], v[36:39], v[244:247], v[48:63]
    v_and_b32 v85, s55, v16
    v_sub_f32 v86, v16, v85
    v_cvt_pk_bf16_f32 v85, v85, v86
    s_mov_b32 exec_hi, 0
    buffer_load_dwordx4 v3, s[16:19], s43 offen offset:2048 lds
    s_mov_b32 exec_hi, -1
    ds_write_b32 v94, v85 offset:33408
    ds_read_b64_tr_b16 v[36:37], v105 offset:8192
    ds_read_b64_tr_b16 v[38:39], v105 offset:8704
    s_waitcnt lgkmcnt(8)
    v_mfma_f32_32x32x16_bf16 v[48:63], v[40:43], v[248:251], v[48:63]
    s_waitcnt vmcnt(9)
    s_waitcnt vmcnt(8)
    s_waitcnt lgkmcnt(2)
    s_barrier
    ds_read_b128 v[8:11], v90
    ds_read_b64_tr_b16 v[40:41], v106 offset:8192
    ds_read_b64_tr_b16 v[42:43], v106 offset:8704
    v_mfma_f32_32x32x16_bf16 v[48:63], v[44:47], v[252:255], v[48:63]
    ds_read_b128 v[44:47], v0 offset:33408
    v_mfma_f32_16x16x32_bf16 v[18:21], v[12:15], v[32:35], v[18:21]
    v_mfma_f32_32x32x16_bf16 v[64:79], v[32:35], v[128:131], 0
    ds_read_b64_tr_b16 v[32:33], v107 offset:8192
    ds_read_b64_tr_b16 v[34:35], v107 offset:8704
    s_waitcnt lgkmcnt(5)
    v_mfma_f32_32x32x16_bf16 v[64:79], v[36:39], v[132:135], v[64:79]
    v_add_f32 v8, v8, v10
    v_add_f32 v24, v9, v11
    v_mul_f32 v25, 0xbb000000, v8
    v_mul_f32 v24, 0x3b000000, v24
    v_cvt_pk_bf16_f32 v8, v25, v25
    v_cvt_pk_bf16_f32 v9, v25, v25
    v_cvt_pk_bf16_f32 v10, v25, v25
    ds_read_b64_tr_b16 v[36:37], v104 offset:16384
    ds_read_b64_tr_b16 v[38:39], v104 offset:16896
    s_waitcnt lgkmcnt(5)
    v_mfma_f32_32x32x16_bf16 v[64:79], v[40:43], v[136:139], v[64:79]
    v_cvt_pk_bf16_f32 v11, v25, v25
    v_fma_f32 v24, -v25, v25, v24
    v_max_f32 v24, 0, v24
    v_add_f32 v24, 0x3727c5ac, v24
    v_rsq_f32 v26, v24
    ds_read_b64_tr_b16 v[40:41], v27 offset:0
    ds_read_b64_tr_b16 v[42:43], v27 offset:128
    s_waitcnt lgkmcnt(6)
    v_mfma_f32_32x32x16_bf16 v[48:63], v[44:47], v[8:11], v[48:63]
    v_mul_f32 v25, v24, v26
    v_mul_f32 v24, 0xbfb8aa3b, v26
    ds_read_b64_tr_b16 v[44:45], v27 offset:512
    ds_read_b64_tr_b16 v[46:47], v27 offset:640
    s_waitcnt lgkmcnt(6)
    v_mfma_f32_32x32x16_bf16 v[64:79], v[32:35], v[140:143], v[64:79]
    ds_read_b64_tr_b16 v[32:33], v105 offset:16384
    ds_read_b64_tr_b16 v[34:35], v105 offset:16896
    s_waitcnt lgkmcnt(6)
    v_mfma_f32_16x16x32_bf16 v[18:21], v[12:15], v[36:39], v[18:21]
    v_mfma_f32_32x32x16_bf16 v[64:79], v[36:39], v[144:147], v[64:79]
    s_nop 0
    v_cvt_pk_bf16_f32 v96, v48, v49
    v_cvt_pk_bf16_f32 v97, v50, v51
    v_cvt_pk_bf16_f32 v98, v52, v53
    v_cvt_pk_bf16_f32 v99, v54, v55
    v_cvt_pk_bf16_f32 v100, v56, v57
    v_cvt_pk_bf16_f32 v101, v58, v59
    v_cvt_pk_bf16_f32 v102, v60, v61
    ds_read_b64_tr_b16 v[36:37], v106 offset:16384
    ds_read_b64_tr_b16 v[38:39], v106 offset:16896
    s_waitcnt lgkmcnt(6)
    v_mfma_f32_32x32x16_bf16 v[112:127], v[40:43], v[96:99], 0
    v_cvt_pk_bf16_f32 v103, v62, v63
    ds_read_b64_tr_b16 v[40:41], v107 offset:16384
    ds_read_b64_tr_b16 v[42:43], v107 offset:16896
    s_waitcnt lgkmcnt(6)
    v_mfma_f32_32x32x16_bf16 v[48:63], v[44:47], v[100:103], 0
    ds_read_b64_tr_b16 v[44:45], v104 offset:28800
    ds_read_b64_tr_b16 v[46:47], v104 offset:29312
    s_waitcnt lgkmcnt(6)
    v_mfma_f32_32x32x16_bf16 v[64:79], v[32:35], v[148:151], v[64:79]
    s_nop 2
    v_max_f32 v87, v112, v113
    v_max_f32 v88, v114, v115
    v_max3_f32 v87, v87, v116, v117
    v_max3_f32 v88, v88, v118, v119
    v_max3_f32 v87, v87, v120, v121
    v_max3_f32 v88, v88, v122, v123
    v_max3_f32 v87, v87, v124, v125
    ds_read_b64_tr_b16 v[32:33], v105 offset:28800
    ds_read_b64_tr_b16 v[34:35], v105 offset:29312
    s_waitcnt lgkmcnt(6)
    v_mfma_f32_32x32x16_bf16 v[64:79], v[36:39], v[152:155], v[64:79]
    v_max_f32 v31, v48, v49
    v_max_f32 v27, v50, v51
    v_max3_f32 v88, v88, v126, v127
    v_max_f32 v87, v87, v88
    v_mul_f32 v87, v87, v24
    v_fma_f32 v112, v112, -v24, v87
    v_fma_f32 v113, v113, -v24, v87
    ds_read_b64_tr_b16 v[36:37], v106 offset:28800
    ds_read_b64_tr_b16 v[38:39], v106 offset:29312
    s_waitcnt lgkmcnt(6)
    v_mfma_f32_32x32x16_bf16 v[64:79], v[40:43], v[156:159], v[64:79]
    v_exp_f32 v112, v112
    v_fma_f32 v114, v114, -v24, v87
    v_fma_f32 v115, v115, -v24, v87
    v_fma_f32 v116, v116, -v24, v87
    v_fma_f32 v117, v117, -v24, v87
    v_fma_f32 v118, v118, -v24, v87
    ds_read_b64_tr_b16 v[40:41], v107 offset:28800
    ds_read_b64_tr_b16 v[42:43], v107 offset:29312
    s_waitcnt lgkmcnt(6)
    v_mfma_f32_16x16x32_bf16 v[18:21], v[12:15], v[44:47], v[18:21]
    v_mfma_f32_32x32x16_bf16 v[64:79], v[44:47], v[160:163], v[64:79]
    v_exp_f32 v113, v113
    v_fma_f32 v119, v119, -v24, v87
    v_fma_f32 v120, v120, -v24, v87
    v_fma_f32 v121, v121, -v24, v87
    v_fma_f32 v122, v122, -v24, v87
    s_waitcnt vmcnt(7)
    s_waitcnt vmcnt(6)
    s_waitcnt vmcnt(5)
    s_barrier
    ds_read_b64_tr_b16 v[44:45], v104 offset:36992
    ds_read_b64_tr_b16 v[46:47], v104 offset:37504
    s_waitcnt lgkmcnt(6)
    v_mfma_f32_32x32x16_bf16 v[64:79], v[32:35], v[164:167], v[64:79]
    v_exp_f32 v114, v114
    v_fma_f32 v123, v123, -v24, v87
    v_fma_f32 v124, v124, -v24, v87
    v_fma_f32 v125, v125, -v24, v87
    v_fma_f32 v126, v126, -v24, v87
    v_fma_f32 v127, v127, -v24, v87
    s_add_u32 s41, s36, 9
    s_and_b32 s41, s41, 7
    s_add_u32 m0, s40, 20608
    s_mul_i32 s43, s41, 176128
    buffer_load_dwordx4 v1, s[16:19], s43 offen lds
    ds_read_b64_tr_b16 v[32:33], v105 offset:36992
    ds_read_b64_tr_b16 v[34:35], v105 offset:37504
    s_waitcnt lgkmcnt(6)
    v_mfma_f32_32x32x16_bf16 v[64:79], v[36:39], v[168:171], v[64:79]
    v_add_f32 v88, v112, v113
    v_exp_f32 v115, v115
    v_add_f32 v88, v88, v114
    v_exp_f32 v116, v116
    v_add_f32 v88, v88, v115
    ds_read_b64_tr_b16 v[36:37], v106 offset:36992
    ds_read_b64_tr_b16 v[38:39], v106 offset:37504
    s_waitcnt lgkmcnt(6)
    v_mfma_f32_32x32x16_bf16 v[64:79], v[40:43], v[172:175], v[64:79]
    v_exp_f32 v117, v117
    v_add_f32 v88, v88, v116
    v_exp_f32 v118, v118
    v_add_f32 v88, v88, v117
    v_add_f32 v88, v88, v118
    ds_read_b64_tr_b16 v[40:41], v107 offset:36992
    ds_read_b64_tr_b16 v[42:43], v107 offset:37504
    s_waitcnt lgkmcnt(6)
    v_mfma_f32_16x16x32_bf16 v[18:21], v[12:15], v[44:47], v[18:21]
    v_mfma_f32_32x32x16_bf16 v[64:79], v[44:47], v[176:179], v[64:79]
    v_exp_f32 v119, v119
    v_exp_f32 v120, v120
    v_add_f32 v88, v88, v119
    v_exp_f32 v121, v121
    ds_read_b64_tr_b16 v[44:45], v104 offset:53632
    ds_read_b64_tr_b16 v[46:47], v104 offset:54144
    s_waitcnt lgkmcnt(6)
    v_mfma_f32_32x32x16_bf16 v[64:79], v[32:35], v[180:183], v[64:79]
    v_add_f32 v88, v88, v120
    v_exp_f32 v122, v122
    v_add_f32 v88, v88, v121
    v_exp_f32 v123, v123
    v_add_f32 v88, v88, v122
    buffer_load_dwordx4 v2, s[16:19], s43 offen offset:1024 lds
    ds_read_b64_tr_b16 v[32:33], v105 offset:53632
    ds_read_b64_tr_b16 v[34:35], v105 offset:54144
    s_waitcnt lgkmcnt(6)
    v_mfma_f32_32x32x16_bf16 v[64:79], v[36:39], v[184:187], v[64:79]
    v_exp_f32 v124, v124
    v_add_f32 v88, v88, v123
    v_exp_f32 v125, v125
    v_add_f32 v88, v88, v124
    v_add_f32 v88, v88, v125
    ds_read_b64_tr_b16 v[36:37], v106 offset:53632
    ds_read_b64_tr_b16 v[38:39], v106 offset:54144
    s_waitcnt lgkmcnt(6)
    v_mfma_f32_32x32x16_bf16 v[64:79], v[40:43], v[188:191], v[64:79]
    v_exp_f32 v126, v126
    v_exp_f32 v127, v127
    v_add_f32 v88, v88, v126
    v_add_f32 v88, v88, v127
    v_max3_f32 v31, v31, v52, v53
    ds_read_b64_tr_b16 v[40:41], v107 offset:53632
    ds_read_b64_tr_b16 v[42:43], v107 offset:54144
    s_waitcnt lgkmcnt(6)
    v_mfma_f32_16x16x32_bf16 v[18:21], v[12:15], v[44:47], v[18:21]
    v_mfma_f32_32x32x16_bf16 v[64:79], v[44:47], v[192:195], v[64:79]
    v_rcp_f32 v88, v88
    v_max3_f32 v27, v27, v54, v55
    v_mul_f32 v112, v112, v88
    v_mul_f32 v113, v113, v88
    v_cvt_pk_bf16_f32 v112, v112, v113
    v_mul_f32 v114, v114, v88
    ds_read_b64_tr_b16 v[44:45], v104 offset:61824
    ds_read_b64_tr_b16 v[46:47], v104 offset:62336
    s_waitcnt lgkmcnt(6)
    v_mfma_f32_32x32x16_bf16 v[64:79], v[32:35], v[196:199], v[64:79]
    v_mul_f32 v115, v115, v88
    v_cvt_pk_bf16_f32 v113, v114, v115
    v_mul_f32 v116, v116, v88
    v_mul_f32 v117, v117, v88
    v_cvt_pk_bf16_f32 v114, v116, v117
    v_mul_f32 v118, v118, v88
    v_mul_f32 v119, v119, v88
    s_mov_b32 exec_hi, 0
    buffer_load_dwordx4 v3, s[16:19], s43 offen offset:2048 lds
    s_mov_b32 exec_hi, -1
    ds_read_b64_tr_b16 v[32:33], v105 offset:61824
    ds_read_b64_tr_b16 v[34:35], v105 offset:62336
    s_waitcnt lgkmcnt(6)
    v_mfma_f32_32x32x16_bf16 v[64:79], v[36:39], v[200:203], v[64:79]
    v_cvt_pk_bf16_f32 v115, v118, v119
    v_mul_f32 v120, v120, v88
    v_mul_f32 v121, v121, v88
    v_cvt_pk_bf16_f32 v116, v120, v121
    v_mul_f32 v122, v122, v88
    v_mul_f32 v123, v123, v88
    v_cvt_pk_bf16_f32 v117, v122, v123
    ds_read_b64_tr_b16 v[36:37], v106 offset:61824
    ds_read_b64_tr_b16 v[38:39], v106 offset:62336
    s_waitcnt lgkmcnt(6)
    v_mfma_f32_32x32x16_bf16 v[64:79], v[40:43], v[204:207], v[64:79]
    ds_write_b128 v28, v[112:115] offset:0
    v_xor_b32 v28, 16, v28
    v_mul_f32 v124, v124, v88
    v_mul_f32 v125, v125, v88
    v_cvt_pk_bf16_f32 v118, v124, v125
    v_mul_f32 v126, v126, v88
    v_mul_f32 v127, v127, v88
    v_cvt_pk_bf16_f32 v119, v126, v127
    ds_read_b64_tr_b16 v[40:41], v107 offset:61824
    ds_read_b64_tr_b16 v[42:43], v107 offset:62336
    s_waitcnt lgkmcnt(7)
    v_mfma_f32_16x16x32_bf16 v[18:21], v[12:15], v[44:47], v[18:21]
    v_mfma_f32_32x32x16_bf16 v[64:79], v[44:47], v[208:211], v[64:79]
    ds_write_b128 v28, v[116:119] offset:0
    v_xor_b32 v28, 16, v28
    v_max3_f32 v31, v31, v56, v57
    v_max3_f32 v27, v27, v58, v59
    v_max3_f32 v31, v31, v60, v61
    v_max3_f32 v27, v27, v62, v63
    s_waitcnt vmcnt(7)
    s_waitcnt vmcnt(6)
    s_barrier
    ds_read_b64_tr_b16 v[44:45], v108 offset:0
    ds_read_b64_tr_b16 v[46:47], v108 offset:512
    s_waitcnt lgkmcnt(8)
    v_mfma_f32_32x32x16_bf16 v[64:79], v[32:35], v[212:215], v[64:79]
    v_max_f32 v31, v31, v27
    v_mul_f32 v31, v31, v24
    v_fma_f32 v48, v48, -v24, v31
    v_fma_f32 v49, v49, -v24, v31
    v_fma_f32 v50, v50, -v24, v31
    v_fma_f32 v51, v51, -v24, v31
    v_fma_f32 v52, v52, -v24, v31
    s_add_u32 s41, s36, 10
    s_and_b32 s41, s41, 7
    s_add_u32 m0, s40, 41216
    s_mul_i32 s43, s41, 176128
    buffer_load_dwordx4 v1, s[16:19], s43 offen lds
    ds_read_b64_tr_b16 v[32:33], v108 offset:8192
    ds_read_b64_tr_b16 v[34:35], v108 offset:8704
    s_waitcnt lgkmcnt(8)
    v_mfma_f32_32x32x16_bf16 v[64:79], v[36:39], v[216:219], v[64:79]
    v_exp_f32 v48, v48
    v_fma_f32 v53, v53, -v24, v31
    v_fma_f32 v54, v54, -v24, v31
    v_fma_f32 v55, v55, -v24, v31
    v_fma_f32 v56, v56, -v24, v31
    v_fma_f32 v57, v57, -v24, v31
    ds_read_b64_tr_b16 v[36:37], v109 offset:0
    ds_read_b64_tr_b16 v[38:39], v109 offset:512
    s_waitcnt lgkmcnt(7)
    v_mfma_f32_32x32x16_bf16 v[64:79], v[40:43], v[220:223], v[64:79]
    v_exp_f32 v49, v49
    v_fma_f32 v58, v58, -v24, v31
    v_fma_f32 v59, v59, -v24, v31
    v_fma_f32 v60, v60, -v24, v31
    v_fma_f32 v61, v61, -v24, v31
    v_fma_f32 v62, v62, -v24, v31
    buffer_load_dwordx4 v2, s[16:19], s43 offen offset:1024 lds
    ds_read_b64_tr_b16 v[40:41], v110 offset:0
    ds_read_b64_tr_b16 v[42:43], v110 offset:512
    s_waitcnt lgkmcnt(6)
    v_mfma_f32_16x16x32_bf16 v[18:21], v[12:15], v[44:47], v[18:21]
    v_mfma_f32_32x32x16_bf16 v[64:79], v[44:47], v[224:227], v[64:79]
    v_exp_f32 v50, v50
    v_fma_f32 v63, v63, -v24, v31
    v_add_f32 v27, v48, v49
    v_exp_f32 v51, v51
    v_add_f32 v27, v27, v50
    ds_read_b64_tr_b16 v[44:45], v111 offset:0
    ds_read_b64_tr_b16 v[46:47], v111 offset:512
    s_waitcnt lgkmcnt(6)
    v_mfma_f32_16x16x32_bf16 v[18:21], v[12:15], v[32:35], v[18:21]
    v_mfma_f32_32x32x16_bf16 v[64:79], v[32:35], v[240:243], v[64:79]
    v_exp_f32 v52, v52
    v_add_f32 v27, v27, v51
    v_exp_f32 v53, v53
    v_add_f32 v27, v27, v52
    v_add_f32 v27, v27, v53
    ds_read_b64_tr_b16 v[32:33], v109 offset:8192
    ds_read_b64_tr_b16 v[34:35], v109 offset:8704
    s_waitcnt lgkmcnt(6)
    v_mfma_f32_32x32x16_bf16 v[64:79], v[36:39], v[228:231], v[64:79]
    v_and_b32 v83, s55, v18
    v_sub_f32 v84, v18, v83
    v_cvt_pk_bf16_f32 v83, v83, v84
    v_exp_f32 v54, v54
    v_exp_f32 v55, v55
    s_mov_b32 exec_hi, 0
    buffer_load_dwordx4 v3, s[16:19], s43 offen offset:2048 lds
    s_mov_b32 exec_hi, -1
    ds_write_b32 v94, v83 offset:35456
    ds_read_b64_tr_b16 v[36:37], v110 offset:8192
    ds_read_b64_tr_b16 v[38:39], v110 offset:8704
    s_waitcnt lgkmcnt(7)
    v_mfma_f32_32x32x16_bf16 v[64:79], v[40:43], v[232:235], v[64:79]
    v_add_f32 v27, v27, v54
    v_exp_f32 v56, v56
    v_add_f32 v27, v27, v55
    v_exp_f32 v57, v57
    v_add_f32 v27, v27, v56
    ds_read_b64_tr_b16 v[40:41], v111 offset:8192
    ds_read_b64_tr_b16 v[42:43], v111 offset:8704
    s_waitcnt lgkmcnt(7)
    v_mfma_f32_32x32x16_bf16 v[64:79], v[44:47], v[236:239], v[64:79]
    v_exp_f32 v58, v58
    v_add_f32 v27, v27, v57
    v_exp_f32 v59, v59
    v_add_f32 v27, v27, v58
    s_waitcnt vmcnt(6)
    s_waitcnt lgkmcnt(4)
    s_barrier
    ds_read_b64_tr_b16 v[44:45], v4 offset:0
    ds_read_b64_tr_b16 v[46:47], v4 offset:640
    v_mfma_f32_32x32x16_bf16 v[64:79], v[32:35], v[244:247], v[64:79]
    v_exp_f32 v60, v60
    v_add_f32 v27, v27, v59
    v_exp_f32 v61, v61
    v_add_f32 v27, v27, v60
    v_add_f32 v27, v27, v61
    s_add_u32 s41, s36, 11
    s_and_b32 s41, s41, 7
    s_add_u32 m0, s40, 61824
    s_mul_i32 s43, s41, 176128
    buffer_load_dwordx4 v1, s[16:19], s43 offen lds
    ds_read_b128 v[32:35], v0 offset:35456
    s_waitcnt lgkmcnt(5)
    v_mfma_f32_32x32x16_bf16 v[64:79], v[36:39], v[248:251], v[64:79]
    v_exp_f32 v62, v62
    v_exp_f32 v63, v63
    v_add_f32 v27, v27, v62
    v_add_f32 v27, v27, v63
    ds_read_b64_tr_b16 v[36:37], v4 offset:32
    ds_read_b64_tr_b16 v[38:39], v4 offset:672
    s_waitcnt lgkmcnt(5)
    v_mfma_f32_32x32x16_bf16 v[64:79], v[40:43], v[252:255], v[64:79]
    v_rcp_f32 v27, v27
    s_nop 0
    v_mul_f32 v48, v48, v27
    v_mul_f32 v49, v49, v27
    v_cvt_pk_bf16_f32 v48, v48, v49
    v_mul_f32 v50, v50, v27
    ds_read_b64_tr_b16 v[40:41], v4 offset:64
    ds_read_b64_tr_b16 v[42:43], v4 offset:704
    s_waitcnt lgkmcnt(5)
    v_mfma_f32_16x16x32_bf16 v[16:19], v[12:15], v[44:47], 0
    v_mfma_f32_32x32x16_bf16 v[80:95], v[44:47], v[128:131], 0
    v_mul_f32 v51, v51, v27
    v_cvt_pk_bf16_f32 v49, v50, v51
    v_mul_f32 v52, v52, v27
    v_mul_f32 v53, v53, v27
    v_cvt_pk_bf16_f32 v50, v52, v53
    v_mul_f32 v54, v54, v27
    v_mul_f32 v55, v55, v27
    buffer_load_dwordx4 v2, s[16:19], s43 offen offset:1024 lds
    s_and_b32 s59, s37, 1
    s_lshl_b32 s59, s59, 5
    ds_read_b64_tr_b16 v[44:45], v5 offset:0
    ds_read_b64_tr_b16 v[46:47], v5 offset:640
    s_waitcnt lgkmcnt(6)
    v_mfma_f32_32x32x16_bf16 v[64:79], v[32:35], v[8:11], v[64:79]
    v_cvt_pk_bf16_f32 v51, v54, v55
    v_mul_f32 v56, v56, v27
    v_mul_f32 v57, v57, v27
    v_cvt_pk_bf16_f32 v52, v56, v57
    v_mul_f32 v58, v58, v27
    v_mul_f32 v59, v59, v27
    v_cvt_pk_bf16_f32 v53, v58, v59
    s_and_b32 s56, s2, 0x38
    s_cmp_eq_u32 s56, 56
    s_cselect_b32 s58, 0xa0, 0
    s_xor_b32 s58, s58, s2
    s_and_b32 s56, s2, 7
    s_lshr_b32 s57, s58, 6
    s_lshl2_add_u32 s56, s56, s57
    s_bfe_u32 s57, s58, 0x30003
    s_lshl_b32 s57, s57, 7
    s_lshl3_add_u32 s31, s56, s32
    s_lshl_b32 s31, s31, 7
    s_add_u32 s31, s31, 13631488
    s_lshl_b32 s0, s56, 16
    s_add_u32 s0, s0, s57
    s_lshl_b32 s58, s37, 13
    s_add_u32 s0, s0, s58
    ds_read_b64_tr_b16 v[32:33], v5 offset:32
    ds_read_b64_tr_b16 v[34:35], v5 offset:672
    s_waitcnt lgkmcnt(6)
    v_mfma_f32_16x16x32_bf16 v[18:21], v[12:15], v[36:39], 0
    v_mfma_f32_32x32x16_bf16 v[96:111], v[36:39], v[128:131], 0
    ds_write_b128 v28, v[48:51] offset:12288
    v_xor_b32 v28, 16, v28
    v_mul_f32 v60, v60, v27
    v_mul_f32 v61, v61, v27
    v_cvt_pk_bf16_f32 v54, v60, v61
    v_mul_f32 v62, v62, v27
    v_mul_f32 v63, v63, v27
    v_cvt_pk_bf16_f32 v55, v62, v63
    s_mul_i32 s29, s56, 241664
    s_mul_i32 s58, s32, 6144
    s_add_u32 s28, s29, s58
    s_add_u32 s28, s28, 32768
    s_mul_i32 s58, s32, 5
    s_min_u32 s58, s58, 33
    s_add_u32 s58, s58, 48
    s_lshl_b32 s22, s58, 14
    s_add_u32 s22, s22, s57
    s_lshl_b32 s58, s58, 10
    s_add_u32 s30, s29, s58
    s_add_u32 s30, s30, 32768
    s_lshl_b32 s58, s32, 12
    s_add_u32 s29, s29, s58
    ds_read_b64_tr_b16 v[36:37], v5 offset:64
    ds_read_b64_tr_b16 v[38:39], v5 offset:704
    s_waitcnt lgkmcnt(7)
    v_mfma_f32_16x16x32_bf16 v[20:23], v[12:15], v[40:43], 0
    v_mfma_f32_32x32x16_bf16 v[112:127], v[40:43], v[128:131], 0
    ds_write_b128 v28, v[52:55] offset:12288
    v_mov_b32 v60, 0
    v_mov_b32 v61, 0
    v_mov_b32 v62, 0
    v_mov_b32 v63, 0
    v_mul_f32 v64, v64, v26
    v_mul_f32 v65, v65, v26
    v_cvt_pk_bf16_f32 v64, v64, v65
    s_mul_i32 s20, s32, 98304
    s_add_u32 s20, s20, s57
    s_lshl_b32 s21, s32, 16
    s_add_u32 s21, s21, s57
    s_cmp_eq_u32 s32, 7
    s_cselect_b32 s23, 0x2000000, s22
    s_lshl_b32 s1, s37, 14
    s_sub_u32 s1, s1, 122880
    buffer_store_dwordx4 v[60:63], v0, s[24:27], s34 offen offset:0
    ds_read_b64_tr_b16 v[40:41], v6 offset:0
    ds_read_b64_tr_b16 v[42:43], v6 offset:640
    s_waitcnt lgkmcnt(8)
    v_mfma_f32_32x32x16_bf16 v[80:95], v[44:47], v[132:135], v[80:95]
    v_mul_f32 v66, v66, v26
    v_mul_f32 v67, v67, v26
    v_cvt_pk_bf16_f32 v65, v66, v67
    v_mul_f32 v68, v68, v26
    v_mul_f32 v69, v69, v26
    v_cvt_pk_bf16_f32 v66, v68, v69
    v_mul_f32 v70, v70, v26
    s_mov_b32 exec_hi, 0
    buffer_load_dwordx4 v3, s[16:19], s43 offen offset:2048 lds
    s_mov_b32 exec_hi, -1
    ds_read_b64_tr_b16 v[44:45], v6 offset:32
    ds_read_b64_tr_b16 v[46:47], v6 offset:672
    s_waitcnt lgkmcnt(8)
    v_mfma_f32_32x32x16_bf16 v[96:111], v[32:35], v[132:135], v[96:111]
    v_mul_f32 v71, v71, v26
    v_cvt_pk_bf16_f32 v67, v70, v71
    v_mul_f32 v72, v72, v26
    v_mul_f32 v73, v73, v26
    v_cvt_pk_bf16_f32 v68, v72, v73
    v_mul_f32 v74, v74, v26
    v_mul_f32 v75, v75, v26
    buffer_store_dwordx4 v[60:63], v0, s[24:27], s34 offen offset:1024
    ds_read_b64_tr_b16 v[32:33], v7 offset:0
    ds_read_b64_tr_b16 v[34:35], v7 offset:640
    s_waitcnt lgkmcnt(7)
    v_mfma_f32_32x32x16_bf16 v[112:127], v[36:39], v[132:135], v[112:127]
    ds_write_b128 v30, v[64:67] offset:64
    v_cvt_pk_bf16_f32 v69, v74, v75
    v_mul_f32 v76, v76, v26
    v_mul_f32 v77, v77, v26
    v_cvt_pk_bf16_f32 v70, v76, v77
    v_mul_f32 v78, v78, v26
    v_mul_f32 v79, v79, v26
    v_cvt_pk_bf16_f32 v71, v78, v79
    buffer_store_dwordx4 v[60:63], v0, s[24:27], s52 offen offset:2048
    ds_read_b64_tr_b16 v[36:37], v7 offset:32
    ds_read_b64_tr_b16 v[38:39], v7 offset:672
    s_waitcnt lgkmcnt(7)
    v_mfma_f32_32x32x16_bf16 v[80:95], v[40:43], v[136:139], v[80:95]
    s_waitcnt vmcnt(9)
    s_barrier
    ds_read_b64_tr_b16 v[40:41], v4 offset:20608
    ds_read_b64_tr_b16 v[42:43], v4 offset:21248
    s_waitcnt lgkmcnt(7)
    v_mfma_f32_32x32x16_bf16 v[96:111], v[44:47], v[136:139], v[96:111]
    ds_write_b128 v30, v[68:71] offset:12352
    v_mov_b32 v56, 0x3f803f80
    v_mov_b32 v57, 0x3f803f80
    v_mov_b32 v58, 0x3f803f80
    v_mov_b32 v59, 0x3f803f80
    v_lshrrev_b32 v60, 1, v0
    v_lshrrev_b32 v61, 5, v0
    v_subrev_u32 v28, s59, v29
    s_add_u32 s41, s36, 12
    s_and_b32 s41, s41, 7
    s_add_u32 m0, s40, 82432
    s_mul_i32 s43, s41, 176128
    buffer_load_dwordx4 v1, s[16:19], s43 offen lds
    ds_read_b64_tr_b16 v[44:45], v4 offset:20640
    ds_read_b64_tr_b16 v[46:47], v4 offset:21280
    s_waitcnt lgkmcnt(8)
    v_mfma_f32_32x32x16_bf16 v[80:95], v[32:35], v[140:143], v[80:95]
    s_waitcnt lgkmcnt(2)
    s_barrier
    ds_read_b64_tr_b16 v[32:33], v4 offset:20672
    ds_read_b64_tr_b16 v[34:35], v4 offset:21312
    v_mfma_f32_32x32x16_bf16 v[96:111], v[36:39], v[140:143], v[96:111]
    v_bfe_u32 v62, v0, 4, 6
    v_and_b32 v63, 7, v62
    v_lshlrev_b32 v63, 4, v63
    v_and_b32 v26, 16, v62
    v_lshlrev_b32 v26, 1, v26
    v_xor_b32 v63, v63, v26
    v_lshrrev_b32 v26, 3, v62
    ds_read_b64_tr_b16 v[64:65], v29 offset:0
    ds_read_b64_tr_b16 v[66:67], v29 offset:768
    ds_read_b64_tr_b16 v[68:69], v28 offset:64
    ds_read_b64_tr_b16 v[70:71], v28 offset:832
    ds_read_b64_tr_b16 v[36:37], v5 offset:20608
    ds_read_b64_tr_b16 v[38:39], v5 offset:21248
    v_mfma_f32_16x16x32_bf16 v[16:19], v[12:15], v[40:43], v[16:19]
    v_mfma_f32_32x32x16_bf16 v[80:95], v[40:43], v[144:147], v[80:95]
    v_lshl_add_u32 v27, v26, 10, v63
    v_and_b32 v63, 16, v62
    v_and_b32 v26, 1, v62
    v_lshl_add_u32 v63, v26, 3, v63
    v_and_b32 v26, 14, v62
    s_add_u32 m0, s40, 82432
    s_nop 0
    buffer_load_dwordx4 v2, s[16:19], s43 offen offset:1024 lds
    ds_read_b64_tr_b16 v[72:73], v29 offset:3072
    ds_read_b64_tr_b16 v[74:75], v29 offset:3840
    ds_read_b64_tr_b16 v[76:77], v28 offset:3136
    ds_read_b64_tr_b16 v[78:79], v28 offset:3904
    ds_read_b64_tr_b16 v[40:41], v5 offset:20640
    ds_read_b64_tr_b16 v[42:43], v5 offset:21280
    s_waitcnt lgkmcnt(10)
    v_mfma_f32_16x16x32_bf16 v[18:21], v[12:15], v[44:47], v[18:21]
    v_mfma_f32_16x16x32_bf16 v[52:55], v[64:67], v[56:59], 0
    v_mfma_f32_32x32x16_bf16 v[96:111], v[44:47], v[144:147], v[96:111]
    v_lshl_add_u32 v63, v26, 5, v63
    v_and_b32 v26, 8, v62
    v_lshl_add_u32 v63, v26, 2, v63
    v_lshrrev_b32 v26, 5, v62
    v_lshl_add_u32 v63, v26, 10, v63
    ds_read_b64_tr_b16 v[128:129], v29 offset:6144
    ds_read_b64_tr_b16 v[130:131], v29 offset:6912
    ds_read_b64_tr_b16 v[132:133], v28 offset:6208
    ds_read_b64_tr_b16 v[134:135], v28 offset:6976
    ds_read_b64_tr_b16 v[44:45], v5 offset:20672
    ds_read_b64_tr_b16 v[46:47], v5 offset:21312
    s_waitcnt lgkmcnt(14)
    v_mfma_f32_16x16x32_bf16 v[20:23], v[12:15], v[32:35], v[20:23]
    v_mfma_f32_16x16x32_bf16 v[48:51], v[64:67], v[68:71], 0
    v_mfma_f32_32x32x16_bf16 v[112:127], v[32:35], v[144:147], v[112:127]
    v_lshl_add_u32 v63, s39, 1, v63
    v_xor_b32 v26, 32, v63
    v_add_u32 v31, 103040, v63
    v_add_u32 v26, 103040, v26
    ds_read_b64_tr_b16 v[136:137], v29 offset:9216
    ds_read_b64_tr_b16 v[138:139], v29 offset:9984
    ds_read_b64_tr_b16 v[140:141], v28 offset:9280
    ds_read_b64_tr_b16 v[142:143], v28 offset:10048
    ds_read_b64_tr_b16 v[32:33], v6 offset:20608
    ds_read_b64_tr_b16 v[34:35], v6 offset:21248
    s_waitcnt lgkmcnt(15)
    v_mfma_f32_16x16x32_bf16 v[52:55], v[72:75], v[56:59], v[52:55]
    v_mfma_f32_32x32x16_bf16 v[80:95], v[36:39], v[148:151], v[80:95]
    v_lshrrev_b32 v28, 2, v0
    v_and_b32 v28, 28, v28
    v_lshlrev_b32 v29, 3, v28
    s_add_u32 m0, s40, 82432
    s_mov_b32 exec_hi, 0
    buffer_load_dwordx4 v3, s[16:19], s43 offen offset:2048 lds
    s_mov_b32 exec_hi, -1
    ds_read_b64_tr_b16 v[36:37], v6 offset:20640
    ds_read_b64_tr_b16 v[38:39], v6 offset:21280
    s_waitcnt lgkmcnt(14)
    v_mfma_f32_16x16x32_bf16 v[48:51], v[72:75], v[76:79], v[48:51]
    v_mfma_f32_32x32x16_bf16 v[96:111], v[40:43], v[148:151], v[96:111]
    ds_read_b64_tr_b16 v[40:41], v7 offset:20608
    ds_read_b64_tr_b16 v[42:43], v7 offset:21248
    s_waitcnt lgkmcnt(10)
    v_mfma_f32_16x16x32_bf16 v[52:55], v[128:131], v[56:59], v[52:55]
    v_mfma_f32_32x32x16_bf16 v[112:127], v[44:47], v[148:151], v[112:127]
    ds_read_b64_tr_b16 v[44:45], v7 offset:20640
    ds_read_b64_tr_b16 v[46:47], v7 offset:21280
    s_waitcnt lgkmcnt(6)
    v_mfma_f32_16x16x32_bf16 v[48:51], v[128:131], v[132:135], v[48:51]
    v_mfma_f32_32x32x16_bf16 v[80:95], v[32:35], v[152:155], v[80:95]
    s_waitcnt vmcnt(9)
    s_barrier
    ds_read_b64_tr_b16 v[32:33], v4 offset:41216
    ds_read_b64_tr_b16 v[34:35], v4 offset:41856
    s_waitcnt lgkmcnt(6)
    v_mfma_f32_16x16x32_bf16 v[48:51], v[136:139], v[140:143], v[48:51]
    v_mfma_f32_32x32x16_bf16 v[96:111], v[36:39], v[152:155], v[96:111]
    s_add_u32 s41, s36, 13
    s_and_b32 s41, s41, 7
    s_add_u32 m0, s40, 0
    s_mul_i32 s43, s41, 176128
    buffer_load_dwordx4 v1, s[16:19], s43 offen lds
    ds_read_b64_tr_b16 v[36:37], v4 offset:41248
    ds_read_b64_tr_b16 v[38:39], v4 offset:41888
    s_waitcnt lgkmcnt(6)
    v_mfma_f32_16x16x32_bf16 v[52:55], v[136:139], v[56:59], v[52:55]
    v_mfma_f32_32x32x16_bf16 v[80:95], v[40:43], v[156:159], v[80:95]
    v_cvt_pk_bf16_f32 v48, v48, v49
    v_cvt_pk_bf16_f32 v49, v50, v51
    buffer_store_dwordx2 v[48:49], v60, s[24:27], s53 offen sc1
    ds_read_b64_tr_b16 v[40:41], v4 offset:41280
    ds_read_b64_tr_b16 v[42:43], v4 offset:41920
    s_waitcnt lgkmcnt(6)
    v_mfma_f32_32x32x16_bf16 v[96:111], v[44:47], v[156:159], v[96:111]
    v_add_u32 v4, 61824, v4
    v_cvt_pk_bf16_f32 v52, v52, v53
    v_cvt_pk_bf16_f32 v53, v54, v55
    v_add_u32 v49, s35, v0
    s_mov_b32 exec_lo, 0x10001
    s_mov_b32 exec_hi, 0x10001
    buffer_store_dwordx2 v[52:53], v61, s[24:27], s54 offen sc1
    s_mov_b64 exec, -1
    ds_read_b64_tr_b16 v[44:45], v5 offset:41216
    ds_read_b64_tr_b16 v[46:47], v5 offset:41856
    s_waitcnt lgkmcnt(6)
    v_mfma_f32_16x16x32_bf16 v[16:19], v[12:15], v[32:35], v[16:19]
    v_mfma_f32_32x32x16_bf16 v[80:95], v[32:35], v[160:163], v[80:95]
    s_add_u32 m0, s40, 0
    s_nop 0
    buffer_load_dwordx4 v2, s[16:19], s43 offen offset:1024 lds
    ds_read_b64_tr_b16 v[32:33], v5 offset:41248
    ds_read_b64_tr_b16 v[34:35], v5 offset:41888
    s_waitcnt lgkmcnt(6)
    v_mfma_f32_16x16x32_bf16 v[18:21], v[12:15], v[36:39], v[18:21]
    v_mfma_f32_32x32x16_bf16 v[96:111], v[36:39], v[160:163], v[96:111]
    s_lshl1_add_u32 m0, s39, 103040
    s_add_u32 s42, s20, 0
    buffer_load_dwordx4 v27, s[48:51], s42 offen lds
    ds_read_b64_tr_b16 v[36:37], v5 offset:41280
    ds_read_b64_tr_b16 v[38:39], v5 offset:41920
    s_waitcnt lgkmcnt(6)
    v_mfma_f32_16x16x32_bf16 v[20:23], v[12:15], v[40:43], v[20:23]
    v_mfma_f32_32x32x16_bf16 v[112:127], v[40:43], v[160:163], v[112:127]
    v_add_u32 v5, 61824, v5
    s_lshl1_add_u32 m0, s39, 103040
    s_add_u32 s42, s20, 7168
    buffer_load_dwordx4 v27, s[48:51], s42 offen offset:1024 lds
    ds_read_b64_tr_b16 v[40:41], v6 offset:41216
    ds_read_b64_tr_b16 v[42:43], v6 offset:41856
    s_waitcnt lgkmcnt(6)
    v_mfma_f32_32x32x16_bf16 v[80:95], v[44:47], v[164:167], v[80:95]
    s_add_u32 m0, s40, 0
    s_mov_b32 exec_hi, 0
    buffer_load_dwordx4 v3, s[16:19], s43 offen offset:2048 lds
    s_mov_b32 exec_hi, -1
    ds_read_b64_tr_b16 v[44:45], v6 offset:41248
    ds_read_b64_tr_b16 v[46:47], v6 offset:41888
    s_waitcnt lgkmcnt(6)
    v_mfma_f32_32x32x16_bf16 v[96:111], v[32:35], v[164:167], v[96:111]
    v_add_u32 v6, 61824, v6
    s_lshl1_add_u32 m0, s39, 119424
    s_add_u32 s42, s20, 49152
    buffer_load_dwordx4 v27, s[48:51], s42 offen lds
    ds_read_b64_tr_b16 v[32:33], v7 offset:41216
    ds_read_b64_tr_b16 v[34:35], v7 offset:41856
    s_waitcnt lgkmcnt(6)
    v_mfma_f32_32x32x16_bf16 v[112:127], v[36:39], v[164:167], v[112:127]
    s_lshl1_add_u32 m0, s39, 119424
    s_add_u32 s42, s20, 56320
    buffer_load_dwordx4 v27, s[48:51], s42 offen offset:1024 lds
    ds_read_b64_tr_b16 v[36:37], v7 offset:41248
    ds_read_b64_tr_b16 v[38:39], v7 offset:41888
    s_waitcnt lgkmcnt(6)
    v_mfma_f32_32x32x16_bf16 v[80:95], v[40:43], v[168:171], v[80:95]
    s_lshl1_add_u32 m0, s39, 135808
    s_add_u32 s42, s20, 16384
    buffer_load_dwordx4 v27, s[48:51], s42 offen lds
    s_waitcnt vmcnt(15)
    s_barrier
    ds_read_b64_tr_b16 v[40:41], v4 offset:0
    ds_read_b64_tr_b16 v[42:43], v4 offset:640
    s_waitcnt lgkmcnt(6)
    v_mfma_f32_32x32x16_bf16 v[96:111], v[44:47], v[168:171], v[96:111]
    v_add_u32 v7, 61824, v7
    s_add_u32 s41, s36, 14
    s_and_b32 s41, s41, 7
    s_add_u32 m0, s40, 20608
    s_mul_i32 s43, s41, 176128
    buffer_load_dwordx4 v1, s[16:19], s43 offen lds
    ds_read_b64_tr_b16 v[44:45], v4 offset:32
    ds_read_b64_tr_b16 v[46:47], v4 offset:672
    s_waitcnt lgkmcnt(6)
    v_mfma_f32_32x32x16_bf16 v[80:95], v[32:35], v[172:175], v[80:95]
    s_lshl1_add_u32 m0, s39, 135808
    s_add_u32 s42, s20, 23552
    buffer_load_dwordx4 v27, s[48:51], s42 offen offset:1024 lds
    ds_read_b64_tr_b16 v[32:33], v4 offset:64
    ds_read_b64_tr_b16 v[34:35], v4 offset:704
    s_waitcnt lgkmcnt(6)
    v_mfma_f32_32x32x16_bf16 v[96:111], v[36:39], v[172:175], v[96:111]
    ds_read_b64_tr_b16 v[36:37], v5 offset:0
    ds_read_b64_tr_b16 v[38:39], v5 offset:640
    s_waitcnt lgkmcnt(6)
    v_mfma_f32_16x16x32_bf16 v[16:19], v[12:15], v[40:43], v[16:19]
    v_mfma_f32_32x32x16_bf16 v[80:95], v[40:43], v[176:179], v[80:95]
    s_add_u32 m0, s40, 20608
    s_nop 0
    buffer_load_dwordx4 v2, s[16:19], s43 offen offset:1024 lds
    ds_read_b64_tr_b16 v[40:41], v5 offset:32
    ds_read_b64_tr_b16 v[42:43], v5 offset:672
    s_waitcnt lgkmcnt(6)
    v_mfma_f32_16x16x32_bf16 v[18:21], v[12:15], v[44:47], v[18:21]
    v_mfma_f32_32x32x16_bf16 v[96:111], v[44:47], v[176:179], v[96:111]
    ds_read_b64_tr_b16 v[44:45], v5 offset:64
    ds_read_b64_tr_b16 v[46:47], v5 offset:704
    s_waitcnt lgkmcnt(6)
    s_nop 1
    v_mfma_f32_16x16x32_bf16 v[20:23], v[12:15], v[32:35], v[20:23]
    v_mfma_f32_32x32x16_bf16 v[112:127], v[32:35], v[176:179], v[112:127]
    s_waitcnt vmcnt(7)
    ds_read_b64_tr_b16 v[128:129], v31 offset:0
    ds_read_b64_tr_b16 v[130:131], v31 offset:512
    ds_read_b64_tr_b16 v[132:133], v26 offset:0
    ds_read_b64_tr_b16 v[134:135], v26 offset:512
    ds_read_b64_tr_b16 v[32:33], v6 offset:0
    ds_read_b64_tr_b16 v[34:35], v6 offset:640
    s_waitcnt lgkmcnt(10)
    v_mfma_f32_32x32x16_bf16 v[80:95], v[36:39], v[180:183], v[80:95]
    s_add_u32 m0, s40, 20608
    s_mov_b32 exec_hi, 0
    buffer_load_dwordx4 v3, s[16:19], s43 offen offset:2048 lds
    s_mov_b32 exec_hi, -1
    ds_read_b64_tr_b16 v[36:37], v6 offset:32
    ds_read_b64_tr_b16 v[38:39], v6 offset:672
    s_waitcnt lgkmcnt(10)
    v_mfma_f32_32x32x16_bf16 v[96:111], v[40:43], v[180:183], v[96:111]
    s_waitcnt lgkmcnt(4)
    s_lshl1_add_u32 m0, s39, 103040
    s_add_u32 s42, s20, 65536
    buffer_load_dwordx4 v27, s[48:51], s42 offen lds
    ds_read_b64_tr_b16 v[40:41], v7 offset:0
    ds_read_b64_tr_b16 v[42:43], v7 offset:640
    v_mfma_f32_32x32x16_bf16 v[112:127], v[44:47], v[180:183], v[112:127]
    s_waitcnt vmcnt(6)
    ds_read_b64_tr_b16 v[136:137], v31 offset:16384
    ds_read_b64_tr_b16 v[138:139], v31 offset:16896
    ds_read_b64_tr_b16 v[140:141], v26 offset:16384
    ds_read_b64_tr_b16 v[142:143], v26 offset:16896
    s_lshl1_add_u32 m0, s39, 103040
    s_add_u32 s42, s20, 72704
    buffer_load_dwordx4 v27, s[48:51], s42 offen offset:1024 lds
    ds_read_b64_tr_b16 v[44:45], v7 offset:32
    ds_read_b64_tr_b16 v[46:47], v7 offset:672
    s_waitcnt lgkmcnt(10)
    v_mfma_f32_32x32x16_bf16 v[80:95], v[32:35], v[184:187], v[80:95]
    s_barrier
    ds_read_b64_tr_b16 v[32:33], v4 offset:20608
    ds_read_b64_tr_b16 v[34:35], v4 offset:21248
    s_waitcnt lgkmcnt(10)
    v_mfma_f32_32x32x16_bf16 v[96:111], v[36:39], v[184:187], v[96:111]
    s_add_u32 s41, s36, 15
    s_and_b32 s41, s41, 7
    s_add_u32 m0, s40, 41216
    s_mul_i32 s43, s41, 176128
    buffer_load_dwordx4 v1, s[16:19], s43 offen lds
    ds_read_b64_tr_b16 v[36:37], v4 offset:20640
    ds_read_b64_tr_b16 v[38:39], v4 offset:21280
    s_waitcnt lgkmcnt(10)
    v_mfma_f32_32x32x16_bf16 v[80:95], v[40:43], v[188:191], v[80:95]
    s_waitcnt vmcnt(5)
    ds_read_b64_tr_b16 v[144:145], v31 offset:32768
    ds_read_b64_tr_b16 v[146:147], v31 offset:33280
    ds_read_b64_tr_b16 v[148:149], v26 offset:32768
    ds_read_b64_tr_b16 v[150:151], v26 offset:33280
    s_waitcnt lgkmcnt(10)
    s_lshl1_add_u32 m0, s39, 119424
    s_add_u32 s42, s20, 32768
    buffer_load_dwordx4 v27, s[48:51], s42 offen lds
    ds_read_b64_tr_b16 v[40:41], v4 offset:20672
    ds_read_b64_tr_b16 v[42:43], v4 offset:21312
    s_waitcnt lgkmcnt(10)
    v_mfma_f32_32x32x16_bf16 v[96:111], v[44:47], v[188:191], v[96:111]
    v_subrev_u32 v4, 61824, v4
    s_lshl1_add_u32 m0, s39, 119424
    s_add_u32 s42, s20, 39936
    buffer_load_dwordx4 v27, s[48:51], s42 offen offset:1024 lds
    ds_read_b64_tr_b16 v[44:45], v5 offset:20608
    ds_read_b64_tr_b16 v[46:47], v5 offset:21248
    s_waitcnt lgkmcnt(10)
    v_mfma_f32_16x16x32_bf16 v[16:19], v[12:15], v[32:35], v[16:19]
    v_mfma_f32_32x32x16_bf16 v[80:95], v[32:35], v[192:195], v[80:95]
    v_lshrrev_b32 v48, 6, v0
    v_and_b32 v48, 12, v48
    v_xor_b32 v48, s3, v48
    v_or_b32 v48, v48, v0
    s_add_u32 m0, s40, 41216
    s_nop 0
    buffer_load_dwordx4 v2, s[16:19], s43 offen offset:1024 lds
    ds_read_b64_tr_b16 v[32:33], v5 offset:20640
    ds_read_b64_tr_b16 v[34:35], v5 offset:21280
    s_waitcnt lgkmcnt(10)
    v_mfma_f32_16x16x32_bf16 v[18:21], v[12:15], v[36:39], v[18:21]
    v_mfma_f32_32x32x16_bf16 v[96:111], v[36:39], v[192:195], v[96:111]
    s_waitcnt lgkmcnt(6)
    s_lshl1_add_u32 m0, s39, 135808
    s_add_u32 s42, s20, 81920
    buffer_load_dwordx4 v27, s[48:51], s42 offen lds
    ds_read_b64_tr_b16 v[36:37], v5 offset:20672
    ds_read_b64_tr_b16 v[38:39], v5 offset:21312
    s_waitcnt lgkmcnt(6)
    v_mfma_f32_16x16x32_bf16 v[20:23], v[12:15], v[40:43], v[20:23]
    v_mfma_f32_32x32x16_bf16 v[112:127], v[40:43], v[192:195], v[112:127]
    v_subrev_u32 v5, 61824, v5
    s_lshl1_add_u32 m0, s39, 135808
    s_add_u32 s42, s20, 89088
    buffer_load_dwordx4 v27, s[48:51], s42 offen offset:1024 lds
    ds_read_b64_tr_b16 v[40:41], v6 offset:20608
    ds_read_b64_tr_b16 v[42:43], v6 offset:21248
    s_waitcnt lgkmcnt(6)
    v_mfma_f32_32x32x16_bf16 v[80:95], v[44:47], v[196:199], v[80:95]
    s_add_u32 m0, s40, 41216
    s_mov_b32 exec_hi, 0
    buffer_load_dwordx4 v3, s[16:19], s43 offen offset:2048 lds
    s_mov_b32 exec_hi, -1
    ds_read_b64_tr_b16 v[44:45], v6 offset:20640
    ds_read_b64_tr_b16 v[46:47], v6 offset:21280
    s_waitcnt lgkmcnt(6)
    v_mfma_f32_32x32x16_bf16 v[96:111], v[32:35], v[196:199], v[96:111]
    v_subrev_u32 v6, 61824, v6
    ds_read_b64_tr_b16 v[32:33], v7 offset:20608
    ds_read_b64_tr_b16 v[34:35], v7 offset:21248
    s_waitcnt lgkmcnt(6)
    v_mfma_f32_32x32x16_bf16 v[112:127], v[36:39], v[196:199], v[112:127]
    s_waitcnt vmcnt(7)
    ds_read_b64_tr_b16 v[152:153], v31 offset:0
    ds_read_b64_tr_b16 v[154:155], v31 offset:512
    ds_read_b64_tr_b16 v[156:157], v26 offset:0
    ds_read_b64_tr_b16 v[158:159], v26 offset:512
    ds_read_b64_tr_b16 v[36:37], v7 offset:20640
    ds_read_b64_tr_b16 v[38:39], v7 offset:21280
    s_waitcnt lgkmcnt(10)
    v_mfma_f32_32x32x16_bf16 v[80:95], v[40:43], v[200:203], v[80:95]
    buffer_load_dword v30, v29, s[4:7], 0 offen
    s_barrier
    ds_read_b64_tr_b16 v[40:41], v4 offset:0
    ds_read_b64_tr_b16 v[42:43], v4 offset:640
    s_waitcnt lgkmcnt(10)
    v_mfma_f32_32x32x16_bf16 v[96:111], v[44:47], v[200:203], v[96:111]
    v_subrev_u32 v7, 61824, v7
    s_waitcnt lgkmcnt(4)
    s_lshl1_add_u32 m0, s39, 103040
    s_add_u32 s42, s21, 0
    buffer_load_dwordx4 v27, s[44:47], s42 offen lds
    s_cmp_eq_u32 s23, 0x2000000
    s_cselect_b32 s36, 2.0, s30
    ds_read_b64_tr_b16 v[44:45], v4 offset:32
    ds_read_b64_tr_b16 v[46:47], v4 offset:672
    v_mfma_f32_32x32x16_bf16 v[80:95], v[32:35], v[204:207], v[80:95]
    s_lshl1_add_u32 m0, s39, 103040
    s_add_u32 s42, s21, 7168
    buffer_load_dwordx4 v27, s[44:47], s42 offen offset:1024 lds
    ds_read_b64_tr_b16 v[32:33], v4 offset:64
    ds_read_b64_tr_b16 v[34:35], v4 offset:704
    s_waitcnt lgkmcnt(6)
    v_mfma_f32_32x32x16_bf16 v[96:111], v[36:39], v[204:207], v[96:111]
    s_waitcnt vmcnt(7)
    ds_read_b64_tr_b16 v[160:161], v31 offset:16384
    ds_read_b64_tr_b16 v[162:163], v31 offset:16896
    ds_read_b64_tr_b16 v[164:165], v26 offset:16384
    ds_read_b64_tr_b16 v[166:167], v26 offset:16896
    ds_read_b64_tr_b16 v[36:37], v5 offset:64
    ds_read_b64_tr_b16 v[38:39], v5 offset:704
    s_waitcnt lgkmcnt(10)
    v_mfma_f32_16x16x32_bf16 v[16:19], v[12:15], v[40:43], v[16:19]
    v_mfma_f32_32x32x16_bf16 v[80:95], v[40:43], v[208:211], v[80:95]
    ds_read_b64_tr_b16 v[40:41], v5 offset:0
    ds_read_b64_tr_b16 v[42:43], v5 offset:640
    s_waitcnt lgkmcnt(10)
    s_nop 1
    v_mfma_f32_16x16x32_bf16 v[18:21], v[12:15], v[44:47], v[18:21]
    v_mfma_f32_32x32x16_bf16 v[96:111], v[44:47], v[208:211], v[96:111]
    s_waitcnt lgkmcnt(4)
    s_lshl1_add_u32 m0, s39, 119424
    s_add_u32 s42, s21, 16384
    buffer_load_dwordx4 v27, s[44:47], s42 offen lds
    ds_read_b64_tr_b16 v[44:45], v6 offset:0
    ds_read_b64_tr_b16 v[46:47], v6 offset:640
    v_mfma_f32_16x16x32_bf16 v[20:23], v[12:15], v[32:35], v[20:23]
    v_mfma_f32_32x32x16_bf16 v[112:127], v[32:35], v[208:211], v[112:127]
    s_waitcnt vmcnt(5)
    ds_read_b64_tr_b16 v[168:169], v31 offset:32768
    ds_read_b64_tr_b16 v[170:171], v31 offset:33280
    ds_read_b64_tr_b16 v[172:173], v26 offset:32768
    ds_read_b64_tr_b16 v[174:175], v26 offset:33280
    s_lshl1_add_u32 m0, s39, 119424
    s_add_u32 s42, s21, 23552
    buffer_load_dwordx4 v27, s[44:47], s42 offen offset:1024 lds
    ds_read_b64_tr_b16 v[32:33], v7 offset:0
    ds_read_b64_tr_b16 v[34:35], v7 offset:640
    s_waitcnt lgkmcnt(10)
    v_mfma_f32_32x32x16_bf16 v[112:127], v[36:39], v[212:215], v[112:127]
    s_waitcnt vmcnt(5)
    s_barrier
    ds_read_b64_tr_b16 v[36:37], v4 offset:20608
    ds_read_b64_tr_b16 v[38:39], v4 offset:21248
    s_waitcnt lgkmcnt(10)
    v_mfma_f32_32x32x16_bf16 v[80:95], v[40:43], v[212:215], v[80:95]
    s_waitcnt lgkmcnt(4)
    s_lshl1_add_u32 m0, s39, 135808
    s_add_u32 s42, s21, 32768
    buffer_load_dwordx4 v27, s[44:47], s42 offen lds
    s_and_b32 s101, s2, 7
    s_waitcnt vmcnt(5)
    v_readlane_b32 s101, v30, s101
    v_and_b32 v30, 0xff, v30
    v_cmp_gt_u32 vcc, 32, v30
    s_lshl_b32 s57, s100, 5
    s_sub_u32 s101, s101, s57
    s_cbranch_vccnz L_parallel_sum__linear_kernel_hedgehog__glu_gated_glu__prompt_kernel_00_cp
L_parallel_sum__linear_kernel_hedgehog__glu_gated_glu__prompt_kernel_00_cb:
    ds_read_b64_tr_b16 v[40:41], v4 offset:20640
    ds_read_b64_tr_b16 v[42:43], v4 offset:21280
    v_mfma_f32_32x32x16_bf16 v[80:95], v[44:47], v[216:219], v[80:95]
    s_lshl1_add_u32 m0, s39, 135808
    s_add_u32 s42, s21, 39936
    buffer_load_dwordx4 v27, s[44:47], s42 offen offset:1024 lds
    ds_read_b64_tr_b16 v[44:45], v4 offset:20672
    ds_read_b64_tr_b16 v[46:47], v4 offset:21312
    s_waitcnt lgkmcnt(6)
    v_mfma_f32_32x32x16_bf16 v[80:95], v[32:35], v[220:223], v[80:95]
    ds_read_b64_tr_b16 v[32:33], v5 offset:20672
    ds_read_b64_tr_b16 v[34:35], v5 offset:21312
    s_waitcnt lgkmcnt(6)
    v_mfma_f32_16x16x32_bf16 v[16:19], v[12:15], v[36:39], v[16:19]
    v_mfma_f32_32x32x16_bf16 v[80:95], v[36:39], v[224:227], v[80:95]
    ds_read_b64_tr_b16 v[36:37], v4 offset:41280
    ds_read_b64_tr_b16 v[38:39], v4 offset:41920
    s_waitcnt lgkmcnt(6)
    s_nop 1
    v_mfma_f32_16x16x32_bf16 v[18:21], v[12:15], v[40:43], v[18:21]
    v_mfma_f32_32x32x16_bf16 v[96:111], v[40:43], v[224:227], v[96:111]
    s_waitcnt vmcnt(4)
    ds_read_b64_tr_b16 v[176:177], v31 offset:0
    ds_read_b64_tr_b16 v[178:179], v31 offset:512
    ds_read_b64_tr_b16 v[180:181], v26 offset:0
    ds_read_b64_tr_b16 v[182:183], v26 offset:512
    ds_read_b64_tr_b16 v[40:41], v5 offset:41280
    ds_read_b64_tr_b16 v[42:43], v5 offset:41920
    s_waitcnt lgkmcnt(10)
    v_mfma_f32_16x16x32_bf16 v[20:23], v[12:15], v[44:47], v[20:23]
    v_mfma_f32_32x32x16_bf16 v[112:127], v[44:47], v[224:227], v[112:127]
    ds_read_b64_tr_b16 v[44:45], v4 offset:41216
    ds_read_b64_tr_b16 v[46:47], v4 offset:41856
    s_waitcnt lgkmcnt(10)
    v_mfma_f32_32x32x16_bf16 v[112:127], v[32:35], v[228:231], v[112:127]
    s_waitcnt lgkmcnt(4)
    s_lshl1_add_u32 m0, s39, 103040
    s_add_u32 s42, s21, 49152
    buffer_load_dwordx4 v27, s[44:47], s42 offen lds
    ds_read_b64_tr_b16 v[32:33], v4 offset:41248
    ds_read_b64_tr_b16 v[34:35], v4 offset:41888
    v_mfma_f32_16x16x32_bf16 v[20:23], v[12:15], v[36:39], v[20:23]
    v_mfma_f32_32x32x16_bf16 v[112:127], v[36:39], v[240:243], v[112:127]
    s_lshl1_add_u32 m0, s39, 103040
    s_add_u32 s42, s21, 56320
    buffer_load_dwordx4 v27, s[44:47], s42 offen offset:1024 lds
    ds_read_b64_tr_b16 v[36:37], v5 offset:20608
    ds_read_b64_tr_b16 v[38:39], v5 offset:21248
    s_waitcnt lgkmcnt(6)
    v_mfma_f32_32x32x16_bf16 v[112:127], v[40:43], v[244:247], v[112:127]
    s_waitcnt vmcnt(4)
    ds_read_b64_tr_b16 v[184:185], v31 offset:16384
    ds_read_b64_tr_b16 v[186:187], v31 offset:16896
    ds_read_b64_tr_b16 v[188:189], v26 offset:16384
    ds_read_b64_tr_b16 v[190:191], v26 offset:16896
    ds_read_b64_tr_b16 v[40:41], v6 offset:20608
    ds_read_b64_tr_b16 v[42:43], v6 offset:21248
    s_waitcnt lgkmcnt(10)
    v_mfma_f32_16x16x32_bf16 v[16:19], v[12:15], v[44:47], v[16:19]
    v_mfma_f32_32x32x16_bf16 v[80:95], v[44:47], v[240:243], v[80:95]
    ds_read_b64_tr_b16 v[44:45], v7 offset:20608
    ds_read_b64_tr_b16 v[46:47], v7 offset:21248
    s_waitcnt lgkmcnt(10)
    s_nop 1
    v_mfma_f32_16x16x32_bf16 v[18:21], v[12:15], v[32:35], v[18:21]
    v_mfma_f32_32x32x16_bf16 v[96:111], v[32:35], v[240:243], v[96:111]
    ds_write_b128 v49, v[116:119] offset:0
    v_and_b32 v50, s55, v16
    v_sub_f32 v51, v16, v50
    v_cvt_pk_bf16_f32 v50, v50, v51
    ds_write_b32 v48, v50 offset:33408
    s_waitcnt lgkmcnt(6)
    s_lshl1_add_u32 m0, s39, 119424
    s_add_u32 s42, s22, 32768
    buffer_load_dwordx4 v27, s[48:51], s42 offen lds
    ds_read_b64_tr_b16 v[32:33], v5 offset:41216
    ds_read_b64_tr_b16 v[34:35], v5 offset:41856
    v_mfma_f32_32x32x16_bf16 v[80:95], v[36:39], v[228:231], v[80:95]
    ds_write_b128 v49, v[124:127] offset:1024
    v_and_b32 v52, s55, v18
    v_sub_f32 v53, v18, v52
    v_cvt_pk_bf16_f32 v52, v52, v53
    v_and_b32 v54, s55, v20
    v_sub_f32 v55, v20, v54
    v_cvt_pk_bf16_f32 v54, v54, v55
    ds_write_b32 v48, v52 offset:34432
    ds_write_b32 v48, v54 offset:35456
    s_waitcnt vmcnt(3)
    ds_read_b64_tr_b16 v[64:65], v31 offset:32768
    ds_read_b64_tr_b16 v[66:67], v31 offset:33280
    s_lshl1_add_u32 m0, s39, 119424
    s_add_u32 s42, s22, 39936
    buffer_load_dwordx4 v27, s[48:51], s42 offen offset:1024 lds
    ds_read_b64_tr_b16 v[36:37], v6 offset:41216
    ds_read_b64_tr_b16 v[38:39], v6 offset:41856
    s_waitcnt lgkmcnt(13)
    v_mfma_f32_32x32x16_bf16 v[80:95], v[40:43], v[232:235], v[80:95]
    ds_read_b64_tr_b16 v[68:69], v26 offset:32768
    ds_read_b64_tr_b16 v[70:71], v26 offset:33280
    s_waitcnt lgkmcnt(6)
    s_barrier
    ds_read_b128 v[40:43], v0 offset:35456
    v_mfma_f32_32x32x16_bf16 v[80:95], v[44:47], v[236:239], v[80:95]
    ds_read_b128 v[56:59], v49 offset:8192
    ds_read_b128 v[60:63], v49 offset:9216
    ds_read_b64_tr_b16 v[44:45], v7 offset:41216
    ds_read_b64_tr_b16 v[46:47], v7 offset:41856
    v_mfma_f32_32x32x16_bf16 v[80:95], v[32:35], v[244:247], v[80:95]
    s_waitcnt lgkmcnt(5)
    s_lshl1_add_u32 m0, s39, 135808
    s_add_u32 s42, s23, 0
    buffer_load_dwordx4 v27, s[48:51], s42 offen lds
    ds_read_b128 v[32:35], v0 offset:33408
    v_mfma_f32_32x32x16_bf16 v[80:95], v[36:39], v[248:251], v[80:95]
    s_lshl1_add_u32 m0, s39, 135808
    s_add_u32 s42, s23, 7168
    buffer_load_dwordx4 v27, s[48:51], s42 offen offset:1024 lds
    ds_read_b64_tr_b16 v[36:37], v5 offset:32
    ds_read_b64_tr_b16 v[38:39], v5 offset:672
    s_waitcnt lgkmcnt(7)
    v_mfma_f32_32x32x16_bf16 v[112:127], v[40:43], v[8:11], v[112:127]
    ds_read_b64_tr_b16 v[40:41], v6 offset:32
    ds_read_b64_tr_b16 v[42:43], v6 offset:672
    s_waitcnt lgkmcnt(5)
    v_mfma_f32_32x32x16_bf16 v[80:95], v[44:47], v[252:255], v[80:95]
    s_waitcnt vmcnt(4)
    ds_read_b64_tr_b16 v[72:73], v31 offset:0
    ds_read_b64_tr_b16 v[74:75], v31 offset:512
    ds_read_b64_tr_b16 v[76:77], v26 offset:0
    ds_read_b64_tr_b16 v[78:79], v26 offset:512
    ds_read_b64_tr_b16 v[44:45], v7 offset:32
    ds_read_b64_tr_b16 v[46:47], v7 offset:672
    s_waitcnt lgkmcnt(10)
    v_mfma_f32_32x32x16_bf16 v[80:95], v[32:35], v[8:11], v[80:95]
    v_add_f32 v56, v56, v112
    v_add_f32 v57, v57, v113
    v_add_f32 v58, v58, v114
    v_add_f32 v59, v59, v115
    v_add_f32 v60, v60, v120
    v_add_f32 v61, v61, v121
    ds_read_b64_tr_b16 v[32:33], v5 offset:20640
    ds_read_b64_tr_b16 v[34:35], v5 offset:21280
    s_waitcnt lgkmcnt(10)
    v_mfma_f32_32x32x16_bf16 v[96:111], v[36:39], v[212:215], v[96:111]
    v_add_f32 v62, v62, v122
    v_add_f32 v63, v63, v123
    v_mul_f32 v56, v56, v24
    v_mul_f32 v57, v57, v24
    v_mul_f32 v58, v58, v24
    v_mul_f32 v59, v59, v24
    s_waitcnt lgkmcnt(4)
    s_lshl1_add_u32 m0, s39, 103040
    s_add_u32 s42, s22, 49152
    buffer_load_dwordx4 v27, s[48:51], s42 offen lds
    ds_read_b64_tr_b16 v[36:37], v6 offset:20640
    ds_read_b64_tr_b16 v[38:39], v6 offset:21280
    v_mfma_f32_32x32x16_bf16 v[96:111], v[40:43], v[216:219], v[96:111]
    v_exp_f32 v56, v56
    v_exp_f32 v57, v57
    v_exp_f32 v58, v58
    s_lshl1_add_u32 m0, s39, 103040
    s_add_u32 s42, s22, 56320
    buffer_load_dwordx4 v27, s[48:51], s42 offen offset:1024 lds
    ds_read_b64_tr_b16 v[40:41], v7 offset:20640
    ds_read_b64_tr_b16 v[42:43], v7 offset:21280
    s_waitcnt lgkmcnt(6)
    v_mfma_f32_32x32x16_bf16 v[96:111], v[44:47], v[220:223], v[96:111]
    v_exp_f32 v59, v59
    v_fma_f32 v56, v56, v25, v25
    v_fma_f32 v57, v57, v25, v25
    v_fma_f32 v58, v58, v25, v25
    v_fma_f32 v59, v59, v25, v25
    s_waitcnt vmcnt(4)
    ds_read_b64_tr_b16 v[192:193], v31 offset:16384
    ds_read_b64_tr_b16 v[194:195], v31 offset:16896
    ds_read_b64_tr_b16 v[196:197], v26 offset:16384
    ds_read_b64_tr_b16 v[198:199], v26 offset:16896
    ds_read_b64_tr_b16 v[44:45], v5 offset:41248
    ds_read_b64_tr_b16 v[46:47], v5 offset:41888
    s_waitcnt lgkmcnt(10)
    v_mfma_f32_32x32x16_bf16 v[96:111], v[32:35], v[228:231], v[96:111]
    v_rcp_f32 v56, v56
    v_rcp_f32 v57, v57
    v_rcp_f32 v58, v58
    ds_read_b64_tr_b16 v[32:33], v6 offset:41248
    ds_read_b64_tr_b16 v[34:35], v6 offset:41888
    s_waitcnt lgkmcnt(10)
    v_mfma_f32_32x32x16_bf16 v[96:111], v[36:39], v[232:235], v[96:111]
    v_rcp_f32 v59, v59
    v_mul_f32 v56, v56, v60
    v_mul_f32 v57, v57, v61
    v_mul_f32 v58, v58, v62
    v_mul_f32 v59, v59, v63
    s_waitcnt lgkmcnt(4)
    s_lshl1_add_u32 m0, s39, 119424
    s_add_u32 s42, s23, 16384
    buffer_load_dwordx4 v27, s[48:51], s42 offen lds
    ds_read_b64_tr_b16 v[36:37], v7 offset:41248
    ds_read_b64_tr_b16 v[38:39], v7 offset:41888
    v_mfma_f32_32x32x16_bf16 v[96:111], v[40:43], v[236:239], v[96:111]
    v_cvt_pk_bf16_f32 v56, v56, v57
    v_cvt_pk_bf16_f32 v57, v58, v59
    v_mul_f32 v80, v80, v24
    v_mul_f32 v81, v81, v24
    v_mul_f32 v82, v82, v24
    v_mul_f32 v83, v83, v24
    s_cmp_lg_u32 s101, 0
    s_cbranch_scc1 L_parallel_sum__linear_kernel_hedgehog__glu_gated_glu__prompt_kernel_00_ss1
    buffer_store_dwordx2 v[56:57], v0, s[24:27], s52 offen offset:2048
L_parallel_sum__linear_kernel_hedgehog__glu_gated_glu__prompt_kernel_00_sb1:
    ds_read_b128 v[40:43], v0 offset:34432
    s_waitcnt lgkmcnt(5)
    v_mfma_f32_32x32x16_bf16 v[96:111], v[44:47], v[244:247], v[96:111]
    v_mul_f32 v84, v84, v24
    v_mul_f32 v85, v85, v24
    v_mul_f32 v86, v86, v24
    v_mul_f32 v87, v87, v24
    v_exp_f32 v80, v80
    s_waitcnt vmcnt(4)
    ds_read_b64_tr_b16 v[200:201], v31 offset:32768
    ds_read_b64_tr_b16 v[202:203], v31 offset:33280
    ds_read_b64_tr_b16 v[204:205], v26 offset:32768
    ds_read_b64_tr_b16 v[206:207], v26 offset:33280
    s_lshl1_add_u32 m0, s39, 119424
    s_add_u32 s42, s23, 23552
    buffer_load_dwordx4 v27, s[48:51], s42 offen offset:1024 lds
    s_waitcnt lgkmcnt(7)
    v_mfma_f32_32x32x16_bf16 v[96:111], v[32:35], v[248:251], v[96:111]
    v_exp_f32 v81, v81
    v_exp_f32 v82, v82
    v_exp_f32 v83, v83
    s_waitcnt lgkmcnt(5)
    v_mfma_f32_32x32x16_bf16 v[96:111], v[36:39], v[252:255], v[96:111]
    v_exp_f32 v84, v84
    v_exp_f32 v85, v85
    v_exp_f32 v86, v86
    s_waitcnt lgkmcnt(0)
    s_lshl1_add_u32 m0, s39, 135808
    s_add_u32 s42, s22, 65536
    buffer_load_dwordx4 v27, s[48:51], s42 offen lds
    v_mfma_f32_32x32x16_bf16 v[96:111], v[40:43], v[8:11], v[96:111]
    v_exp_f32 v87, v87
    v_fma_f32 v80, v80, v25, v25
    v_fma_f32 v81, v81, v25, v25
    v_fma_f32 v82, v82, v25, v25
    v_fma_f32 v83, v83, v25, v25
    s_lshl1_add_u32 m0, s39, 135808
    s_add_u32 s42, s22, 72704
    buffer_load_dwordx4 v27, s[48:51], s42 offen offset:1024 lds
    v_fma_f32 v84, v84, v25, v25
    v_fma_f32 v85, v85, v25, v25
    v_fma_f32 v86, v86, v25, v25
    v_fma_f32 v87, v87, v25, v25
    v_rcp_f32 v80, v80
    v_rcp_f32 v81, v81
    v_rcp_f32 v82, v82
    v_rcp_f32 v83, v83
    v_rcp_f32 v84, v84
    v_rcp_f32 v85, v85
    v_rcp_f32 v86, v86
    v_rcp_f32 v87, v87
    v_mul_f32 v80, v80, v88
    v_mul_f32 v81, v81, v89
    v_mul_f32 v82, v82, v90
    v_mul_f32 v83, v83, v91
    v_mul_f32 v84, v84, v92
    v_mul_f32 v85, v85, v93
    v_mul_f32 v86, v86, v94
    v_mul_f32 v87, v87, v95
    v_cvt_pk_bf16_f32 v80, v80, v81
    v_cvt_pk_bf16_f32 v81, v82, v83
    v_cvt_pk_bf16_f32 v82, v84, v85
    v_cvt_pk_bf16_f32 v83, v86, v87
    s_cmp_lg_u32 s101, 0
    s_cbranch_scc1 L_parallel_sum__linear_kernel_hedgehog__glu_gated_glu__prompt_kernel_00_ss2
    buffer_store_dwordx4 v[80:83], v0, s[24:27], s34 offen offset:0
L_parallel_sum__linear_kernel_hedgehog__glu_gated_glu__prompt_kernel_00_sb2:
    v_mul_f32 v96, v96, v24
    v_mul_f32 v97, v97, v24
    v_mul_f32 v98, v98, v24
    v_mul_f32 v99, v99, v24
    v_mul_f32 v100, v100, v24
    v_mul_f32 v101, v101, v24
    v_mul_f32 v102, v102, v24
    v_mul_f32 v103, v103, v24
    v_exp_f32 v96, v96
    v_exp_f32 v97, v97
    v_exp_f32 v98, v98
    v_exp_f32 v99, v99
    v_exp_f32 v100, v100
    v_exp_f32 v101, v101
    v_exp_f32 v102, v102
    v_exp_f32 v103, v103
    v_fma_f32 v96, v96, v25, v25
    v_fma_f32 v97, v97, v25, v25
    v_fma_f32 v98, v98, v25, v25
    v_fma_f32 v99, v99, v25, v25
    v_fma_f32 v100, v100, v25, v25
    v_fma_f32 v101, v101, v25, v25
    v_fma_f32 v102, v102, v25, v25
    v_fma_f32 v103, v103, v25, v25
    v_rcp_f32 v96, v96
    v_rcp_f32 v97, v97
    v_rcp_f32 v98, v98
    v_rcp_f32 v99, v99
    v_rcp_f32 v100, v100
    v_rcp_f32 v101, v101
    v_rcp_f32 v102, v102
    v_rcp_f32 v103, v103
    v_mul_f32 v96, v96, v104
    v_mul_f32 v97, v97, v105
    v_mul_f32 v98, v98, v106
    v_mul_f32 v99, v99, v107
    v_mul_f32 v100, v100, v108
    v_mul_f32 v101, v101, v109
    v_mul_f32 v102, v102, v110
    v_mul_f32 v103, v103, v111
    v_cvt_pk_bf16_f32 v96, v96, v97
    v_cvt_pk_bf16_f32 v97, v98, v99
    v_cvt_pk_bf16_f32 v98, v100, v101
    v_cvt_pk_bf16_f32 v99, v102, v103
    buffer_load_dword v29, v28, s[24:27], s31 offen sc1
    s_cmp_lg_u32 s101, 0
    s_cbranch_scc1 L_parallel_sum__linear_kernel_hedgehog__glu_gated_glu__prompt_kernel_00_ss3
    buffer_store_dwordx4 v[96:99], v0, s[24:27], s34 offen offset:1024
L_parallel_sum__linear_kernel_hedgehog__glu_gated_glu__prompt_kernel_00_sb3:
    s_barrier
    v_mov_b32 v30, 3
    s_waitcnt vmcnt(0)
    s_mov_b64 exec, 1
    s_cmp_lg_u32 s101, 0
    s_cbranch_scc1 L_parallel_sum__linear_kernel_hedgehog__glu_gated_glu__prompt_kernel_00_ss4
    buffer_store_dword v30, off, s[24:27], s33
L_parallel_sum__linear_kernel_hedgehog__glu_gated_glu__prompt_kernel_00_sb4:
    s_mov_b64 exec, -1
    v_cmp_gt_u32 vcc, 3, v29
    s_and_b32 s57, vcc_lo, 240
    s_cbranch_scc1 L_parallel_sum__linear_kernel_hedgehog__glu_gated_glu__prompt_kernel_00_fp1
L_parallel_sum__linear_kernel_hedgehog__glu_gated_glu__prompt_kernel_00_fb1:
    s_add_u32 s42, s28, 0
    buffer_load_dwordx4 v[112:115], v0, s[24:27], s42 offen
    s_add_u32 s42, s28, 120832
    buffer_load_dwordx4 v[116:119], v0, s[24:27], s42 offen
    s_add_u32 s42, s28, 3072
    buffer_load_dwordx4 v[120:123], v0, s[24:27], s42 offen
    s_add_u32 s42, s28, 123904
    buffer_load_dwordx4 v[124:127], v0, s[24:27], s42 offen
    s_add_u32 s42, s28, 1024
    buffer_load_dwordx4 v[48:51], v0, s[24:27], s42 offen
    s_add_u32 s42, s28, 121856
    buffer_load_dwordx4 v[52:55], v0, s[24:27], s42 offen
    s_add_u32 s42, s28, 4096
    buffer_load_dwordx4 v[56:59], v0, s[24:27], s42 offen
    s_add_u32 s42, s28, 124928
    buffer_load_dwordx4 v[60:63], v0, s[24:27], s42 offen
    s_add_u32 s42, s28, 2048
    buffer_load_dwordx4 v[80:83], v0, s[24:27], s42 offen
    s_add_u32 s42, s28, 122880
    buffer_load_dwordx4 v[84:87], v0, s[24:27], s42 offen
    s_add_u32 s42, s28, 5120
    buffer_load_dwordx4 v[88:91], v0, s[24:27], s42 offen
    s_add_u32 s42, s28, 125952
    buffer_load_dwordx4 v[92:95], v0, s[24:27], s42 offen
    buffer_load_dword v29, v28, s[24:27], s31 offen sc1
    s_waitcnt vmcnt(12)
    v_mfma_f32_32x32x16_bf16 v[208:223], v[128:131], v[112:115], 0
    s_waitcnt vmcnt(11)
    v_mfma_f32_32x32x16_bf16 v[240:255], v[128:131], v[116:119], 0
    v_mfma_f32_32x32x16_bf16 v[224:239], v[132:135], v[112:115], 0
    v_mfma_f32_32x32x16_bf16 v[32:47], v[132:135], v[116:119], 0
    s_waitcnt vmcnt(10)
    v_mfma_f32_32x32x16_bf16 v[208:223], v[136:139], v[120:123], v[208:223]
    s_waitcnt vmcnt(9)
    v_mfma_f32_32x32x16_bf16 v[240:255], v[136:139], v[124:127], v[240:255]
    v_mfma_f32_32x32x16_bf16 v[224:239], v[140:143], v[120:123], v[224:239]
    v_mfma_f32_32x32x16_bf16 v[32:47], v[140:143], v[124:127], v[32:47]
    s_waitcnt vmcnt(8)
    v_mfma_f32_32x32x16_bf16 v[208:223], v[144:147], v[48:51], v[208:223]
    s_waitcnt vmcnt(7)
    v_mfma_f32_32x32x16_bf16 v[240:255], v[144:147], v[52:55], v[240:255]
    v_mfma_f32_32x32x16_bf16 v[224:239], v[148:151], v[48:51], v[224:239]
    v_mfma_f32_32x32x16_bf16 v[32:47], v[148:151], v[52:55], v[32:47]
    s_waitcnt vmcnt(6)
    v_mfma_f32_32x32x16_bf16 v[208:223], v[152:155], v[56:59], v[208:223]
    s_waitcnt vmcnt(5)
    v_mfma_f32_32x32x16_bf16 v[240:255], v[152:155], v[60:63], v[240:255]
    v_mfma_f32_32x32x16_bf16 v[224:239], v[156:159], v[56:59], v[224:239]
    v_mfma_f32_32x32x16_bf16 v[32:47], v[156:159], v[60:63], v[32:47]
    ds_read_b64_tr_b16 v[128:129], v31 offset:0
    ds_read_b64_tr_b16 v[130:131], v31 offset:512
    ds_read_b64_tr_b16 v[132:133], v26 offset:0
    ds_read_b64_tr_b16 v[134:135], v26 offset:512
    ds_read_b64_tr_b16 v[136:137], v31 offset:16384
    ds_read_b64_tr_b16 v[138:139], v31 offset:16896
    ds_read_b64_tr_b16 v[140:141], v26 offset:16384
    ds_read_b64_tr_b16 v[142:143], v26 offset:16896
    ds_read_b64_tr_b16 v[144:145], v31 offset:32768
    ds_read_b64_tr_b16 v[146:147], v31 offset:33280
    ds_read_b64_tr_b16 v[148:149], v26 offset:32768
    ds_read_b64_tr_b16 v[150:151], v26 offset:33280
    s_waitcnt vmcnt(0)
    v_cmp_gt_u32 vcc, 4, v29
    s_and_b32 s57, vcc_lo, 240
    s_cbranch_scc1 L_parallel_sum__linear_kernel_hedgehog__glu_gated_glu__prompt_kernel_00_fp2
L_parallel_sum__linear_kernel_hedgehog__glu_gated_glu__prompt_kernel_00_fb2:
    s_add_u32 s42, s29, 0
    buffer_load_dwordx4 v[96:99], v0, s[24:27], s42 offen
    s_add_u32 s42, s29, 120832
    buffer_load_dwordx4 v[100:103], v0, s[24:27], s42 offen
    v_mfma_f32_32x32x16_bf16 v[208:223], v[160:163], v[80:83], v[208:223]
    v_mfma_f32_32x32x16_bf16 v[240:255], v[160:163], v[84:87], v[240:255]
    v_mfma_f32_32x32x16_bf16 v[224:239], v[164:167], v[80:83], v[224:239]
    v_mfma_f32_32x32x16_bf16 v[32:47], v[164:167], v[84:87], v[32:47]
    s_add_u32 s42, s29, 1024
    buffer_load_dwordx4 v[104:107], v0, s[24:27], s42 offen
    s_add_u32 s42, s29, 121856
    buffer_load_dwordx4 v[108:111], v0, s[24:27], s42 offen
    s_add_u32 s42, s29, 2048
    buffer_load_dwordx4 v[112:115], v0, s[24:27], s42 offen
    s_add_u32 s42, s29, 122880
    buffer_load_dwordx4 v[116:119], v0, s[24:27], s42 offen
    v_mfma_f32_32x32x16_bf16 v[208:223], v[168:171], v[88:91], v[208:223]
    v_mfma_f32_32x32x16_bf16 v[240:255], v[168:171], v[92:95], v[240:255]
    v_mfma_f32_32x32x16_bf16 v[224:239], v[172:175], v[88:91], v[224:239]
    v_mfma_f32_32x32x16_bf16 v[32:47], v[172:175], v[92:95], v[32:47]
    s_add_u32 s42, s29, 3072
    buffer_load_dwordx4 v[120:123], v0, s[24:27], s42 offen
    s_add_u32 s42, s29, 123904
    buffer_load_dwordx4 v[124:127], v0, s[24:27], s42 offen
    v_and_b32 v4, 48, v0
    v_bfe_u32 v13, v0, 6, 2
    v_lshl_add_u32 v4, v13, 10, v4
    v_bfe_u32 v7, v0, 8, 1
    v_lshl_add_u32 v4, v7, 6, v4
    v_bfe_u32 v7, v0, 9, 1
    v_lshl_add_u32 v4, v7, 12, v4
    buffer_load_dwordx4 v[8:11], v4, s[8:11], s0 offen
    v_bfe_u32 v7, v0, 8, 2
    v_lshlrev_b32 v7, 11, v7
    v_lshl_add_u32 v7, v13, 4, v7
    v_lshl_add_u32 v7, s37, 7, v7
    v_bfe_u32 v13, v0, 4, 2
    v_mov_b32 v12, 0
    v_mov_b32 v14, 16448
    v_cmp_eq_u32 vcc, 1, v13
    s_nop 1
    v_cndmask_b32 v12, v12, v14, vcc
    v_mov_b32 v14, 32896
    v_cmp_eq_u32 vcc, 2, v13
    s_nop 1
    v_cndmask_b32 v12, v12, v14, vcc
    v_mov_b32 v14, 49344
    v_cmp_eq_u32 vcc, 3, v13
    s_nop 1
    v_cndmask_b32 v12, v12, v14, vcc
    v_add_u32 v12, v12, v7
    v_and_b32 v14, 16, v0
    v_mov_b32 v7, 0x3f80
    v_lshlrev_b32 v14, v14, v7
    v_bfe_u32 v7, v0, 5, 3
    v_cmp_eq_u32 vcc, 0, v7
    s_nop 1
    v_cndmask_b32 v168, 0, v14, vcc
    v_cmp_eq_u32 vcc, 1, v7
    s_nop 1
    v_cndmask_b32 v169, 0, v14, vcc
    v_cmp_eq_u32 vcc, 2, v7
    s_nop 1
    v_cndmask_b32 v170, 0, v14, vcc
    v_cmp_eq_u32 vcc, 3, v7
    s_nop 1
    v_cndmask_b32 v171, 0, v14, vcc
    v_cmp_eq_u32 vcc, 4, v7
    s_nop 1
    v_cndmask_b32 v172, 0, v14, vcc
    v_cmp_eq_u32 vcc, 5, v7
    s_nop 1
    v_cndmask_b32 v173, 0, v14, vcc
    v_cmp_eq_u32 vcc, 6, v7
    s_nop 1
    v_cndmask_b32 v174, 0, v14, vcc
    v_cmp_eq_u32 vcc, 7, v7
    s_nop 1
    v_cndmask_b32 v175, 0, v14, vcc
    v_cmp_gt_u32 vcc, 3, v29
    s_and_b32 s57, vcc_lo, 15
    s_cbranch_scc1 L_parallel_sum__linear_kernel_hedgehog__glu_gated_glu__prompt_kernel_00_fp3
L_parallel_sum__linear_kernel_hedgehog__glu_gated_glu__prompt_kernel_00_fb3:
    s_add_u32 s42, s30, 2048
    buffer_load_dwordx4 v[48:51], v0, s[24:27], s42 offen
    s_add_u32 s42, s30, 122880
    buffer_load_dwordx4 v[52:55], v0, s[24:27], s42 offen
    s_waitcnt vmcnt(10)
    v_mfma_f32_32x32x16_bf16 v[208:223], v[176:179], v[96:99], v[208:223]
    s_waitcnt vmcnt(9)
    v_mfma_f32_32x32x16_bf16 v[240:255], v[176:179], v[100:103], v[240:255]
    v_mfma_f32_32x32x16_bf16 v[224:239], v[180:183], v[96:99], v[224:239]
    v_mfma_f32_32x32x16_bf16 v[32:47], v[180:183], v[100:103], v[32:47]
    s_add_u32 s42, s36, 0
    buffer_load_dwordx4 v[56:59], v0, s[24:27], s42 offen
    s_add_u32 s42, s36, 120832
    buffer_load_dwordx4 v[60:63], v0, s[24:27], s42 offen
    s_waitcnt vmcnt(10)
    v_mfma_f32_32x32x16_bf16 v[208:223], v[184:187], v[104:107], v[208:223]
    s_waitcnt vmcnt(9)
    v_mfma_f32_32x32x16_bf16 v[240:255], v[184:187], v[108:111], v[240:255]
    v_mfma_f32_32x32x16_bf16 v[224:239], v[188:191], v[104:107], v[224:239]
    v_mfma_f32_32x32x16_bf16 v[32:47], v[188:191], v[108:111], v[32:47]
    s_add_u32 s42, s30, 3072
    buffer_load_dwordx4 v[152:155], v0, s[24:27], s42 offen
    s_add_u32 s42, s30, 123904
    buffer_load_dwordx4 v[156:159], v0, s[24:27], s42 offen
    s_waitcnt vmcnt(10)
    v_mfma_f32_32x32x16_bf16 v[208:223], v[64:67], v[112:115], v[208:223]
    s_waitcnt vmcnt(9)
    v_mfma_f32_32x32x16_bf16 v[240:255], v[64:67], v[116:119], v[240:255]
    v_mfma_f32_32x32x16_bf16 v[224:239], v[68:71], v[112:115], v[224:239]
    v_mfma_f32_32x32x16_bf16 v[32:47], v[68:71], v[116:119], v[32:47]
    s_add_u32 s42, s36, 1024
    buffer_load_dwordx4 v[80:83], v0, s[24:27], s42 offen
    s_add_u32 s42, s36, 121856
    buffer_load_dwordx4 v[84:87], v0, s[24:27], s42 offen
    s_waitcnt vmcnt(10)
    v_mfma_f32_32x32x16_bf16 v[208:223], v[72:75], v[120:123], v[208:223]
    s_waitcnt vmcnt(9)
    v_mfma_f32_32x32x16_bf16 v[240:255], v[72:75], v[124:127], v[240:255]
    v_mfma_f32_32x32x16_bf16 v[224:239], v[76:79], v[120:123], v[224:239]
    v_mfma_f32_32x32x16_bf16 v[32:47], v[76:79], v[124:127], v[32:47]
    s_add_u32 s42, s30, 4096
    buffer_load_dwordx4 v[88:91], v0, s[24:27], s42 offen
    s_add_u32 s42, s30, 124928
    buffer_load_dwordx4 v[92:95], v0, s[24:27], s42 offen
    s_waitcnt vmcnt(9)
    v_mfma_f32_32x32x16_bf16 v[208:223], v[192:195], v[48:51], v[208:223]
    s_waitcnt vmcnt(8)
    v_mfma_f32_32x32x16_bf16 v[240:255], v[192:195], v[52:55], v[240:255]
    v_mfma_f32_32x32x16_bf16 v[224:239], v[196:199], v[48:51], v[224:239]
    v_mfma_f32_32x32x16_bf16 v[32:47], v[196:199], v[52:55], v[32:47]
    s_waitcnt vmcnt(7)
    v_mfma_f32_32x32x16_bf16 v[208:223], v[200:203], v[56:59], v[208:223]
    s_waitcnt vmcnt(6)
    v_mfma_f32_32x32x16_bf16 v[240:255], v[200:203], v[60:63], v[240:255]
    v_mfma_f32_32x32x16_bf16 v[224:239], v[204:207], v[56:59], v[224:239]
    v_mfma_f32_32x32x16_bf16 v[32:47], v[204:207], v[60:63], v[32:47]
    s_waitcnt vmcnt(5) lgkmcnt(10)
    v_mfma_f32_32x32x16_bf16 v[208:223], v[128:131], v[152:155], v[208:223]
    s_waitcnt vmcnt(4)
    v_mfma_f32_32x32x16_bf16 v[240:255], v[128:131], v[156:159], v[240:255]
    s_waitcnt lgkmcnt(8)
    v_mfma_f32_32x32x16_bf16 v[224:239], v[132:135], v[152:155], v[224:239]
    v_mfma_f32_32x32x16_bf16 v[32:47], v[132:135], v[156:159], v[32:47]
    s_lshl_b32 s56, s39, 1
    s_sub_u32 s56, s56, 122880
    v_add_u32 v5, s56, v0
    v_add_u32 v6, 65536, v5
    v_add_u32 v7, 119424, v5
    s_waitcnt vmcnt(3) lgkmcnt(6)
    v_mfma_f32_32x32x16_bf16 v[208:223], v[136:139], v[80:83], v[208:223]
    s_waitcnt vmcnt(1) lgkmcnt(2)
    v_mfma_f32_32x32x16_bf16 v[208:223], v[144:147], v[88:91], v[208:223]
    v_mfma_f32_32x32x16_bf16 v[240:255], v[136:139], v[84:87], v[240:255]
    s_waitcnt vmcnt(0)
    v_mfma_f32_32x32x16_bf16 v[240:255], v[144:147], v[92:95], v[240:255]
    s_nop 8
    v_cvt_pk_bf16_f32 v208, v208, v209
    v_cvt_pk_bf16_f32 v209, v210, v211
    v_cvt_pk_bf16_f32 v210, v212, v213
    v_cvt_pk_bf16_f32 v211, v214, v215
    ds_write_b128 v5, v[208:211] offset:0
    v_cvt_pk_bf16_f32 v216, v216, v217
    v_cvt_pk_bf16_f32 v217, v218, v219
    v_cvt_pk_bf16_f32 v218, v220, v221
    v_cvt_pk_bf16_f32 v219, v222, v223
    ds_write_b128 v5, v[216:219] offset:16448
    v_mfma_f32_32x32x16_bf16 v[224:239], v[140:143], v[80:83], v[224:239]
    s_waitcnt lgkmcnt(2)
    v_mfma_f32_32x32x16_bf16 v[224:239], v[148:151], v[88:91], v[224:239]
    v_cvt_pk_bf16_f32 v240, v240, v241
    v_cvt_pk_bf16_f32 v241, v242, v243
    v_cvt_pk_bf16_f32 v242, v244, v245
    v_cvt_pk_bf16_f32 v243, v246, v247
    ds_write_b128 v6, v[240:243] offset:0
    v_cvt_pk_bf16_f32 v248, v248, v249
    v_cvt_pk_bf16_f32 v249, v250, v251
    v_cvt_pk_bf16_f32 v250, v252, v253
    v_cvt_pk_bf16_f32 v251, v254, v255
    ds_write_b128 v6, v[248:251] offset:37696
    v_mfma_f32_32x32x16_bf16 v[32:47], v[140:143], v[84:87], v[32:47]
    v_mfma_f32_32x32x16_bf16 v[32:47], v[148:151], v[92:95], v[32:47]
    v_cvt_pk_bf16_f32 v224, v224, v225
    v_cvt_pk_bf16_f32 v225, v226, v227
    v_cvt_pk_bf16_f32 v226, v228, v229
    v_cvt_pk_bf16_f32 v227, v230, v231
    ds_write_b128 v5, v[224:227] offset:32896
    v_cvt_pk_bf16_f32 v232, v232, v233
    v_cvt_pk_bf16_f32 v233, v234, v235
    v_cvt_pk_bf16_f32 v234, v236, v237
    v_cvt_pk_bf16_f32 v235, v238, v239
    ds_write_b128 v5, v[232:235] offset:49344
    v_lshlrev_b32 v16, 16, v8
    v_and_b32 v17, s55, v8
    v_lshlrev_b32 v18, 16, v9
    v_and_b32 v19, s55, v9
    v_lshlrev_b32 v20, 16, v10
    v_and_b32 v21, s55, v10
    v_lshlrev_b32 v22, 16, v11
    v_and_b32 v23, s55, v11
    v_cvt_pk_bf16_f32 v32, v32, v33
    v_cvt_pk_bf16_f32 v33, v34, v35
    v_cvt_pk_bf16_f32 v34, v36, v37
    v_cvt_pk_bf16_f32 v35, v38, v39
    ds_write_b128 v7, v[32:35] offset:0
    v_cvt_pk_bf16_f32 v40, v40, v41
    v_cvt_pk_bf16_f32 v41, v42, v43
    v_cvt_pk_bf16_f32 v42, v44, v45
    v_cvt_pk_bf16_f32 v43, v46, v47
    ds_write_b128 v7, v[40:43] offset:16448
    s_waitcnt lgkmcnt(0)
    s_barrier
    ds_read_b128 v[128:131], v12 offset:0
    ds_read_b128 v[132:135], v12 offset:512
    ds_read_b128 v[136:139], v12 offset:64
    ds_read_b128 v[140:143], v12 offset:576
    ds_read_b128 v[144:147], v12 offset:8192
    ds_read_b128 v[148:151], v12 offset:8704
    ds_read_b128 v[152:155], v12 offset:8256
    ds_read_b128 v[156:159], v12 offset:8768
    s_waitcnt lgkmcnt(7)
    v_mfma_f32_16x16x32_bf16 v[16:19], v[168:171], v[128:131], v[16:19]
    s_waitcnt lgkmcnt(6)
    v_mfma_f32_16x16x32_bf16 v[20:23], v[168:171], v[132:135], v[20:23]
    s_waitcnt lgkmcnt(5)
    v_mfma_f32_16x16x32_bf16 v[16:19], v[172:175], v[136:139], v[16:19]
    s_waitcnt lgkmcnt(4)
    v_mfma_f32_16x16x32_bf16 v[20:23], v[172:175], v[140:143], v[20:23]
    s_waitcnt lgkmcnt(3)
    v_mfma_f32_16x16x32_bf16 v[16:19], v[168:171], v[144:147], v[16:19]
    s_waitcnt lgkmcnt(2)
    v_mfma_f32_16x16x32_bf16 v[20:23], v[168:171], v[148:151], v[20:23]
    s_waitcnt lgkmcnt(1)
    v_mfma_f32_16x16x32_bf16 v[16:19], v[172:175], v[152:155], v[16:19]
    s_waitcnt lgkmcnt(0)
    v_mfma_f32_16x16x32_bf16 v[20:23], v[172:175], v[156:159], v[20:23]
    s_nop 5
    v_cvt_pk_bf16_f32 v16, v16, v17
    v_cvt_pk_bf16_f32 v17, v18, v19
    v_cvt_pk_bf16_f32 v18, v20, v21
    v_cvt_pk_bf16_f32 v19, v22, v23
    buffer_store_dwordx4 v[16:19], v4, s[12:15], s0 offen sc1
    s_endpgm
.p2align 6
L_parallel_sum__linear_kernel_hedgehog__glu_gated_glu__prompt_kernel_r1:
    s_mov_b32 s30, 16384
    s_mov_b32 s31, 0x20000
    s_mov_b32 s22, 1409024
    s_mov_b32 s23, 0x20000
    s_mov_b32 s26, 16777216
    s_mov_b32 s27, 0x20000
    s_mov_b32 s6, 256
    s_mov_b32 s7, 0x20000
    s_mov_b32 s50, 1409024
    s_mov_b32 s51, 0x20000
    s_mov_b32 s55, 0xffff0000
    s_getreg_b32 s100, hwreg(HW_REG_XCC_ID, 0, 4)
    s_mul_i32 s101, s100, s100
    s_lshl_b32 s101, s101, 9
    s_add_u32 s100, s100, s101
    s_lshl_b32 s100, s100, 8
    s_add_u32 s100, s100, 1
    s_lshl_b32 s3, s37, 2
    v_mov_b32 v121, v2
    v_lshrrev_b32 v116, 5, v82
    v_and_b32 v117, 1, v2
    v_bfe_u32 v118, v82, 2, 2
    v_bfe_u32 v112, v82, 1, 1
    v_and_b32 v113, 1, v82
    v_lshl_or_b32 v119, v113, 1, v112
    v_lshlrev_b32 v119, 3, v119
    v_lshl_add_u32 v120, v116, 3, v118
    v_lshl_or_b32 v114, v117, 1, v112
    v_lshlrev_b32 v114, 3, v114
    v_lshl_add_u32 v114, v120, 5, v114
    v_lshl_add_u32 v114, v113, 11, v114
    v_add_u32 v27, 153216, v114
    v_bfe_u32 v114, v82, 2, 3
    v_lshl_add_u32 v114, v116, 4, v114
    v_mul_u32_u24 v114, 96, v114
    v_lshl_add_u32 v114, v113, 3, v114
    s_lshr_b32 s56, s37, 1
    s_mul_i32 s56, s56, 12288
    s_add_u32 s56, s56, 127616
    s_and_b32 s57, s37, 1
    s_lshl_b32 s57, s57, 5
    s_add_u32 s57, s57, s56
    v_xor_b32 v115, v112, v117
    v_lshlrev_b32 v115, 4, v115
    v_add3_u32 v29, v114, v115, s57
    v_and_b32 v113, 2, v118
    v_or_b32 v113, v113, v117
    v_lshl_add_u32 v113, v113, 5, v119
    v_lshl_add_u32 v113, v120, 7, v113
    s_lshl_b32 s56, s37, 11
    s_add_u32 s56, s56, 64
    v_xor_b32 v104, s56, v113
    v_and_b32 v112, 31, v82
    v_bfe_u32 v113, v82, 1, 3
    v_xor_b32 v113, v113, v116
    v_lshlrev_b32 v113, 4, v113
    v_lshl_add_u32 v113, v112, 7, v113
    s_mul_i32 s56, s37, 4128
    v_xor_b32 v96, s56, v113
    v_xor_b32 v97, 32, v96
    v_xor_b32 v105, 2048, v104
    v_xor_b32 v98, 64, v96
    v_xor_b32 v106, 4096, v104
    v_xor_b32 v99, 96, v96
    v_xor_b32 v107, 6144, v104
    v_add_u32 v100, 103040, v96
    v_add_u32 v108, 82432, v104
    v_add_u32 v96, 20608, v96
    v_add_u32 v104, 12416, v104
    v_add_u32 v101, 103040, v97
    v_add_u32 v109, 82432, v105
    v_add_u32 v97, 20608, v97
    v_add_u32 v105, 12416, v105
    v_add_u32 v102, 103040, v98
    v_add_u32 v110, 82432, v106
    v_add_u32 v98, 20608, v98
    v_add_u32 v106, 12416, v106
    v_add_u32 v103, 103040, v99
    v_add_u32 v111, 82432, v107
    v_add_u32 v99, 20608, v99
    v_add_u32 v107, 12416, v107
    s_lshl_b32 s56, s37, 9
    s_add_u32 s56, s56, 98816
    v_lshlrev_b32 v113, 4, v112
    v_add_u32 v90, s56, v113
    v_lshl_add_u32 v89, v116, 2, v90
    v_lshl_add_u32 v89, v117, 3, v89
    v_xor_b32 v89, 8, v89
    v_mul_u32_u24 v113, 96, v112
    v_and_b32 v114, 4, v112
    v_lshlrev_b32 v114, 2, v114
    s_mul_i32 s56, s37, 3072
    s_add_u32 s56, s56, 127616
    v_add3_u32 v113, v113, v114, s56
    v_lshl_add_u32 v28, v116, 5, v113
    v_lshlrev_b32 v114, 4, v116
    v_xor_b32 v30, v113, v114
    v_mul_u32_u24 v113, 160, v120
    v_mul_u32_u24 v114, 10368, v117
    v_add3_u32 v113, v113, v114, v119
    s_xor_b32 s56, s37, 0
    s_mul_i32 s56, s56, 2560
    v_add_u32 v4, s56, v113
    s_xor_b32 s56, s37, 1
    s_mul_i32 s56, s56, 2560
    v_add_u32 v5, s56, v113
    s_xor_b32 s56, s37, 2
    s_mul_i32 s56, s56, 2560
    v_add_u32 v6, s56, v113
    s_xor_b32 s56, s37, 3
    s_mul_i32 s56, s56, 2560
    v_add_u32 v7, s56, v113
    s_mul_i32 s40, s37, 2560
    s_add_u32 s40, s40, 10368
    s_mul_i32 s58, s34, 5
    s_min_u32 s58, s58, 33
    s_add_u32 s58, s58, 48
    s_mul_i32 s56, s37, 44032
    s_lshl_b32 s57, s58, 5
    s_add_u32 s56, s56, s57
    s_mov_b32 s57, 2592
    v_lshlrev_b32 v112, 4, v82
    v_add_u32 v0, 122880, v112
    v_add_u32 v112, s56, v112
    v_mul_u32_u24 v113, 205, v82
    v_lshrrev_b32 v114, 11, v113
    v_mad_u32_u24 v1, v114, s57, v112
    s_cmp_eq_u32 s34, 7
    s_cselect_b32 s59, 820, 0
    v_and_b32 v114, 0x7ff, v113
    v_cmp_gt_u32 vcc, s59, v114
    s_nop 1
    v_cndmask_b32 v1, v1, 2.0, vcc
    v_add_u32 v113, 13120, v113
    v_lshrrev_b32 v114, 11, v113
    v_mad_u32_u24 v2, v114, s57, v112
    v_and_b32 v114, 0x7ff, v113
    v_cmp_gt_u32 vcc, s59, v114
    s_nop 1
    v_cndmask_b32 v2, v2, 2.0, vcc
    v_add_u32 v113, 13120, v113
    v_lshrrev_b32 v114, 11, v113
    v_mad_u32_u24 v3, v114, s57, v112
    v_and_b32 v114, 0x7ff, v113
    v_cmp_gt_u32 vcc, s59, v114
    s_nop 1
    v_cndmask_b32 v3, v3, 2.0, vcc
    v_and_b32 v112, 15, v82
    v_lshlrev_b32 v113, 2, v121
    v_mov_b32 v114, 0x3f803f80
    v_cmp_eq_u32 vcc, v112, v113
    s_nop 1
    v_cndmask_b32 v12, 0, v114, vcc
    v_cndmask_b32 v13, 0, v114, vcc
    v_cndmask_b32 v14, 0, v114, vcc
    v_cndmask_b32 v15, 0, v114, vcc
    v_xor_b32 v113, s3, v113
    v_or_b32 v94, v113, v0
    s_lshl2_add_u32 s56, s33, s37
    s_mul_i32 s56, s56, 118
    s_add_u32 s57, s56, s58
    s_add_u32 s57, s57, 34
    s_lshl_b32 s52, s57, 10
    s_lshr_b32 s57, s32, 1
    s_lshl2_add_u32 s57, s34, s57
    s_mul_i32 s57, s57, 17408
    s_and_b32 s58, s32, 1
    s_lshl4_add_u32 s59, s58, s33
    s_lshl_b32 s59, s59, 9
    s_add_u32 s53, s57, s59
    s_add_u32 s53, s53, 12521472
    s_lshl1_add_u32 s59, s33, s58
    s_lshl_b32 s59, s59, 5
    s_add_u32 s54, s57, s59
    s_add_u32 s54, s54, 12595456
    s_lshl_b32 s35, s37, 11
    s_sub_u32 s35, s35, 61056
    v_lshlrev_b32 v112, 2, v82
    s_lshl_b32 s56, s32, 8
    s_lshl_b32 s57, s34, 11
    s_add_u32 s57, s57, s56
    s_add_u32 s56, s56, 152192
    v_add_u32 v92, s56, v112
    s_lshr_b32 s56, s37, 1
    s_lshl1_add_u32 s56, s33, s56
    s_lshl3_add_u32 s56, s56, s34
    s_lshl_b32 s56, s56, 7
    s_and_b32 s58, s37, 1
    s_lshl2_add_u32 s56, s58, s56
    s_add_u32 s33, s56, 13631496
    v_mov_b32 v113, 0
    v_lshlrev_b32 v93, 7, v82
    v_mov_b32 v116, -1
    v_mov_b32 v117, -1
    v_lshrrev_b32 v114, 1, v0
    v_lshrrev_b32 v115, 5, v0
    s_waitcnt lgkmcnt(0)
    s_add_u32 s41, s36, 1
    s_and_b32 s41, s41, 7
    s_add_u32 m0, s38, 41216
    s_lshl_b32 s42, s41, 7
    buffer_load_dwordx4 v80, s[8:11], s42 offen lds
    s_add_u32 s42, s42, 14336
    buffer_load_dwordx4 v80, s[8:11], s42 offen offset:2048 lds
    buffer_load_dword v91, v112, s[28:31], s57 offen
    s_add_u32 s41, s36, 1
    s_and_b32 s41, s41, 7
    s_add_u32 m0, s39, 57600
    s_mul_i32 s43, s41, 196608
    buffer_load_dwordx4 v81, s[12:15], s43 offen lds
    s_add_u32 s41, s36, 2
    s_and_b32 s41, s41, 7
    s_add_u32 m0, s38, 119424
    s_lshl_b32 s42, s41, 7
    buffer_load_dwordx4 v80, s[8:11], s42 offen lds
    s_add_u32 s42, s42, 14336
    buffer_load_dwordx4 v80, s[8:11], s42 offen offset:2048 lds
    s_lshr_b32 s56, s2, 3
    s_lshl2_add_u32 s56, s56, s37
    s_mul_i32 s56, s56, 12288
    v_lshlrev_b32 v112, 3, v93
    s_mov_b64 exec, 0xfff
    buffer_load_dword v26, v112, s[12:15], s56 offen offset:384
    s_mov_b64 exec, 1
    buffer_store_dword v113, off, s[24:27], s33 sc1
    s_mov_b64 exec, -1
    buffer_store_dwordx2 v[116:117], v114, s[24:27], s53 offen sc1
    s_mov_b32 exec_lo, 0x10001
    s_mov_b32 exec_hi, 0x10001
    buffer_store_dwordx2 v[116:117], v115, s[24:27], s54 offen sc1
    s_mov_b64 exec, -1
    s_mov_b32 s0, 0xaaaaaaaa
    s_mov_b32 s1, 0xaaaaaaaa
    s_mov_b32 s28, 0xcccccccc
    s_mov_b32 s29, 0xcccccccc
    s_mov_b32 s30, 0xff00ff00
    s_mov_b32 s31, 0xff00ff00
    s_mov_b32 s16, 0xffff0000
    s_mov_b32 s17, 0xffff0000
    s_mov_b32 s18, 0xf0f0f0f
    s_mov_b32 s19, 0xf0f0f0f0
    s_waitcnt vmcnt(11)
    s_waitcnt vmcnt(10)
    s_barrier
    ds_read_b128 v[128:131], v96 offset:0
    ds_read_b64_tr_b16 v[32:33], v104 offset:0
    ds_read_b64_tr_b16 v[34:35], v104 offset:512
    ds_read_b128 v[132:135], v97 offset:0
    ds_read_b128 v[136:139], v98 offset:0
    ds_read_b128 v[140:143], v99 offset:0
    ds_read_b64_tr_b16 v[36:37], v105 offset:0
    ds_read_b64_tr_b16 v[38:39], v105 offset:512
    ds_read_b64_tr_b16 v[40:41], v106 offset:0
    ds_read_b64_tr_b16 v[42:43], v106 offset:512
    ds_read_b64_tr_b16 v[44:45], v107 offset:0
    ds_read_b64_tr_b16 v[46:47], v107 offset:512
    s_waitcnt lgkmcnt(9)
    v_mfma_f32_16x16x32_bf16 v[16:19], v[12:15], v[32:35], 0
    v_mfma_f32_32x32x16_bf16 v[48:63], v[32:35], v[128:131], 0
    s_waitcnt lgkmcnt(4)
    v_mfma_f32_16x16x32_bf16 v[20:23], v[12:15], v[136:139], 0
    v_mfma_f32_32x32x16_bf16 v[48:63], v[36:39], v[132:135], v[48:63]
    s_waitcnt lgkmcnt(2)
    v_mfma_f32_16x16x32_bf16 v[20:23], v[12:15], v[140:143], v[20:23]
    v_mfma_f32_32x32x16_bf16 v[48:63], v[40:43], v[136:139], v[48:63]
    s_add_u32 s41, s36, 2
    s_and_b32 s41, s41, 7
    s_add_u32 m0, s39, 144000
    s_mul_i32 s43, s41, 196608
    buffer_load_dwordx4 v81, s[12:15], s43 offen lds
    s_add_u32 s41, s36, 3
    s_and_b32 s41, s41, 7
    s_add_u32 m0, s38, 103040
    s_lshl_b32 s42, s41, 7
    buffer_load_dwordx4 v80, s[8:11], s42 offen lds
    s_add_u32 s42, s42, 14336
    buffer_load_dwordx4 v80, s[8:11], s42 offen offset:2048 lds
    s_waitcnt vmcnt(11)
    s_waitcnt vmcnt(9)
    s_waitcnt vmcnt(7)
    s_barrier
    ds_read_b128 v[144:147], v96 offset:20608
    ds_read_b64_tr_b16 v[40:41], v104 offset:45184
    ds_read_b64_tr_b16 v[42:43], v104 offset:45696
    ds_read_b128 v[148:151], v97 offset:20608
    ds_read_b128 v[152:155], v98 offset:20608
    ds_read_b128 v[156:159], v99 offset:20608
    s_waitcnt lgkmcnt(6)
    v_mfma_f32_32x32x16_bf16 v[48:63], v[44:47], v[140:143], v[48:63]
    s_add_u32 s41, s36, 3
    s_and_b32 s41, s41, 7
    s_add_u32 m0, s39, 135808
    s_mul_i32 s43, s41, 196608
    buffer_load_dwordx4 v81, s[12:15], s43 offen lds
    ds_read_b128 v[168:171], v102 offset:16384
    ds_read_b128 v[172:175], v103 offset:16384
    ds_read_b64_tr_b16 v[44:45], v105 offset:45184
    ds_read_b64_tr_b16 v[46:47], v105 offset:45696
    v_mfma_f32_32x32x16_bf16 v[112:127], v[136:139], v[136:139], 0
    s_add_u32 s41, s36, 4
    s_and_b32 s41, s41, 7
    s_add_u32 m0, s38, 66048
    s_lshl_b32 s42, s41, 7
    buffer_load_dwordx4 v80, s[8:11], s42 offen lds
    ds_read_b128 v[160:163], v100 offset:16384
    ds_read_b128 v[164:167], v101 offset:16384
    ds_read_b64_tr_b16 v[32:33], v106 offset:45184
    ds_read_b64_tr_b16 v[34:35], v106 offset:45696
    v_mfma_f32_32x32x16_bf16 v[112:127], v[140:143], v[140:143], v[112:127]
    s_add_u32 s42, s42, 14336
    buffer_load_dwordx4 v80, s[8:11], s42 offen offset:2048 lds
    ds_read_b64_tr_b16 v[36:37], v107 offset:45184
    ds_read_b64_tr_b16 v[38:39], v107 offset:45696
    s_waitcnt lgkmcnt(13)
    v_mfma_f32_16x16x32_bf16 v[16:19], v[12:15], v[40:43], v[16:19]
    v_mfma_f32_32x32x16_bf16 v[48:63], v[40:43], v[144:147], v[48:63]
    s_waitcnt lgkmcnt(6)
    v_mfma_f32_16x16x32_bf16 v[20:23], v[12:15], v[152:155], v[20:23]
    v_mfma_f32_32x32x16_bf16 v[48:63], v[44:47], v[148:151], v[48:63]
    s_waitcnt lgkmcnt(2)
    v_mfma_f32_16x16x32_bf16 v[20:23], v[12:15], v[156:159], v[20:23]
    v_mfma_f32_32x32x16_bf16 v[48:63], v[32:35], v[152:155], v[48:63]
    s_waitcnt vmcnt(5)
    s_waitcnt vmcnt(3)
    s_barrier
    ds_read_b64_tr_b16 v[32:33], v108 offset:61568
    ds_read_b64_tr_b16 v[34:35], v108 offset:62080
    s_waitcnt lgkmcnt(2)
    v_mfma_f32_16x16x32_bf16 v[20:23], v[12:15], v[168:171], v[20:23]
    v_mfma_f32_32x32x16_bf16 v[48:63], v[36:39], v[156:159], v[48:63]
    v_mov_b32 v95, s100
    s_add_u32 s41, s36, 4
    s_and_b32 s41, s41, 7
    s_add_u32 m0, s39, 12416
    s_mul_i32 s43, s41, 196608
    buffer_load_dwordx4 v81, s[12:15], s43 offen lds
    ds_read_b128 v[184:187], v102 offset:0
    ds_read_b128 v[188:191], v103 offset:0
    ds_read_b64_tr_b16 v[36:37], v109 offset:61568
    ds_read_b64_tr_b16 v[38:39], v109 offset:62080
    v_mfma_f32_16x16x32_bf16 v[20:23], v[12:15], v[172:175], v[20:23]
    v_mfma_f32_32x32x16_bf16 v[112:127], v[152:155], v[152:155], v[112:127]
    s_add_u32 s41, s36, 5
    s_and_b32 s41, s41, 7
    s_add_u32 m0, s38, 82432
    s_lshl_b32 s42, s41, 7
    buffer_load_dwordx4 v80, s[8:11], s42 offen lds
    ds_read_b128 v[176:179], v100 offset:0
    ds_read_b128 v[180:183], v101 offset:0
    ds_read_b64_tr_b16 v[40:41], v110 offset:61568
    ds_read_b64_tr_b16 v[42:43], v110 offset:62080
    s_waitcnt lgkmcnt(7)
    v_mfma_f32_16x16x32_bf16 v[20:23], v[12:15], v[184:187], v[20:23]
    v_mfma_f32_32x32x16_bf16 v[112:127], v[156:159], v[156:159], v[112:127]
    s_add_u32 s42, s42, 14336
    buffer_load_dwordx4 v80, s[8:11], s42 offen offset:2048 lds
    ds_write_b32 v92, v91
    ds_read_b64_tr_b16 v[44:45], v111 offset:61568
    ds_read_b64_tr_b16 v[46:47], v111 offset:62080
    v_mfma_f32_16x16x32_bf16 v[16:19], v[12:15], v[32:35], v[16:19]
    v_mfma_f32_32x32x16_bf16 v[48:63], v[32:35], v[160:163], v[48:63]
    v_xor_b32 v91, 0x80008000, v91
    ds_write_b32 v92, v91 offset:2048
    s_waitcnt lgkmcnt(8)
    v_mfma_f32_16x16x32_bf16 v[20:23], v[12:15], v[188:191], v[20:23]
    v_mfma_f32_32x32x16_bf16 v[48:63], v[36:39], v[164:167], v[48:63]
    s_waitcnt lgkmcnt(4)
    v_mfma_f32_32x32x16_bf16 v[48:63], v[40:43], v[168:171], v[48:63]
    s_waitcnt lgkmcnt(1)
    v_mfma_f32_32x32x16_bf16 v[48:63], v[44:47], v[172:175], v[48:63]
    v_mfma_f32_32x32x16_bf16 v[112:127], v[168:171], v[168:171], v[112:127]
    s_waitcnt vmcnt(5)
    s_waitcnt vmcnt(3)
    s_barrier
    ds_read_b64_tr_b16 v[32:33], v108 offset:53376
    ds_read_b64_tr_b16 v[34:35], v108 offset:53888
    v_mfma_f32_32x32x16_bf16 v[112:127], v[172:175], v[172:175], v[112:127]
    s_add_u32 s41, s36, 5
    s_and_b32 s41, s41, 7
    s_add_u32 m0, s39, 57600
    s_mul_i32 s43, s41, 196608
    buffer_load_dwordx4 v81, s[12:15], s43 offen lds
    ds_read_b128 v[200:203], v98 offset:45440
    ds_read_b128 v[204:207], v99 offset:45440
    ds_read_b64_tr_b16 v[36:37], v109 offset:53376
    ds_read_b64_tr_b16 v[38:39], v109 offset:53888
    v_mfma_f32_32x32x16_bf16 v[112:127], v[184:187], v[184:187], v[112:127]
    s_add_u32 s41, s36, 6
    s_and_b32 s41, s41, 7
    s_add_u32 m0, s38, 119424
    s_lshl_b32 s42, s41, 7
    buffer_load_dwordx4 v80, s[8:11], s42 offen lds
    ds_read_b128 v[192:195], v96 offset:45440
    ds_read_b128 v[196:199], v97 offset:45440
    ds_read_b64_tr_b16 v[40:41], v110 offset:53376
    ds_read_b64_tr_b16 v[42:43], v110 offset:53888
    s_waitcnt lgkmcnt(7)
    v_mfma_f32_16x16x32_bf16 v[20:23], v[12:15], v[200:203], v[20:23]
    v_mfma_f32_32x32x16_bf16 v[112:127], v[188:191], v[188:191], v[112:127]
    s_add_u32 s42, s42, 14336
    buffer_load_dwordx4 v80, s[8:11], s42 offen offset:2048 lds
    ds_read_b64_tr_b16 v[44:45], v111 offset:53376
    ds_read_b64_tr_b16 v[46:47], v111 offset:53888
    v_mfma_f32_16x16x32_bf16 v[16:19], v[12:15], v[32:35], v[16:19]
    v_mfma_f32_32x32x16_bf16 v[48:63], v[32:35], v[176:179], v[48:63]
    s_waitcnt lgkmcnt(6)
    v_mfma_f32_16x16x32_bf16 v[20:23], v[12:15], v[204:207], v[20:23]
    v_mfma_f32_32x32x16_bf16 v[48:63], v[36:39], v[180:183], v[48:63]
    s_waitcnt lgkmcnt(2)
    v_mfma_f32_32x32x16_bf16 v[48:63], v[40:43], v[184:187], v[48:63]
    s_waitcnt vmcnt(5)
    s_waitcnt vmcnt(3)
    s_barrier
    ds_read_b64_tr_b16 v[40:41], v104 offset:0
    ds_read_b64_tr_b16 v[42:43], v104 offset:512
    s_waitcnt lgkmcnt(2)
    v_mfma_f32_32x32x16_bf16 v[48:63], v[44:47], v[188:191], v[48:63]
    s_add_u32 s41, s36, 6
    s_and_b32 s41, s41, 7
    s_add_u32 m0, s39, 144000
    s_mul_i32 s43, s41, 196608
    buffer_load_dwordx4 v81, s[12:15], s43 offen lds
    ds_read_b128 v[216:219], v98 offset:61824
    ds_read_b128 v[220:223], v99 offset:61824
    ds_read_b64_tr_b16 v[44:45], v105 offset:0
    ds_read_b64_tr_b16 v[46:47], v105 offset:512
    v_mfma_f32_32x32x16_bf16 v[112:127], v[200:203], v[200:203], v[112:127]
    s_add_u32 s41, s36, 7
    s_and_b32 s41, s41, 7
    s_add_u32 m0, s38, 103040
    s_lshl_b32 s42, s41, 7
    buffer_load_dwordx4 v80, s[8:11], s42 offen lds
    ds_read_b128 v[208:211], v96 offset:61824
    ds_read_b128 v[212:215], v97 offset:61824
    ds_read_b64_tr_b16 v[32:33], v106 offset:0
    ds_read_b64_tr_b16 v[34:35], v106 offset:512
    s_waitcnt lgkmcnt(7)
    v_mfma_f32_16x16x32_bf16 v[20:23], v[12:15], v[216:219], v[20:23]
    v_mfma_f32_32x32x16_bf16 v[112:127], v[204:207], v[204:207], v[112:127]
    s_add_u32 s42, s42, 14336
    buffer_load_dwordx4 v80, s[8:11], s42 offen offset:2048 lds
    ds_read_b64_tr_b16 v[36:37], v107 offset:0
    ds_read_b64_tr_b16 v[38:39], v107 offset:512
    v_mfma_f32_16x16x32_bf16 v[16:19], v[12:15], v[40:43], v[16:19]
    v_mfma_f32_32x32x16_bf16 v[48:63], v[40:43], v[192:195], v[48:63]
    s_add_u32 s41, s36, 0
    s_and_b32 s41, s41, 7
    s_add_u32 m0, s39, 19584
    s_mul_i32 s43, s41, 196608
    buffer_load_dwordx4 v81, s[12:15], s43 offen offset:1024 lds
    s_waitcnt lgkmcnt(6)
    v_mfma_f32_16x16x32_bf16 v[20:23], v[12:15], v[220:223], v[20:23]
    v_mfma_f32_32x32x16_bf16 v[48:63], v[44:47], v[196:199], v[48:63]
    s_waitcnt lgkmcnt(2)
    v_mfma_f32_32x32x16_bf16 v[48:63], v[32:35], v[200:203], v[48:63]
    s_waitcnt vmcnt(6)
    s_waitcnt vmcnt(4)
    s_barrier
    ds_read_b64_tr_b16 v[32:33], v104 offset:45184
    ds_read_b64_tr_b16 v[34:35], v104 offset:45696
    s_waitcnt lgkmcnt(2)
    v_mfma_f32_32x32x16_bf16 v[48:63], v[36:39], v[204:207], v[48:63]
    s_add_u32 s41, s36, 7
    s_and_b32 s41, s41, 7
    s_add_u32 m0, s39, 135808
    s_mul_i32 s43, s41, 196608
    buffer_load_dwordx4 v81, s[12:15], s43 offen lds
    ds_read_b128 v[232:235], v102 offset:16384
    ds_read_b128 v[236:239], v103 offset:16384
    ds_read_b64_tr_b16 v[36:37], v105 offset:45184
    ds_read_b64_tr_b16 v[38:39], v105 offset:45696
    v_mfma_f32_32x32x16_bf16 v[112:127], v[216:219], v[216:219], v[112:127]
    s_add_u32 s41, s36, 1
    s_and_b32 s41, s41, 7
    s_add_u32 m0, s39, 27776
    s_mul_i32 s43, s41, 196608
    buffer_load_dwordx4 v81, s[12:15], s43 offen offset:1024 lds
    ds_read_b128 v[224:227], v100 offset:16384
    ds_read_b128 v[228:231], v101 offset:16384
    ds_read_b64_tr_b16 v[40:41], v106 offset:45184
    ds_read_b64_tr_b16 v[42:43], v106 offset:45696
    s_waitcnt lgkmcnt(7)
    v_mfma_f32_16x16x32_bf16 v[20:23], v[12:15], v[232:235], v[20:23]
    v_mfma_f32_32x32x16_bf16 v[112:127], v[220:223], v[220:223], v[112:127]
    s_add_u32 s41, s36, 2
    s_and_b32 s41, s41, 7
    s_add_u32 m0, s39, 40192
    s_mul_i32 s43, s41, 196608
    buffer_load_dwordx4 v81, s[12:15], s43 offen offset:1024 lds
    ds_read_b64_tr_b16 v[44:45], v107 offset:45184
    ds_read_b64_tr_b16 v[46:47], v107 offset:45696
    v_mfma_f32_16x16x32_bf16 v[16:19], v[12:15], v[32:35], v[16:19]
    v_mfma_f32_32x32x16_bf16 v[48:63], v[32:35], v[208:211], v[48:63]
    s_waitcnt lgkmcnt(6)
    v_mfma_f32_16x16x32_bf16 v[20:23], v[12:15], v[236:239], v[20:23]
    v_mfma_f32_32x32x16_bf16 v[48:63], v[36:39], v[212:215], v[48:63]
    s_waitcnt lgkmcnt(2)
    v_mfma_f32_32x32x16_bf16 v[48:63], v[40:43], v[216:219], v[48:63]
    s_waitcnt vmcnt(6)
    s_waitcnt vmcnt(4)
    s_barrier
    ds_read_b64_tr_b16 v[40:41], v108 offset:61568
    ds_read_b64_tr_b16 v[42:43], v108 offset:62080
    s_waitcnt lgkmcnt(2)
    v_mfma_f32_32x32x16_bf16 v[48:63], v[44:47], v[220:223], v[48:63]
    s_add_u32 s41, s36, 3
    s_and_b32 s41, s41, 7
    s_add_u32 m0, s39, 48384
    s_mul_i32 s43, s41, 196608
    buffer_load_dwordx4 v81, s[12:15], s43 offen offset:1024 lds
    ds_read_b128 v[248:251], v102 offset:0
    ds_read_b128 v[252:255], v103 offset:0
    v_mfma_f32_32x32x16_bf16 v[112:127], v[232:235], v[232:235], v[112:127]
    s_add_u32 s41, s36, 4
    s_and_b32 s41, s41, 7
    s_add_u32 m0, s39, 65024
    s_mul_i32 s43, s41, 196608
    buffer_load_dwordx4 v81, s[12:15], s43 offen offset:1024 lds
    ds_read_b128 v[240:243], v100 offset:0
    ds_read_b128 v[244:247], v101 offset:0
    s_waitcnt lgkmcnt(3)
    v_mfma_f32_16x16x32_bf16 v[20:23], v[12:15], v[248:251], v[20:23]
    v_mfma_f32_32x32x16_bf16 v[112:127], v[236:239], v[236:239], v[112:127]
    s_add_u32 s41, s36, 5
    s_and_b32 s41, s41, 7
    s_add_u32 m0, s39, 73216
    s_mul_i32 s43, s41, 196608
    buffer_load_dwordx4 v81, s[12:15], s43 offen offset:1024 lds
    ds_read_b64_tr_b16 v[36:37], v109 offset:61568
    ds_read_b64_tr_b16 v[38:39], v109 offset:62080
    v_mfma_f32_16x16x32_bf16 v[16:19], v[12:15], v[40:43], v[16:19]
    v_mfma_f32_32x32x16_bf16 v[48:63], v[40:43], v[224:227], v[48:63]
    ds_read_b64_tr_b16 v[40:41], v110 offset:61568
    ds_read_b64_tr_b16 v[42:43], v110 offset:62080
    s_waitcnt lgkmcnt(6)
    v_mfma_f32_16x16x32_bf16 v[20:23], v[12:15], v[252:255], v[20:23]
    v_mfma_f32_32x32x16_bf16 v[112:127], v[248:251], v[248:251], v[112:127]
    ds_read_b64_tr_b16 v[44:45], v111 offset:61568
    ds_read_b64_tr_b16 v[46:47], v111 offset:62080
    v_mfma_f32_32x32x16_bf16 v[112:127], v[252:255], v[252:255], v[112:127]
    s_nop 3
    v_mov_b32 v83, v20
    s_waitcnt vmcnt(5)
    s_barrier
    ds_read_b64_tr_b16 v[32:33], v108 offset:53376
    ds_read_b64_tr_b16 v[34:35], v108 offset:53888
    s_waitcnt lgkmcnt(6)
    v_mfma_f32_32x32x16_bf16 v[48:63], v[36:39], v[228:231], v[48:63]
    s_add_u32 s41, s36, 6
    s_and_b32 s41, s41, 7
    s_add_u32 m0, s39, 81408
    s_mul_i32 s43, s41, 196608
    buffer_load_dwordx4 v81, s[12:15], s43 offen offset:1024 lds
    ds_read_b64_tr_b16 v[36:37], v109 offset:53376
    ds_read_b64_tr_b16 v[38:39], v109 offset:53888
    s_waitcnt lgkmcnt(6)
    v_mfma_f32_32x32x16_bf16 v[48:63], v[40:43], v[232:235], v[48:63]
    v_cndmask_b32 v112, v112, v113, s[0:1]
    v_cndmask_b32 v114, v114, v115, s[0:1]
    v_cndmask_b32 v116, v116, v117, s[0:1]
    v_cndmask_b32 v118, v118, v119, s[0:1]
    v_cndmask_b32 v120, v120, v121, s[0:1]
    v_cndmask_b32 v122, v122, v123, s[0:1]
    s_add_u32 s41, s36, 7
    s_and_b32 s41, s41, 7
    s_add_u32 m0, s39, 89600
    s_mul_i32 s43, s41, 196608
    buffer_load_dwordx4 v81, s[12:15], s43 offen offset:1024 lds
    s_mov_b32 s12, s46
    s_mov_b32 s13, s47
    s_mov_b32 s14, 2097152
    s_mov_b32 s46, 524288
    s_mov_b32 s47, 0x20000
    ds_read_b64_tr_b16 v[40:41], v110 offset:53376
    ds_read_b64_tr_b16 v[42:43], v110 offset:53888
    s_waitcnt lgkmcnt(6)
    v_mfma_f32_32x32x16_bf16 v[48:63], v[44:47], v[236:239], v[48:63]
    v_cndmask_b32 v124, v124, v125, s[0:1]
    v_cndmask_b32 v126, v126, v127, s[0:1]
    v_cndmask_b32 v112, v112, v114, s[28:29]
    v_cndmask_b32 v116, v116, v118, s[28:29]
    v_cndmask_b32 v120, v120, v122, s[28:29]
    v_cndmask_b32 v124, v124, v126, s[28:29]
    s_add_u32 s41, s36, 8
    s_and_b32 s41, s41, 7
    s_add_u32 m0, s40, 0
    s_mul_i32 s43, s41, 176128
    buffer_load_dwordx4 v1, s[20:23], s43 offen lds
    ds_read_b64_tr_b16 v[44:45], v111 offset:53376
    ds_read_b64_tr_b16 v[46:47], v111 offset:53888
    s_waitcnt lgkmcnt(6)
    v_mfma_f32_16x16x32_bf16 v[16:19], v[12:15], v[32:35], v[16:19]
    v_mfma_f32_32x32x16_bf16 v[48:63], v[32:35], v[240:243], v[48:63]
    v_cndmask_b32 v112, v112, v116, s[30:31]
    v_cndmask_b32 v120, v120, v124, s[30:31]
    v_cndmask_b32 v112, v112, v120, s[16:17]
    v_cndmask_b32 v84, 0, v112, s[18:19]
    s_nop 1
    v_permlane32_swap_b32 v83, v84
    v_add_f32 v83, v83, v84
    buffer_load_dwordx4 v2, s[20:23], s43 offen offset:1024 lds
    ds_write_b32 v89, v83
    ds_read_b64_tr_b16 v[32:33], v104 offset:8192
    ds_read_b64_tr_b16 v[34:35], v104 offset:8704
    s_waitcnt lgkmcnt(7)
    v_mfma_f32_32x32x16_bf16 v[48:63], v[36:39], v[244:247], v[48:63]
    v_and_b32 v85, s55, v16
    v_sub_f32 v86, v16, v85
    v_cvt_pk_bf16_f32 v85, v85, v86
    s_mov_b32 exec_hi, 0
    buffer_load_dwordx4 v3, s[20:23], s43 offen offset:2048 lds
    s_mov_b32 exec_hi, -1
    ds_write_b32 v94, v85 offset:34432
    ds_read_b64_tr_b16 v[36:37], v105 offset:8192
    ds_read_b64_tr_b16 v[38:39], v105 offset:8704
    s_waitcnt lgkmcnt(8)
    v_mfma_f32_32x32x16_bf16 v[48:63], v[40:43], v[248:251], v[48:63]
    s_cmp_eq_u32 s37, 0
    s_cselect_b32 exec_lo, 1, 0
    s_mov_b32 exec_hi, 0
    s_and_b32 s59, s2, 7
    s_lshl_b32 s59, s59, 5
    buffer_atomic_add v95, off, s[4:7], s59 sc1
    s_mov_b64 exec, -1
    s_waitcnt vmcnt(10)
    s_waitcnt vmcnt(9)
    s_waitcnt lgkmcnt(2)
    s_barrier
    ds_read_b128 v[8:11], v90
    ds_read_b64_tr_b16 v[40:41], v106 offset:8192
    ds_read_b64_tr_b16 v[42:43], v106 offset:8704
    v_mfma_f32_32x32x16_bf16 v[48:63], v[44:47], v[252:255], v[48:63]
    ds_read_b128 v[44:47], v0 offset:34432
    v_mfma_f32_16x16x32_bf16 v[18:21], v[12:15], v[32:35], v[18:21]
    v_mfma_f32_32x32x16_bf16 v[64:79], v[32:35], v[128:131], 0
    ds_read_b64_tr_b16 v[32:33], v107 offset:8192
    ds_read_b64_tr_b16 v[34:35], v107 offset:8704
    s_waitcnt lgkmcnt(5)
    v_mfma_f32_32x32x16_bf16 v[64:79], v[36:39], v[132:135], v[64:79]
    v_add_f32 v8, v8, v10
    v_add_f32 v24, v9, v11
    v_mul_f32 v25, 0xbb000000, v8
    v_mul_f32 v24, 0x3b000000, v24
    v_cvt_pk_bf16_f32 v8, v25, v25
    v_cvt_pk_bf16_f32 v9, v25, v25
    v_cvt_pk_bf16_f32 v10, v25, v25
    ds_read_b64_tr_b16 v[36:37], v104 offset:16384
    ds_read_b64_tr_b16 v[38:39], v104 offset:16896
    s_waitcnt lgkmcnt(5)
    v_mfma_f32_32x32x16_bf16 v[64:79], v[40:43], v[136:139], v[64:79]
    v_cvt_pk_bf16_f32 v11, v25, v25
    v_fma_f32 v24, -v25, v25, v24
    v_max_f32 v24, 0, v24
    v_add_f32 v24, 0x3727c5ac, v24
    v_rsq_f32 v26, v24
    ds_read_b64_tr_b16 v[40:41], v27 offset:0
    ds_read_b64_tr_b16 v[42:43], v27 offset:128
    s_waitcnt lgkmcnt(6)
    v_mfma_f32_32x32x16_bf16 v[48:63], v[44:47], v[8:11], v[48:63]
    v_mul_f32 v25, v24, v26
    v_mul_f32 v24, 0xbfb8aa3b, v26
    ds_read_b64_tr_b16 v[44:45], v27 offset:512
    ds_read_b64_tr_b16 v[46:47], v27 offset:640
    s_waitcnt lgkmcnt(6)
    v_mfma_f32_32x32x16_bf16 v[64:79], v[32:35], v[140:143], v[64:79]
    ds_read_b64_tr_b16 v[32:33], v105 offset:16384
    ds_read_b64_tr_b16 v[34:35], v105 offset:16896
    s_waitcnt lgkmcnt(6)
    v_mfma_f32_16x16x32_bf16 v[18:21], v[12:15], v[36:39], v[18:21]
    v_mfma_f32_32x32x16_bf16 v[64:79], v[36:39], v[144:147], v[64:79]
    s_nop 0
    v_cvt_pk_bf16_f32 v96, v48, v49
    v_cvt_pk_bf16_f32 v97, v50, v51
    v_cvt_pk_bf16_f32 v98, v52, v53
    v_cvt_pk_bf16_f32 v99, v54, v55
    v_cvt_pk_bf16_f32 v100, v56, v57
    v_cvt_pk_bf16_f32 v101, v58, v59
    v_cvt_pk_bf16_f32 v102, v60, v61
    ds_read_b64_tr_b16 v[36:37], v106 offset:16384
    ds_read_b64_tr_b16 v[38:39], v106 offset:16896
    s_waitcnt lgkmcnt(6)
    v_mfma_f32_32x32x16_bf16 v[112:127], v[40:43], v[96:99], 0
    v_cvt_pk_bf16_f32 v103, v62, v63
    ds_read_b64_tr_b16 v[40:41], v107 offset:16384
    ds_read_b64_tr_b16 v[42:43], v107 offset:16896
    s_waitcnt lgkmcnt(6)
    v_mfma_f32_32x32x16_bf16 v[48:63], v[44:47], v[100:103], 0
    ds_read_b64_tr_b16 v[44:45], v104 offset:28800
    ds_read_b64_tr_b16 v[46:47], v104 offset:29312
    s_waitcnt lgkmcnt(6)
    v_mfma_f32_32x32x16_bf16 v[64:79], v[32:35], v[148:151], v[64:79]
    s_nop 2
    v_max_f32 v87, v112, v113
    v_max_f32 v88, v114, v115
    v_max3_f32 v87, v87, v116, v117
    v_max3_f32 v88, v88, v118, v119
    v_max3_f32 v87, v87, v120, v121
    v_max3_f32 v88, v88, v122, v123
    v_max3_f32 v87, v87, v124, v125
    ds_read_b64_tr_b16 v[32:33], v105 offset:28800
    ds_read_b64_tr_b16 v[34:35], v105 offset:29312
    s_waitcnt lgkmcnt(6)
    v_mfma_f32_32x32x16_bf16 v[64:79], v[36:39], v[152:155], v[64:79]
    v_max_f32 v31, v48, v49
    v_max_f32 v27, v50, v51
    v_max3_f32 v88, v88, v126, v127
    v_max_f32 v87, v87, v88
    v_mul_f32 v87, v87, v24
    v_fma_f32 v112, v112, -v24, v87
    v_fma_f32 v113, v113, -v24, v87
    ds_read_b64_tr_b16 v[36:37], v106 offset:28800
    ds_read_b64_tr_b16 v[38:39], v106 offset:29312
    s_waitcnt lgkmcnt(6)
    v_mfma_f32_32x32x16_bf16 v[64:79], v[40:43], v[156:159], v[64:79]
    v_exp_f32 v112, v112
    v_fma_f32 v114, v114, -v24, v87
    v_fma_f32 v115, v115, -v24, v87
    v_fma_f32 v116, v116, -v24, v87
    v_fma_f32 v117, v117, -v24, v87
    v_fma_f32 v118, v118, -v24, v87
    ds_read_b64_tr_b16 v[40:41], v107 offset:28800
    ds_read_b64_tr_b16 v[42:43], v107 offset:29312
    s_waitcnt lgkmcnt(6)
    v_mfma_f32_16x16x32_bf16 v[18:21], v[12:15], v[44:47], v[18:21]
    v_mfma_f32_32x32x16_bf16 v[64:79], v[44:47], v[160:163], v[64:79]
    v_exp_f32 v113, v113
    v_fma_f32 v119, v119, -v24, v87
    v_fma_f32 v120, v120, -v24, v87
    v_fma_f32 v121, v121, -v24, v87
    v_fma_f32 v122, v122, -v24, v87
    s_waitcnt vmcnt(8)
    s_waitcnt vmcnt(7)
    s_waitcnt vmcnt(6)
    s_barrier
    ds_read_b64_tr_b16 v[44:45], v104 offset:36992
    ds_read_b64_tr_b16 v[46:47], v104 offset:37504
    s_waitcnt lgkmcnt(6)
    v_mfma_f32_32x32x16_bf16 v[64:79], v[32:35], v[164:167], v[64:79]
    v_exp_f32 v114, v114
    v_fma_f32 v123, v123, -v24, v87
    v_fma_f32 v124, v124, -v24, v87
    v_fma_f32 v125, v125, -v24, v87
    v_fma_f32 v126, v126, -v24, v87
    v_fma_f32 v127, v127, -v24, v87
    ds_read_b64_tr_b16 v[32:33], v105 offset:36992
    ds_read_b64_tr_b16 v[34:35], v105 offset:37504
    s_waitcnt lgkmcnt(6)
    v_mfma_f32_32x32x16_bf16 v[64:79], v[36:39], v[168:171], v[64:79]
    v_add_f32 v88, v112, v113
    v_exp_f32 v115, v115
    v_add_f32 v88, v88, v114
    v_exp_f32 v116, v116
    v_add_f32 v88, v88, v115
    ds_read_b64_tr_b16 v[36:37], v106 offset:36992
    ds_read_b64_tr_b16 v[38:39], v106 offset:37504
    s_waitcnt lgkmcnt(6)
    v_mfma_f32_32x32x16_bf16 v[64:79], v[40:43], v[172:175], v[64:79]
    v_exp_f32 v117, v117
    v_add_f32 v88, v88, v116
    v_exp_f32 v118, v118
    v_add_f32 v88, v88, v117
    v_add_f32 v88, v88, v118
    s_add_u32 s41, s36, 9
    s_and_b32 s41, s41, 7
    s_add_u32 m0, s40, 20608
    s_mul_i32 s43, s41, 176128
    buffer_load_dwordx4 v1, s[20:23], s43 offen lds
    ds_read_b64_tr_b16 v[40:41], v107 offset:36992
    ds_read_b64_tr_b16 v[42:43], v107 offset:37504
    s_waitcnt lgkmcnt(6)
    v_mfma_f32_16x16x32_bf16 v[18:21], v[12:15], v[44:47], v[18:21]
    v_mfma_f32_32x32x16_bf16 v[64:79], v[44:47], v[176:179], v[64:79]
    v_exp_f32 v119, v119
    v_exp_f32 v120, v120
    v_add_f32 v88, v88, v119
    v_exp_f32 v121, v121
    ds_read_b64_tr_b16 v[44:45], v104 offset:53632
    ds_read_b64_tr_b16 v[46:47], v104 offset:54144
    s_waitcnt lgkmcnt(6)
    v_mfma_f32_32x32x16_bf16 v[64:79], v[32:35], v[180:183], v[64:79]
    v_add_f32 v88, v88, v120
    v_exp_f32 v122, v122
    v_add_f32 v88, v88, v121
    v_exp_f32 v123, v123
    v_add_f32 v88, v88, v122
    ds_read_b64_tr_b16 v[32:33], v105 offset:53632
    ds_read_b64_tr_b16 v[34:35], v105 offset:54144
    s_waitcnt lgkmcnt(6)
    v_mfma_f32_32x32x16_bf16 v[64:79], v[36:39], v[184:187], v[64:79]
    v_exp_f32 v124, v124
    v_add_f32 v88, v88, v123
    v_exp_f32 v125, v125
    v_add_f32 v88, v88, v124
    v_add_f32 v88, v88, v125
    ds_read_b64_tr_b16 v[36:37], v106 offset:53632
    ds_read_b64_tr_b16 v[38:39], v106 offset:54144
    s_waitcnt lgkmcnt(6)
    v_mfma_f32_32x32x16_bf16 v[64:79], v[40:43], v[188:191], v[64:79]
    v_exp_f32 v126, v126
    v_exp_f32 v127, v127
    v_add_f32 v88, v88, v126
    v_add_f32 v88, v88, v127
    v_max3_f32 v31, v31, v52, v53
    buffer_load_dwordx4 v2, s[20:23], s43 offen offset:1024 lds
    ds_read_b64_tr_b16 v[40:41], v107 offset:53632
    ds_read_b64_tr_b16 v[42:43], v107 offset:54144
    s_waitcnt lgkmcnt(6)
    v_mfma_f32_16x16x32_bf16 v[18:21], v[12:15], v[44:47], v[18:21]
    v_mfma_f32_32x32x16_bf16 v[64:79], v[44:47], v[192:195], v[64:79]
    v_rcp_f32 v88, v88
    v_max3_f32 v27, v27, v54, v55
    v_mul_f32 v112, v112, v88
    v_mul_f32 v113, v113, v88
    v_cvt_pk_bf16_f32 v112, v112, v113
    v_mul_f32 v114, v114, v88
    ds_read_b64_tr_b16 v[44:45], v104 offset:61824
    ds_read_b64_tr_b16 v[46:47], v104 offset:62336
    s_waitcnt lgkmcnt(6)
    v_mfma_f32_32x32x16_bf16 v[64:79], v[32:35], v[196:199], v[64:79]
    v_mul_f32 v115, v115, v88
    v_cvt_pk_bf16_f32 v113, v114, v115
    v_mul_f32 v116, v116, v88
    v_mul_f32 v117, v117, v88
    v_cvt_pk_bf16_f32 v114, v116, v117
    v_mul_f32 v118, v118, v88
    v_mul_f32 v119, v119, v88
    ds_read_b64_tr_b16 v[32:33], v105 offset:61824
    ds_read_b64_tr_b16 v[34:35], v105 offset:62336
    s_waitcnt lgkmcnt(6)
    v_mfma_f32_32x32x16_bf16 v[64:79], v[36:39], v[200:203], v[64:79]
    v_cvt_pk_bf16_f32 v115, v118, v119
    v_mul_f32 v120, v120, v88
    v_mul_f32 v121, v121, v88
    v_cvt_pk_bf16_f32 v116, v120, v121
    v_mul_f32 v122, v122, v88
    v_mul_f32 v123, v123, v88
    v_cvt_pk_bf16_f32 v117, v122, v123
    ds_read_b64_tr_b16 v[36:37], v106 offset:61824
    ds_read_b64_tr_b16 v[38:39], v106 offset:62336
    s_waitcnt lgkmcnt(6)
    v_mfma_f32_32x32x16_bf16 v[64:79], v[40:43], v[204:207], v[64:79]
    ds_write_b128 v28, v[112:115] offset:0
    v_xor_b32 v28, 16, v28
    v_mul_f32 v124, v124, v88
    v_mul_f32 v125, v125, v88
    v_cvt_pk_bf16_f32 v118, v124, v125
    v_mul_f32 v126, v126, v88
    v_mul_f32 v127, v127, v88
    v_cvt_pk_bf16_f32 v119, v126, v127
    s_mov_b32 exec_hi, 0
    buffer_load_dwordx4 v3, s[20:23], s43 offen offset:2048 lds
    s_mov_b32 exec_hi, -1
    ds_read_b64_tr_b16 v[40:41], v107 offset:61824
    ds_read_b64_tr_b16 v[42:43], v107 offset:62336
    s_waitcnt lgkmcnt(7)
    v_mfma_f32_16x16x32_bf16 v[18:21], v[12:15], v[44:47], v[18:21]
    v_mfma_f32_32x32x16_bf16 v[64:79], v[44:47], v[208:211], v[64:79]
    ds_write_b128 v28, v[116:119] offset:0
    v_xor_b32 v28, 16, v28
    v_max3_f32 v31, v31, v56, v57
    v_max3_f32 v27, v27, v58, v59
    v_max3_f32 v31, v31, v60, v61
    v_max3_f32 v27, v27, v62, v63
    s_waitcnt vmcnt(8)
    s_waitcnt vmcnt(7)
    s_barrier
    ds_read_b64_tr_b16 v[44:45], v108 offset:0
    ds_read_b64_tr_b16 v[46:47], v108 offset:512
    s_waitcnt lgkmcnt(8)
    v_mfma_f32_32x32x16_bf16 v[64:79], v[32:35], v[212:215], v[64:79]
    v_max_f32 v31, v31, v27
    v_mul_f32 v31, v31, v24
    v_fma_f32 v48, v48, -v24, v31
    v_fma_f32 v49, v49, -v24, v31
    v_fma_f32 v50, v50, -v24, v31
    v_fma_f32 v51, v51, -v24, v31
    v_fma_f32 v52, v52, -v24, v31
    ds_read_b64_tr_b16 v[32:33], v108 offset:8192
    ds_read_b64_tr_b16 v[34:35], v108 offset:8704
    s_waitcnt lgkmcnt(8)
    v_mfma_f32_32x32x16_bf16 v[64:79], v[36:39], v[216:219], v[64:79]
    v_exp_f32 v48, v48
    v_fma_f32 v53, v53, -v24, v31
    v_fma_f32 v54, v54, -v24, v31
    v_fma_f32 v55, v55, -v24, v31
    v_fma_f32 v56, v56, -v24, v31
    v_fma_f32 v57, v57, -v24, v31
    s_add_u32 s41, s36, 10
    s_and_b32 s41, s41, 7
    s_add_u32 m0, s40, 41216
    s_mul_i32 s43, s41, 176128
    buffer_load_dwordx4 v1, s[20:23], s43 offen lds
    ds_read_b64_tr_b16 v[36:37], v109 offset:0
    ds_read_b64_tr_b16 v[38:39], v109 offset:512
    s_waitcnt lgkmcnt(7)
    v_mfma_f32_32x32x16_bf16 v[64:79], v[40:43], v[220:223], v[64:79]
    v_exp_f32 v49, v49
    v_fma_f32 v58, v58, -v24, v31
    v_fma_f32 v59, v59, -v24, v31
    v_fma_f32 v60, v60, -v24, v31
    v_fma_f32 v61, v61, -v24, v31
    v_fma_f32 v62, v62, -v24, v31
    ds_read_b64_tr_b16 v[40:41], v110 offset:0
    ds_read_b64_tr_b16 v[42:43], v110 offset:512
    s_waitcnt lgkmcnt(6)
    v_mfma_f32_16x16x32_bf16 v[18:21], v[12:15], v[44:47], v[18:21]
    v_mfma_f32_32x32x16_bf16 v[64:79], v[44:47], v[224:227], v[64:79]
    v_exp_f32 v50, v50
    v_fma_f32 v63, v63, -v24, v31
    v_add_f32 v27, v48, v49
    v_exp_f32 v51, v51
    v_add_f32 v27, v27, v50
    ds_read_b64_tr_b16 v[44:45], v111 offset:0
    ds_read_b64_tr_b16 v[46:47], v111 offset:512
    s_waitcnt lgkmcnt(6)
    v_mfma_f32_16x16x32_bf16 v[18:21], v[12:15], v[32:35], v[18:21]
    v_mfma_f32_32x32x16_bf16 v[64:79], v[32:35], v[240:243], v[64:79]
    v_exp_f32 v52, v52
    v_add_f32 v27, v27, v51
    v_exp_f32 v53, v53
    v_add_f32 v27, v27, v52
    v_add_f32 v27, v27, v53
    buffer_load_dwordx4 v2, s[20:23], s43 offen offset:1024 lds
    ds_read_b64_tr_b16 v[32:33], v109 offset:8192
    ds_read_b64_tr_b16 v[34:35], v109 offset:8704
    s_waitcnt lgkmcnt(6)
    v_mfma_f32_32x32x16_bf16 v[64:79], v[36:39], v[228:231], v[64:79]
    v_and_b32 v83, s55, v18
    v_sub_f32 v84, v18, v83
    v_cvt_pk_bf16_f32 v83, v83, v84
    v_exp_f32 v54, v54
    v_exp_f32 v55, v55
    ds_write_b32 v94, v83 offset:36480
    ds_read_b64_tr_b16 v[36:37], v110 offset:8192
    ds_read_b64_tr_b16 v[38:39], v110 offset:8704
    s_waitcnt lgkmcnt(7)
    v_mfma_f32_32x32x16_bf16 v[64:79], v[40:43], v[232:235], v[64:79]
    v_add_f32 v27, v27, v54
    v_exp_f32 v56, v56
    v_add_f32 v27, v27, v55
    v_exp_f32 v57, v57
    v_add_f32 v27, v27, v56
    s_mov_b32 exec_hi, 0
    buffer_load_dwordx4 v3, s[20:23], s43 offen offset:2048 lds
    s_mov_b32 exec_hi, -1
    ds_read_b64_tr_b16 v[40:41], v111 offset:8192
    ds_read_b64_tr_b16 v[42:43], v111 offset:8704
    s_waitcnt lgkmcnt(7)
    v_mfma_f32_32x32x16_bf16 v[64:79], v[44:47], v[236:239], v[64:79]
    v_exp_f32 v58, v58
    v_add_f32 v27, v27, v57
    v_exp_f32 v59, v59
    v_add_f32 v27, v27, v58
    s_waitcnt vmcnt(7)
    s_waitcnt lgkmcnt(4)
    s_barrier
    ds_read_b64_tr_b16 v[44:45], v4 offset:96
    ds_read_b64_tr_b16 v[46:47], v4 offset:736
    v_mfma_f32_32x32x16_bf16 v[64:79], v[32:35], v[244:247], v[64:79]
    v_exp_f32 v60, v60
    v_add_f32 v27, v27, v59
    v_exp_f32 v61, v61
    v_add_f32 v27, v27, v60
    v_add_f32 v27, v27, v61
    ds_read_b128 v[32:35], v0 offset:36480
    s_waitcnt lgkmcnt(5)
    v_mfma_f32_32x32x16_bf16 v[64:79], v[36:39], v[248:251], v[64:79]
    v_exp_f32 v62, v62
    v_exp_f32 v63, v63
    v_add_f32 v27, v27, v62
    v_add_f32 v27, v27, v63
    s_add_u32 s41, s36, 11
    s_and_b32 s41, s41, 7
    s_add_u32 m0, s40, 61824
    s_mul_i32 s43, s41, 176128
    buffer_load_dwordx4 v1, s[20:23], s43 offen lds
    ds_read_b64_tr_b16 v[36:37], v4 offset:128
    ds_read_b64_tr_b16 v[38:39], v4 offset:768
    s_waitcnt lgkmcnt(5)
    v_mfma_f32_32x32x16_bf16 v[64:79], v[40:43], v[252:255], v[64:79]
    v_rcp_f32 v27, v27
    s_nop 0
    v_mul_f32 v48, v48, v27
    v_mul_f32 v49, v49, v27
    v_cvt_pk_bf16_f32 v48, v48, v49
    v_mul_f32 v50, v50, v27
    ds_read_b64_tr_b16 v[40:41], v5 offset:96
    ds_read_b64_tr_b16 v[42:43], v5 offset:736
    s_waitcnt lgkmcnt(5)
    v_mfma_f32_16x16x32_bf16 v[16:19], v[12:15], v[44:47], 0
    v_mfma_f32_32x32x16_bf16 v[80:95], v[44:47], v[128:131], 0
    v_mul_f32 v51, v51, v27
    v_cvt_pk_bf16_f32 v49, v50, v51
    v_mul_f32 v52, v52, v27
    v_mul_f32 v53, v53, v27
    v_cvt_pk_bf16_f32 v50, v52, v53
    v_mul_f32 v54, v54, v27
    v_mul_f32 v55, v55, v27
    s_and_b32 s59, s37, 1
    s_lshl_b32 s59, s59, 5
    ds_read_b64_tr_b16 v[44:45], v5 offset:128
    ds_read_b64_tr_b16 v[46:47], v5 offset:768
    s_waitcnt lgkmcnt(6)
    v_mfma_f32_32x32x16_bf16 v[64:79], v[32:35], v[8:11], v[64:79]
    v_cvt_pk_bf16_f32 v51, v54, v55
    v_mul_f32 v56, v56, v27
    v_mul_f32 v57, v57, v27
    v_cvt_pk_bf16_f32 v52, v56, v57
    v_mul_f32 v58, v58, v27
    v_mul_f32 v59, v59, v27
    v_cvt_pk_bf16_f32 v53, v58, v59
    s_and_b32 s56, s2, 0x38
    s_cmp_eq_u32 s56, 56
    s_cselect_b32 s58, 0xa0, 0
    s_xor_b32 s58, s58, s2
    s_and_b32 s56, s2, 7
    s_lshr_b32 s57, s58, 6
    s_lshl2_add_u32 s56, s56, s57
    s_bfe_u32 s57, s58, 0x30003
    s_lshl_b32 s57, s57, 7
    s_lshl3_add_u32 s31, s56, s32
    s_lshl_b32 s31, s31, 7
    s_add_u32 s31, s31, 13631488
    s_lshl_b32 s0, s56, 16
    s_add_u32 s0, s0, s57
    s_lshl_b32 s58, s37, 13
    s_add_u32 s0, s0, s58
    s_add_u32 s0, s0, 32768
    ds_read_b64_tr_b16 v[32:33], v6 offset:96
    ds_read_b64_tr_b16 v[34:35], v6 offset:736
    s_waitcnt lgkmcnt(6)
    v_mfma_f32_16x16x32_bf16 v[18:21], v[12:15], v[36:39], 0
    v_mfma_f32_32x32x16_bf16 v[96:111], v[36:39], v[128:131], 0
    ds_write_b128 v28, v[48:51] offset:12288
    v_xor_b32 v28, 16, v28
    v_mul_f32 v60, v60, v27
    v_mul_f32 v61, v61, v27
    v_cvt_pk_bf16_f32 v54, v60, v61
    v_mul_f32 v62, v62, v27
    v_mul_f32 v63, v63, v27
    v_cvt_pk_bf16_f32 v55, v62, v63
    buffer_load_dwordx4 v2, s[20:23], s43 offen offset:1024 lds
    s_mul_i32 s29, s56, 241664
    s_mul_i32 s58, s32, 6144
    s_add_u32 s28, s29, s58
    s_add_u32 s28, s28, 32768
    s_mul_i32 s58, s32, 5
    s_min_u32 s58, s58, 33
    s_add_u32 s58, s58, 48
    s_lshl_b32 s18, s58, 14
    s_add_u32 s18, s18, s57
    s_lshl_b32 s58, s58, 10
    s_add_u32 s30, s29, s58
    s_add_u32 s30, s30, 32768
    s_lshl_b32 s58, s32, 12
    s_add_u32 s29, s29, s58
    ds_read_b64_tr_b16 v[36:37], v6 offset:128
    ds_read_b64_tr_b16 v[38:39], v6 offset:768
    s_waitcnt lgkmcnt(7)
    v_mfma_f32_32x32x16_bf16 v[80:95], v[40:43], v[132:135], v[80:95]
    ds_write_b128 v28, v[52:55] offset:12288
    v_mov_b32 v60, 0
    v_mov_b32 v61, 0
    v_mov_b32 v62, 0
    v_mov_b32 v63, 0
    v_mul_f32 v64, v64, v26
    v_mul_f32 v65, v65, v26
    v_cvt_pk_bf16_f32 v64, v64, v65
    s_mul_i32 s16, s32, 98304
    s_add_u32 s16, s16, s57
    s_lshl_b32 s17, s32, 16
    s_add_u32 s17, s17, s57
    s_cmp_eq_u32 s32, 7
    s_cselect_b32 s19, 0x2000000, s18
    s_cmp_lt_u32 s37, 1
    s_cselect_b32 s1, 0, 21120
    s_lshl_b32 s58, s37, 14
    s_add_u32 s1, s1, s58
    s_add_u32 s1, s1, 65536
    s_sub_u32 s1, s1, 122880
    buffer_store_dwordx4 v[60:63], v0, s[24:27], s52 offen offset:0
    ds_read_b64_tr_b16 v[40:41], v6 offset:64
    ds_read_b64_tr_b16 v[42:43], v6 offset:704
    s_waitcnt lgkmcnt(8)
    v_mfma_f32_32x32x16_bf16 v[96:111], v[44:47], v[132:135], v[96:111]
    v_mul_f32 v66, v66, v26
    v_mul_f32 v67, v67, v26
    v_cvt_pk_bf16_f32 v65, v66, v67
    v_mul_f32 v68, v68, v26
    v_mul_f32 v69, v69, v26
    v_cvt_pk_bf16_f32 v66, v68, v69
    v_mul_f32 v70, v70, v26
    buffer_store_dwordx4 v[60:63], v0, s[24:27], s52 offen offset:1024
    ds_read_b64_tr_b16 v[44:45], v7 offset:96
    ds_read_b64_tr_b16 v[46:47], v7 offset:736
    s_waitcnt lgkmcnt(8)
    v_mfma_f32_32x32x16_bf16 v[80:95], v[32:35], v[136:139], v[80:95]
    v_mul_f32 v71, v71, v26
    v_cvt_pk_bf16_f32 v67, v70, v71
    v_mul_f32 v72, v72, v26
    v_mul_f32 v73, v73, v26
    v_cvt_pk_bf16_f32 v68, v72, v73
    v_mul_f32 v74, v74, v26
    v_mul_f32 v75, v75, v26
    buffer_store_dwordx4 v[60:63], v0, s[24:27], s52 offen offset:2048
    ds_read_b64_tr_b16 v[32:33], v7 offset:128
    ds_read_b64_tr_b16 v[34:35], v7 offset:768
    s_waitcnt lgkmcnt(7)
    v_mfma_f32_32x32x16_bf16 v[96:111], v[36:39], v[136:139], v[96:111]
    ds_write_b128 v30, v[64:67] offset:64
    v_cvt_pk_bf16_f32 v69, v74, v75
    v_mul_f32 v76, v76, v26
    v_mul_f32 v77, v77, v26
    v_cvt_pk_bf16_f32 v70, v76, v77
    v_mul_f32 v78, v78, v26
    v_mul_f32 v79, v79, v26
    v_cvt_pk_bf16_f32 v71, v78, v79
    s_mov_b32 exec_hi, 0
    buffer_load_dwordx4 v3, s[20:23], s43 offen offset:2048 lds
    s_mov_b32 exec_hi, -1
    ds_read_b64_tr_b16 v[36:37], v7 offset:64
    ds_read_b64_tr_b16 v[38:39], v7 offset:704
    s_waitcnt lgkmcnt(7)
    v_mfma_f32_32x32x16_bf16 v[112:127], v[40:43], v[136:139], 0
    s_waitcnt vmcnt(9)
    s_barrier
    ds_read_b64_tr_b16 v[40:41], v4 offset:20704
    ds_read_b64_tr_b16 v[42:43], v4 offset:21344
    s_waitcnt lgkmcnt(7)
    v_mfma_f32_32x32x16_bf16 v[80:95], v[44:47], v[140:143], v[80:95]
    ds_write_b128 v30, v[68:71] offset:12352
    v_mov_b32 v56, 0x3f803f80
    v_mov_b32 v57, 0x3f803f80
    v_mov_b32 v58, 0x3f803f80
    v_mov_b32 v59, 0x3f803f80
    v_lshrrev_b32 v60, 1, v0
    v_lshrrev_b32 v61, 5, v0
    v_subrev_u32 v28, s59, v29
    ds_read_b64_tr_b16 v[44:45], v4 offset:20736
    ds_read_b64_tr_b16 v[46:47], v4 offset:21376
    s_waitcnt lgkmcnt(8)
    v_mfma_f32_32x32x16_bf16 v[96:111], v[32:35], v[140:143], v[96:111]
    s_add_u32 s41, s36, 12
    s_and_b32 s41, s41, 7
    s_add_u32 m0, s40, 82432
    s_mul_i32 s43, s41, 176128
    buffer_load_dwordx4 v1, s[20:23], s43 offen lds
    s_waitcnt lgkmcnt(2)
    s_barrier
    ds_read_b64_tr_b16 v[32:33], v5 offset:20704
    ds_read_b64_tr_b16 v[34:35], v5 offset:21344
    v_mfma_f32_32x32x16_bf16 v[112:127], v[36:39], v[140:143], v[112:127]
    v_bfe_u32 v62, v0, 4, 6
    v_and_b32 v63, 7, v62
    v_lshlrev_b32 v63, 4, v63
    v_and_b32 v26, 16, v62
    v_lshlrev_b32 v26, 1, v26
    v_xor_b32 v63, v63, v26
    v_lshrrev_b32 v26, 3, v62
    ds_read_b64_tr_b16 v[64:65], v29 offset:0
    ds_read_b64_tr_b16 v[66:67], v29 offset:768
    ds_read_b64_tr_b16 v[68:69], v28 offset:64
    ds_read_b64_tr_b16 v[70:71], v28 offset:832
    ds_read_b64_tr_b16 v[36:37], v5 offset:20736
    ds_read_b64_tr_b16 v[38:39], v5 offset:21376
    v_mfma_f32_16x16x32_bf16 v[16:19], v[12:15], v[40:43], v[16:19]
    v_mfma_f32_32x32x16_bf16 v[80:95], v[40:43], v[144:147], v[80:95]
    v_lshl_add_u32 v27, v26, 10, v63
    v_and_b32 v63, 16, v62
    v_and_b32 v26, 1, v62
    v_lshl_add_u32 v63, v26, 3, v63
    v_and_b32 v26, 14, v62
    ds_read_b64_tr_b16 v[72:73], v29 offset:3072
    ds_read_b64_tr_b16 v[74:75], v29 offset:3840
    ds_read_b64_tr_b16 v[76:77], v28 offset:3136
    ds_read_b64_tr_b16 v[78:79], v28 offset:3904
    ds_read_b64_tr_b16 v[40:41], v6 offset:20704
    ds_read_b64_tr_b16 v[42:43], v6 offset:21344
    s_waitcnt lgkmcnt(10)
    v_mfma_f32_16x16x32_bf16 v[18:21], v[12:15], v[44:47], v[18:21]
    v_mfma_f32_16x16x32_bf16 v[52:55], v[64:67], v[56:59], 0
    v_mfma_f32_32x32x16_bf16 v[96:111], v[44:47], v[144:147], v[96:111]
    v_lshl_add_u32 v63, v26, 5, v63
    v_and_b32 v26, 8, v62
    v_lshl_add_u32 v63, v26, 2, v63
    v_lshrrev_b32 v26, 5, v62
    v_lshl_add_u32 v63, v26, 10, v63
    ds_read_b64_tr_b16 v[128:129], v29 offset:6144
    ds_read_b64_tr_b16 v[130:131], v29 offset:6912
    ds_read_b64_tr_b16 v[132:133], v28 offset:6208
    ds_read_b64_tr_b16 v[134:135], v28 offset:6976
    ds_read_b64_tr_b16 v[44:45], v6 offset:20736
    ds_read_b64_tr_b16 v[46:47], v6 offset:21376
    s_waitcnt lgkmcnt(14)
    v_mfma_f32_16x16x32_bf16 v[48:51], v[64:67], v[68:71], 0
    v_mfma_f32_32x32x16_bf16 v[80:95], v[32:35], v[148:151], v[80:95]
    v_lshl_add_u32 v63, s39, 1, v63
    v_xor_b32 v26, 32, v63
    v_add_u32 v31, 103040, v63
    v_add_u32 v26, 103040, v26
    s_add_u32 m0, s40, 82432
    s_nop 0
    buffer_load_dwordx4 v2, s[20:23], s43 offen offset:1024 lds
    ds_read_b64_tr_b16 v[136:137], v29 offset:9216
    ds_read_b64_tr_b16 v[138:139], v29 offset:9984
    ds_read_b64_tr_b16 v[140:141], v28 offset:9280
    ds_read_b64_tr_b16 v[142:143], v28 offset:10048
    ds_read_b64_tr_b16 v[32:33], v6 offset:20672
    ds_read_b64_tr_b16 v[34:35], v6 offset:21312
    s_waitcnt lgkmcnt(15)
    v_mfma_f32_16x16x32_bf16 v[52:55], v[72:75], v[56:59], v[52:55]
    v_mfma_f32_32x32x16_bf16 v[96:111], v[36:39], v[148:151], v[96:111]
    v_lshrrev_b32 v28, 2, v0
    v_and_b32 v28, 28, v28
    v_lshlrev_b32 v29, 3, v28
    ds_read_b64_tr_b16 v[36:37], v7 offset:20704
    ds_read_b64_tr_b16 v[38:39], v7 offset:21344
    s_waitcnt lgkmcnt(14)
    v_mfma_f32_16x16x32_bf16 v[48:51], v[72:75], v[76:79], v[48:51]
    v_mfma_f32_32x32x16_bf16 v[80:95], v[40:43], v[152:155], v[80:95]
    ds_read_b64_tr_b16 v[40:41], v7 offset:20736
    ds_read_b64_tr_b16 v[42:43], v7 offset:21376
    s_waitcnt lgkmcnt(10)
    v_mfma_f32_16x16x32_bf16 v[52:55], v[128:131], v[56:59], v[52:55]
    v_mfma_f32_32x32x16_bf16 v[96:111], v[44:47], v[152:155], v[96:111]
    s_add_u32 m0, s40, 82432
    s_mov_b32 exec_hi, 0
    buffer_load_dwordx4 v3, s[20:23], s43 offen offset:2048 lds
    s_mov_b32 exec_hi, -1
    ds_read_b64_tr_b16 v[44:45], v7 offset:20672
    ds_read_b64_tr_b16 v[46:47], v7 offset:21312
    s_waitcnt lgkmcnt(6)
    v_mfma_f32_16x16x32_bf16 v[48:51], v[128:131], v[132:135], v[48:51]
    v_mfma_f32_32x32x16_bf16 v[112:127], v[32:35], v[152:155], v[112:127]
    s_waitcnt vmcnt(9)
    s_barrier
    ds_read_b64_tr_b16 v[32:33], v4 offset:41312
    ds_read_b64_tr_b16 v[34:35], v4 offset:41952
    s_waitcnt lgkmcnt(6)
    v_mfma_f32_16x16x32_bf16 v[48:51], v[136:139], v[140:143], v[48:51]
    v_mfma_f32_32x32x16_bf16 v[80:95], v[36:39], v[156:159], v[80:95]
    s_lshl1_add_u32 m0, s39, 103040
    s_add_u32 s42, s16, 0
    buffer_load_dwordx4 v27, s[48:51], s42 offen lds
    ds_read_b64_tr_b16 v[36:37], v4 offset:41344
    ds_read_b64_tr_b16 v[38:39], v4 offset:41984
    s_waitcnt lgkmcnt(6)
    v_mfma_f32_16x16x32_bf16 v[52:55], v[136:139], v[56:59], v[52:55]
    v_mfma_f32_32x32x16_bf16 v[96:111], v[40:43], v[156:159], v[96:111]
    v_add_u32 v4, 61824, v4
    v_cvt_pk_bf16_f32 v48, v48, v49
    v_cvt_pk_bf16_f32 v49, v50, v51
    s_add_u32 s41, s36, 13
    s_and_b32 s41, s41, 7
    s_add_u32 m0, s40, 0
    s_mul_i32 s43, s41, 176128
    buffer_load_dwordx4 v1, s[20:23], s43 offen lds
    ds_read_b64_tr_b16 v[40:41], v5 offset:41312
    ds_read_b64_tr_b16 v[42:43], v5 offset:41952
    s_waitcnt lgkmcnt(6)
    v_mfma_f32_32x32x16_bf16 v[112:127], v[44:47], v[156:159], v[112:127]
    v_cvt_pk_bf16_f32 v52, v52, v53
    v_cvt_pk_bf16_f32 v53, v54, v55
    buffer_store_dwordx2 v[48:49], v60, s[24:27], s53 offen sc1
    ds_read_b64_tr_b16 v[44:45], v5 offset:41344
    ds_read_b64_tr_b16 v[46:47], v5 offset:41984
    s_waitcnt lgkmcnt(6)
    v_mfma_f32_16x16x32_bf16 v[16:19], v[12:15], v[32:35], v[16:19]
    v_mfma_f32_32x32x16_bf16 v[80:95], v[32:35], v[160:163], v[80:95]
    v_add_u32 v5, 61824, v5
    v_add_u32 v49, s35, v0
    s_mov_b32 exec_lo, 0x10001
    s_mov_b32 exec_hi, 0x10001
    buffer_store_dwordx2 v[52:53], v61, s[24:27], s54 offen sc1
    s_mov_b64 exec, -1
    ds_read_b64_tr_b16 v[32:33], v6 offset:41312
    ds_read_b64_tr_b16 v[34:35], v6 offset:41952
    s_waitcnt lgkmcnt(6)
    v_mfma_f32_16x16x32_bf16 v[18:21], v[12:15], v[36:39], v[18:21]
    v_mfma_f32_32x32x16_bf16 v[96:111], v[36:39], v[160:163], v[96:111]
    s_lshl1_add_u32 m0, s39, 103040
    s_add_u32 s42, s16, 7168
    buffer_load_dwordx4 v27, s[48:51], s42 offen offset:1024 lds
    ds_read_b64_tr_b16 v[36:37], v6 offset:41344
    ds_read_b64_tr_b16 v[38:39], v6 offset:41984
    s_waitcnt lgkmcnt(6)
    v_mfma_f32_32x32x16_bf16 v[80:95], v[40:43], v[164:167], v[80:95]
    s_add_u32 m0, s40, 0
    s_nop 0
    buffer_load_dwordx4 v2, s[20:23], s43 offen offset:1024 lds
    ds_read_b64_tr_b16 v[40:41], v6 offset:41280
    ds_read_b64_tr_b16 v[42:43], v6 offset:41920
    s_waitcnt lgkmcnt(6)
    v_mfma_f32_32x32x16_bf16 v[96:111], v[44:47], v[164:167], v[96:111]
    v_add_u32 v6, 61824, v6
    s_lshl1_add_u32 m0, s39, 119424
    s_add_u32 s42, s16, 49152
    buffer_load_dwordx4 v27, s[48:51], s42 offen lds
    ds_read_b64_tr_b16 v[44:45], v7 offset:41312
    ds_read_b64_tr_b16 v[46:47], v7 offset:41952
    s_waitcnt lgkmcnt(6)
    v_mfma_f32_32x32x16_bf16 v[80:95], v[32:35], v[168:171], v[80:95]
    s_lshl1_add_u32 m0, s39, 119424
    s_add_u32 s42, s16, 56320
    buffer_load_dwordx4 v27, s[48:51], s42 offen offset:1024 lds
    ds_read_b64_tr_b16 v[32:33], v7 offset:41344
    ds_read_b64_tr_b16 v[34:35], v7 offset:41984
    s_waitcnt lgkmcnt(6)
    v_mfma_f32_32x32x16_bf16 v[96:111], v[36:39], v[168:171], v[96:111]
    s_add_u32 m0, s40, 0
    s_mov_b32 exec_hi, 0
    buffer_load_dwordx4 v3, s[20:23], s43 offen offset:2048 lds
    s_mov_b32 exec_hi, -1
    ds_read_b64_tr_b16 v[36:37], v7 offset:41280
    ds_read_b64_tr_b16 v[38:39], v7 offset:41920
    s_waitcnt lgkmcnt(6)
    v_mfma_f32_32x32x16_bf16 v[112:127], v[40:43], v[168:171], v[112:127]
    s_lshl1_add_u32 m0, s39, 135808
    s_add_u32 s42, s16, 16384
    buffer_load_dwordx4 v27, s[48:51], s42 offen lds
    s_waitcnt vmcnt(13)
    s_barrier
    ds_read_b64_tr_b16 v[40:41], v4 offset:96
    ds_read_b64_tr_b16 v[42:43], v4 offset:736
    s_waitcnt lgkmcnt(6)
    v_mfma_f32_32x32x16_bf16 v[80:95], v[44:47], v[172:175], v[80:95]
    v_add_u32 v7, 61824, v7
    s_lshl1_add_u32 m0, s39, 135808
    s_add_u32 s42, s16, 23552
    buffer_load_dwordx4 v27, s[48:51], s42 offen offset:1024 lds
    ds_read_b64_tr_b16 v[44:45], v4 offset:128
    ds_read_b64_tr_b16 v[46:47], v4 offset:768
    s_waitcnt lgkmcnt(6)
    v_mfma_f32_32x32x16_bf16 v[96:111], v[32:35], v[172:175], v[96:111]
    s_add_u32 s41, s36, 14
    s_and_b32 s41, s41, 7
    s_add_u32 m0, s40, 20608
    s_mul_i32 s43, s41, 176128
    buffer_load_dwordx4 v1, s[20:23], s43 offen lds
    ds_read_b64_tr_b16 v[32:33], v5 offset:96
    ds_read_b64_tr_b16 v[34:35], v5 offset:736
    s_waitcnt lgkmcnt(6)
    v_mfma_f32_32x32x16_bf16 v[112:127], v[36:39], v[172:175], v[112:127]
    ds_read_b64_tr_b16 v[36:37], v5 offset:128
    ds_read_b64_tr_b16 v[38:39], v5 offset:768
    s_waitcnt lgkmcnt(6)
    v_mfma_f32_16x16x32_bf16 v[16:19], v[12:15], v[40:43], v[16:19]
    v_mfma_f32_32x32x16_bf16 v[80:95], v[40:43], v[176:179], v[80:95]
    ds_read_b64_tr_b16 v[40:41], v6 offset:96
    ds_read_b64_tr_b16 v[42:43], v6 offset:736
    s_waitcnt lgkmcnt(6)
    s_nop 1
    v_mfma_f32_16x16x32_bf16 v[18:21], v[12:15], v[44:47], v[18:21]
    v_mfma_f32_32x32x16_bf16 v[96:111], v[44:47], v[176:179], v[96:111]
    s_waitcnt vmcnt(7)
    ds_read_b64_tr_b16 v[128:129], v31 offset:0
    ds_read_b64_tr_b16 v[130:131], v31 offset:512
    ds_read_b64_tr_b16 v[132:133], v26 offset:0
    ds_read_b64_tr_b16 v[134:135], v26 offset:512
    ds_read_b64_tr_b16 v[44:45], v6 offset:128
    ds_read_b64_tr_b16 v[46:47], v6 offset:768
    s_waitcnt lgkmcnt(10)
    v_mfma_f32_32x32x16_bf16 v[80:95], v[32:35], v[180:183], v[80:95]
    s_add_u32 m0, s40, 20608
    s_nop 0
    buffer_load_dwordx4 v2, s[20:23], s43 offen offset:1024 lds
    ds_read_b64_tr_b16 v[32:33], v6 offset:64
    ds_read_b64_tr_b16 v[34:35], v6 offset:704
    s_waitcnt lgkmcnt(10)
    v_mfma_f32_32x32x16_bf16 v[96:111], v[36:39], v[180:183], v[96:111]
    s_waitcnt lgkmcnt(4)
    s_lshl1_add_u32 m0, s39, 103040
    s_add_u32 s42, s16, 65536
    buffer_load_dwordx4 v27, s[48:51], s42 offen lds
    ds_read_b64_tr_b16 v[36:37], v7 offset:96
    ds_read_b64_tr_b16 v[38:39], v7 offset:736
    v_mfma_f32_32x32x16_bf16 v[80:95], v[40:43], v[184:187], v[80:95]
    s_waitcnt vmcnt(6)
    ds_read_b64_tr_b16 v[136:137], v31 offset:16384
    ds_read_b64_tr_b16 v[138:139], v31 offset:16896
    ds_read_b64_tr_b16 v[140:141], v26 offset:16384
    ds_read_b64_tr_b16 v[142:143], v26 offset:16896
    s_lshl1_add_u32 m0, s39, 103040
    s_add_u32 s42, s16, 72704
    buffer_load_dwordx4 v27, s[48:51], s42 offen offset:1024 lds
    ds_read_b64_tr_b16 v[40:41], v7 offset:128
    ds_read_b64_tr_b16 v[42:43], v7 offset:768
    s_waitcnt lgkmcnt(10)
    v_mfma_f32_32x32x16_bf16 v[96:111], v[44:47], v[184:187], v[96:111]
    s_add_u32 m0, s40, 20608
    s_mov_b32 exec_hi, 0
    buffer_load_dwordx4 v3, s[20:23], s43 offen offset:2048 lds
    s_mov_b32 exec_hi, -1
    ds_read_b64_tr_b16 v[44:45], v7 offset:64
    ds_read_b64_tr_b16 v[46:47], v7 offset:704
    s_waitcnt lgkmcnt(10)
    v_mfma_f32_32x32x16_bf16 v[112:127], v[32:35], v[184:187], v[112:127]
    s_waitcnt lgkmcnt(4)
    s_lshl1_add_u32 m0, s39, 119424
    s_add_u32 s42, s16, 32768
    buffer_load_dwordx4 v27, s[48:51], s42 offen lds
    s_barrier
    ds_read_b64_tr_b16 v[32:33], v4 offset:20704
    ds_read_b64_tr_b16 v[34:35], v4 offset:21344
    v_mfma_f32_32x32x16_bf16 v[80:95], v[36:39], v[188:191], v[80:95]
    s_waitcnt vmcnt(6)
    ds_read_b64_tr_b16 v[144:145], v31 offset:32768
    ds_read_b64_tr_b16 v[146:147], v31 offset:33280
    ds_read_b64_tr_b16 v[148:149], v26 offset:32768
    ds_read_b64_tr_b16 v[150:151], v26 offset:33280
    s_lshl1_add_u32 m0, s39, 119424
    s_add_u32 s42, s16, 39936
    buffer_load_dwordx4 v27, s[48:51], s42 offen offset:1024 lds
    ds_read_b64_tr_b16 v[36:37], v4 offset:20736
    ds_read_b64_tr_b16 v[38:39], v4 offset:21376
    s_waitcnt lgkmcnt(10)
    v_mfma_f32_32x32x16_bf16 v[96:111], v[40:43], v[188:191], v[96:111]
    v_subrev_u32 v4, 61824, v4
    s_add_u32 s41, s36, 15
    s_and_b32 s41, s41, 7
    s_add_u32 m0, s40, 41216
    s_mul_i32 s43, s41, 176128
    buffer_load_dwordx4 v1, s[20:23], s43 offen lds
    ds_read_b64_tr_b16 v[40:41], v5 offset:20704
    ds_read_b64_tr_b16 v[42:43], v5 offset:21344
    s_waitcnt lgkmcnt(10)
    v_mfma_f32_32x32x16_bf16 v[112:127], v[44:47], v[188:191], v[112:127]
    s_waitcnt lgkmcnt(4)
    s_lshl1_add_u32 m0, s39, 135808
    s_add_u32 s42, s16, 81920
    buffer_load_dwordx4 v27, s[48:51], s42 offen lds
    ds_read_b64_tr_b16 v[44:45], v5 offset:20736
    ds_read_b64_tr_b16 v[46:47], v5 offset:21376
    v_mfma_f32_16x16x32_bf16 v[16:19], v[12:15], v[32:35], v[16:19]
    v_mfma_f32_32x32x16_bf16 v[80:95], v[32:35], v[192:195], v[80:95]
    v_subrev_u32 v5, 61824, v5
    v_lshrrev_b32 v48, 6, v0
    v_and_b32 v48, 12, v48
    v_xor_b32 v48, s3, v48
    v_or_b32 v48, v48, v0
    s_lshl1_add_u32 m0, s39, 135808
    s_add_u32 s42, s16, 89088
    buffer_load_dwordx4 v27, s[48:51], s42 offen offset:1024 lds
    ds_read_b64_tr_b16 v[32:33], v6 offset:20704
    ds_read_b64_tr_b16 v[34:35], v6 offset:21344
    s_waitcnt lgkmcnt(6)
    v_mfma_f32_16x16x32_bf16 v[18:21], v[12:15], v[36:39], v[18:21]
    v_mfma_f32_32x32x16_bf16 v[96:111], v[36:39], v[192:195], v[96:111]
    ds_read_b64_tr_b16 v[36:37], v6 offset:20736
    ds_read_b64_tr_b16 v[38:39], v6 offset:21376
    s_waitcnt lgkmcnt(6)
    v_mfma_f32_32x32x16_bf16 v[80:95], v[40:43], v[196:199], v[80:95]
    s_add_u32 m0, s40, 41216
    s_nop 0
    buffer_load_dwordx4 v2, s[20:23], s43 offen offset:1024 lds
    ds_read_b64_tr_b16 v[40:41], v6 offset:20672
    ds_read_b64_tr_b16 v[42:43], v6 offset:21312
    s_waitcnt lgkmcnt(6)
    v_mfma_f32_32x32x16_bf16 v[96:111], v[44:47], v[196:199], v[96:111]
    v_subrev_u32 v6, 61824, v6
    ds_read_b64_tr_b16 v[44:45], v7 offset:20704
    ds_read_b64_tr_b16 v[46:47], v7 offset:21344
    s_waitcnt lgkmcnt(6)
    v_mfma_f32_32x32x16_bf16 v[80:95], v[32:35], v[200:203], v[80:95]
    s_waitcnt vmcnt(7)
    ds_read_b64_tr_b16 v[152:153], v31 offset:0
    ds_read_b64_tr_b16 v[154:155], v31 offset:512
    ds_read_b64_tr_b16 v[156:157], v26 offset:0
    ds_read_b64_tr_b16 v[158:159], v26 offset:512
    ds_read_b64_tr_b16 v[32:33], v7 offset:20736
    ds_read_b64_tr_b16 v[34:35], v7 offset:21376
    s_waitcnt lgkmcnt(10)
    v_mfma_f32_32x32x16_bf16 v[96:111], v[36:39], v[200:203], v[96:111]
    s_add_u32 m0, s40, 41216
    s_mov_b32 exec_hi, 0
    buffer_load_dwordx4 v3, s[20:23], s43 offen offset:2048 lds
    s_mov_b32 exec_hi, -1
    ds_read_b64_tr_b16 v[36:37], v7 offset:20672
    ds_read_b64_tr_b16 v[38:39], v7 offset:21312
    s_waitcnt lgkmcnt(10)
    v_mfma_f32_32x32x16_bf16 v[112:127], v[40:43], v[200:203], v[112:127]
    s_waitcnt lgkmcnt(4)
    s_lshl1_add_u32 m0, s39, 103040
    s_add_u32 s42, s17, 0
    buffer_load_dwordx4 v27, s[44:47], s42 offen lds
    s_barrier
    ds_read_b64_tr_b16 v[40:41], v4 offset:96
    ds_read_b64_tr_b16 v[42:43], v4 offset:736
    v_mfma_f32_32x32x16_bf16 v[80:95], v[44:47], v[204:207], v[80:95]
    v_subrev_u32 v7, 61824, v7
    s_waitcnt vmcnt(6)
    ds_read_b64_tr_b16 v[160:161], v31 offset:16384
    ds_read_b64_tr_b16 v[162:163], v31 offset:16896
    ds_read_b64_tr_b16 v[164:165], v26 offset:16384
    ds_read_b64_tr_b16 v[166:167], v26 offset:16896
    s_lshl1_add_u32 m0, s39, 103040
    s_add_u32 s42, s17, 7168
    buffer_load_dwordx4 v27, s[44:47], s42 offen offset:1024 lds
    s_cmp_eq_u32 s19, 0x2000000
    s_cselect_b32 s36, 2.0, s30
    ds_read_b64_tr_b16 v[44:45], v4 offset:128
    ds_read_b64_tr_b16 v[46:47], v4 offset:768
    s_waitcnt lgkmcnt(10)
    v_mfma_f32_32x32x16_bf16 v[96:111], v[32:35], v[204:207], v[96:111]
    buffer_load_dword v30, v29, s[4:7], 0 offen
    ds_read_b64_tr_b16 v[32:33], v6 offset:64
    ds_read_b64_tr_b16 v[34:35], v6 offset:704
    s_waitcnt lgkmcnt(10)
    v_mfma_f32_32x32x16_bf16 v[112:127], v[36:39], v[204:207], v[112:127]
    s_waitcnt lgkmcnt(4)
    s_lshl1_add_u32 m0, s39, 119424
    s_add_u32 s42, s17, 16384
    buffer_load_dwordx4 v27, s[44:47], s42 offen lds
    ds_read_b64_tr_b16 v[36:37], v7 offset:64
    ds_read_b64_tr_b16 v[38:39], v7 offset:704
    v_mfma_f32_16x16x32_bf16 v[16:19], v[12:15], v[40:43], v[16:19]
    v_mfma_f32_32x32x16_bf16 v[80:95], v[40:43], v[208:211], v[80:95]
    s_waitcnt vmcnt(6)
    ds_read_b64_tr_b16 v[168:169], v31 offset:32768
    ds_read_b64_tr_b16 v[170:171], v31 offset:33280
    ds_read_b64_tr_b16 v[172:173], v26 offset:32768
    ds_read_b64_tr_b16 v[174:175], v26 offset:33280
    s_lshl1_add_u32 m0, s39, 119424
    s_add_u32 s42, s17, 23552
    buffer_load_dwordx4 v27, s[44:47], s42 offen offset:1024 lds
    ds_read_b64_tr_b16 v[40:41], v5 offset:96
    ds_read_b64_tr_b16 v[42:43], v5 offset:736
    s_waitcnt lgkmcnt(10)
    v_mfma_f32_16x16x32_bf16 v[18:21], v[12:15], v[44:47], v[18:21]
    v_mfma_f32_32x32x16_bf16 v[96:111], v[44:47], v[208:211], v[96:111]
    ds_read_b64_tr_b16 v[44:45], v6 offset:96
    ds_read_b64_tr_b16 v[46:47], v6 offset:736
    s_waitcnt lgkmcnt(10)
    v_mfma_f32_32x32x16_bf16 v[112:127], v[32:35], v[216:219], v[112:127]
    s_waitcnt lgkmcnt(4)
    s_lshl1_add_u32 m0, s39, 135808
    s_add_u32 s42, s17, 32768
    buffer_load_dwordx4 v27, s[44:47], s42 offen lds
    ds_read_b64_tr_b16 v[32:33], v7 offset:96
    ds_read_b64_tr_b16 v[34:35], v7 offset:736
    v_mfma_f32_32x32x16_bf16 v[112:127], v[36:39], v[220:223], v[112:127]
    s_lshl1_add_u32 m0, s39, 135808
    s_add_u32 s42, s17, 39936
    buffer_load_dwordx4 v27, s[44:47], s42 offen offset:1024 lds
    s_waitcnt vmcnt(7)
    s_barrier
    ds_read_b64_tr_b16 v[36:37], v4 offset:20704
    ds_read_b64_tr_b16 v[38:39], v4 offset:21344
    s_waitcnt lgkmcnt(6)
    v_mfma_f32_32x32x16_bf16 v[80:95], v[40:43], v[212:215], v[80:95]
    ds_read_b64_tr_b16 v[40:41], v4 offset:20736
    ds_read_b64_tr_b16 v[42:43], v4 offset:21376
    s_waitcnt lgkmcnt(6)
    v_mfma_f32_32x32x16_bf16 v[80:95], v[44:47], v[216:219], v[80:95]
    ds_read_b64_tr_b16 v[44:45], v6 offset:20672
    ds_read_b64_tr_b16 v[46:47], v6 offset:21312
    s_waitcnt lgkmcnt(6)
    v_mfma_f32_32x32x16_bf16 v[80:95], v[32:35], v[220:223], v[80:95]
    s_and_b32 s101, s2, 7
    s_waitcnt vmcnt(4)
    v_readlane_b32 s101, v30, s101
    v_and_b32 v30, 0xff, v30
    v_cmp_gt_u32 vcc, 32, v30
    s_lshl_b32 s57, s100, 5
    s_sub_u32 s101, s101, s57
    s_cbranch_vccnz L_parallel_sum__linear_kernel_hedgehog__glu_gated_glu__prompt_kernel_01_cp
L_parallel_sum__linear_kernel_hedgehog__glu_gated_glu__prompt_kernel_01_cb:
    ds_read_b64_tr_b16 v[32:33], v7 offset:20672
    ds_read_b64_tr_b16 v[34:35], v7 offset:21312
    s_waitcnt lgkmcnt(6)
    v_mfma_f32_16x16x32_bf16 v[16:19], v[12:15], v[36:39], v[16:19]
    v_mfma_f32_32x32x16_bf16 v[80:95], v[36:39], v[224:227], v[80:95]
    ds_read_b64_tr_b16 v[176:177], v31 offset:0
    ds_read_b64_tr_b16 v[178:179], v31 offset:512
    ds_read_b64_tr_b16 v[180:181], v26 offset:0
    ds_read_b64_tr_b16 v[182:183], v26 offset:512
    ds_read_b64_tr_b16 v[36:37], v6 offset:41280
    ds_read_b64_tr_b16 v[38:39], v6 offset:41920
    s_waitcnt lgkmcnt(10)
    v_mfma_f32_16x16x32_bf16 v[18:21], v[12:15], v[40:43], v[18:21]
    v_mfma_f32_32x32x16_bf16 v[96:111], v[40:43], v[224:227], v[96:111]
    ds_read_b64_tr_b16 v[40:41], v7 offset:41280
    ds_read_b64_tr_b16 v[42:43], v7 offset:41920
    s_waitcnt lgkmcnt(10)
    v_mfma_f32_32x32x16_bf16 v[112:127], v[44:47], v[232:235], v[112:127]
    s_waitcnt lgkmcnt(4)
    s_lshl1_add_u32 m0, s39, 103040
    s_add_u32 s42, s17, 49152
    buffer_load_dwordx4 v27, s[44:47], s42 offen lds
    ds_read_b64_tr_b16 v[44:45], v4 offset:41312
    ds_read_b64_tr_b16 v[46:47], v4 offset:41952
    v_mfma_f32_32x32x16_bf16 v[112:127], v[32:35], v[236:239], v[112:127]
    s_waitcnt vmcnt(3)
    ds_read_b64_tr_b16 v[184:185], v31 offset:16384
    ds_read_b64_tr_b16 v[186:187], v31 offset:16896
    ds_read_b64_tr_b16 v[188:189], v26 offset:16384
    ds_read_b64_tr_b16 v[190:191], v26 offset:16896
    s_lshl1_add_u32 m0, s39, 103040
    s_add_u32 s42, s17, 56320
    buffer_load_dwordx4 v27, s[44:47], s42 offen offset:1024 lds
    ds_read_b64_tr_b16 v[32:33], v4 offset:41344
    ds_read_b64_tr_b16 v[34:35], v4 offset:41984
    s_waitcnt lgkmcnt(10)
    v_mfma_f32_32x32x16_bf16 v[112:127], v[36:39], v[248:251], v[112:127]
    ds_read_b64_tr_b16 v[36:37], v5 offset:20704
    ds_read_b64_tr_b16 v[38:39], v5 offset:21344
    s_waitcnt lgkmcnt(10)
    v_mfma_f32_32x32x16_bf16 v[112:127], v[40:43], v[252:255], v[112:127]
    s_waitcnt lgkmcnt(4)
    s_lshl1_add_u32 m0, s39, 119424
    s_add_u32 s42, s18, 32768
    buffer_load_dwordx4 v27, s[48:51], s42 offen lds
    ds_read_b64_tr_b16 v[40:41], v6 offset:20704
    ds_read_b64_tr_b16 v[42:43], v6 offset:21344
    v_mfma_f32_16x16x32_bf16 v[16:19], v[12:15], v[44:47], v[16:19]
    v_mfma_f32_32x32x16_bf16 v[80:95], v[44:47], v[240:243], v[80:95]
    s_waitcnt vmcnt(3)
    ds_read_b64_tr_b16 v[64:65], v31 offset:32768
    ds_read_b64_tr_b16 v[66:67], v31 offset:33280
    ds_read_b64_tr_b16 v[68:69], v26 offset:32768
    ds_read_b64_tr_b16 v[70:71], v26 offset:33280
    s_lshl1_add_u32 m0, s39, 119424
    s_add_u32 s42, s18, 39936
    buffer_load_dwordx4 v27, s[48:51], s42 offen offset:1024 lds
    ds_read_b64_tr_b16 v[44:45], v7 offset:20704
    ds_read_b64_tr_b16 v[46:47], v7 offset:21344
    s_waitcnt lgkmcnt(10)
    v_mfma_f32_16x16x32_bf16 v[18:21], v[12:15], v[32:35], v[18:21]
    v_mfma_f32_32x32x16_bf16 v[96:111], v[32:35], v[240:243], v[96:111]
    ds_write_b128 v49, v[112:115] offset:8192
    v_and_b32 v50, s55, v16
    v_sub_f32 v51, v16, v50
    v_cvt_pk_bf16_f32 v50, v50, v51
    ds_write_b32 v48, v50 offset:36480
    ds_read_b64_tr_b16 v[32:33], v5 offset:41312
    ds_read_b64_tr_b16 v[34:35], v5 offset:41952
    s_waitcnt lgkmcnt(12)
    v_mfma_f32_32x32x16_bf16 v[80:95], v[36:39], v[228:231], v[80:95]
    ds_write_b128 v49, v[120:123] offset:9216
    v_and_b32 v52, s55, v18
    v_sub_f32 v53, v18, v52
    v_cvt_pk_bf16_f32 v52, v52, v53
    ds_write_b32 v48, v52 offset:37504
    s_waitcnt lgkmcnt(8)
    s_lshl1_add_u32 m0, s39, 135808
    s_add_u32 s42, s19, 0
    buffer_load_dwordx4 v27, s[48:51], s42 offen lds
    ds_read_b64_tr_b16 v[36:37], v6 offset:41312
    ds_read_b64_tr_b16 v[38:39], v6 offset:41952
    v_mfma_f32_32x32x16_bf16 v[80:95], v[40:43], v[232:235], v[80:95]
    s_lshl1_add_u32 m0, s39, 135808
    s_add_u32 s42, s19, 7168
    buffer_load_dwordx4 v27, s[48:51], s42 offen offset:1024 lds
    s_waitcnt lgkmcnt(2)
    s_barrier
    ds_read_b128 v[40:43], v0 offset:35456
    v_mfma_f32_32x32x16_bf16 v[80:95], v[44:47], v[236:239], v[80:95]
    ds_read_b128 v[56:59], v49 offset:0
    ds_read_b128 v[60:63], v49 offset:1024
    ds_read_b64_tr_b16 v[44:45], v7 offset:41312
    ds_read_b64_tr_b16 v[46:47], v7 offset:41952
    v_mfma_f32_32x32x16_bf16 v[80:95], v[32:35], v[244:247], v[80:95]
    ds_read_b128 v[32:35], v0 offset:36480
    s_waitcnt lgkmcnt(6)
    v_mfma_f32_32x32x16_bf16 v[80:95], v[36:39], v[248:251], v[80:95]
    ds_read_b64_tr_b16 v[36:37], v5 offset:128
    ds_read_b64_tr_b16 v[38:39], v5 offset:768
    s_waitcnt lgkmcnt(7)
    v_mfma_f32_32x32x16_bf16 v[112:127], v[40:43], v[8:11], v[112:127]
    s_waitcnt vmcnt(4)
    ds_read_b64_tr_b16 v[72:73], v31 offset:0
    ds_read_b64_tr_b16 v[74:75], v31 offset:512
    ds_read_b64_tr_b16 v[76:77], v26 offset:0
    ds_read_b64_tr_b16 v[78:79], v26 offset:512
    ds_read_b64_tr_b16 v[40:41], v6 offset:128
    ds_read_b64_tr_b16 v[42:43], v6 offset:768
    s_waitcnt lgkmcnt(9)
    v_mfma_f32_32x32x16_bf16 v[80:95], v[44:47], v[252:255], v[80:95]
    ds_read_b64_tr_b16 v[44:45], v7 offset:128
    ds_read_b64_tr_b16 v[46:47], v7 offset:768
    s_waitcnt lgkmcnt(10)
    v_mfma_f32_32x32x16_bf16 v[80:95], v[32:35], v[8:11], v[80:95]
    v_add_f32 v56, v56, v116
    v_add_f32 v57, v57, v117
    v_add_f32 v58, v58, v118
    v_add_f32 v59, v59, v119
    v_add_f32 v60, v60, v124
    v_add_f32 v61, v61, v125
    s_waitcnt lgkmcnt(4)
    s_lshl1_add_u32 m0, s39, 103040
    s_add_u32 s42, s18, 49152
    buffer_load_dwordx4 v27, s[48:51], s42 offen lds
    ds_read_b64_tr_b16 v[32:33], v5 offset:20736
    ds_read_b64_tr_b16 v[34:35], v5 offset:21376
    v_mfma_f32_32x32x16_bf16 v[96:111], v[36:39], v[212:215], v[96:111]
    v_add_f32 v62, v62, v126
    v_add_f32 v63, v63, v127
    v_mul_f32 v56, v56, v24
    v_mul_f32 v57, v57, v24
    v_mul_f32 v58, v58, v24
    v_mul_f32 v59, v59, v24
    s_waitcnt vmcnt(3)
    ds_read_b64_tr_b16 v[192:193], v31 offset:16384
    ds_read_b64_tr_b16 v[194:195], v31 offset:16896
    ds_read_b64_tr_b16 v[196:197], v26 offset:16384
    ds_read_b64_tr_b16 v[198:199], v26 offset:16896
    s_lshl1_add_u32 m0, s39, 103040
    s_add_u32 s42, s18, 56320
    buffer_load_dwordx4 v27, s[48:51], s42 offen offset:1024 lds
    ds_read_b64_tr_b16 v[36:37], v6 offset:20736
    ds_read_b64_tr_b16 v[38:39], v6 offset:21376
    s_waitcnt lgkmcnt(10)
    v_mfma_f32_32x32x16_bf16 v[96:111], v[40:43], v[216:219], v[96:111]
    v_exp_f32 v56, v56
    v_exp_f32 v57, v57
    v_exp_f32 v58, v58
    ds_read_b64_tr_b16 v[40:41], v7 offset:20736
    ds_read_b64_tr_b16 v[42:43], v7 offset:21376
    s_waitcnt lgkmcnt(10)
    v_mfma_f32_32x32x16_bf16 v[96:111], v[44:47], v[220:223], v[96:111]
    v_exp_f32 v59, v59
    v_fma_f32 v56, v56, v25, v25
    v_fma_f32 v57, v57, v25, v25
    v_fma_f32 v58, v58, v25, v25
    v_fma_f32 v59, v59, v25, v25
    s_waitcnt lgkmcnt(4)
    s_lshl1_add_u32 m0, s39, 119424
    s_add_u32 s42, s19, 16384
    buffer_load_dwordx4 v27, s[48:51], s42 offen lds
    ds_read_b64_tr_b16 v[44:45], v5 offset:41344
    ds_read_b64_tr_b16 v[46:47], v5 offset:41984
    v_mfma_f32_32x32x16_bf16 v[96:111], v[32:35], v[228:231], v[96:111]
    v_rcp_f32 v56, v56
    v_rcp_f32 v57, v57
    v_rcp_f32 v58, v58
    s_waitcnt vmcnt(3)
    ds_read_b64_tr_b16 v[200:201], v31 offset:32768
    ds_read_b64_tr_b16 v[202:203], v31 offset:33280
    ds_read_b64_tr_b16 v[204:205], v26 offset:32768
    ds_read_b64_tr_b16 v[206:207], v26 offset:33280
    s_lshl1_add_u32 m0, s39, 119424
    s_add_u32 s42, s19, 23552
    buffer_load_dwordx4 v27, s[48:51], s42 offen offset:1024 lds
    ds_read_b64_tr_b16 v[32:33], v6 offset:41344
    ds_read_b64_tr_b16 v[34:35], v6 offset:41984
    s_waitcnt lgkmcnt(10)
    v_mfma_f32_32x32x16_bf16 v[96:111], v[36:39], v[232:235], v[96:111]
    v_rcp_f32 v59, v59
    v_mul_f32 v56, v56, v60
    v_mul_f32 v57, v57, v61
    v_mul_f32 v58, v58, v62
    v_mul_f32 v59, v59, v63
    ds_read_b64_tr_b16 v[36:37], v7 offset:41344
    ds_read_b64_tr_b16 v[38:39], v7 offset:41984
    s_waitcnt lgkmcnt(10)
    v_mfma_f32_32x32x16_bf16 v[96:111], v[40:43], v[236:239], v[96:111]
    v_cvt_pk_bf16_f32 v56, v56, v57
    v_cvt_pk_bf16_f32 v57, v58, v59
    v_mul_f32 v80, v80, v24
    v_mul_f32 v81, v81, v24
    v_mul_f32 v82, v82, v24
    v_mul_f32 v83, v83, v24
    s_cmp_lg_u32 s101, 0
    s_cbranch_scc1 L_parallel_sum__linear_kernel_hedgehog__glu_gated_glu__prompt_kernel_01_ss1
    buffer_store_dwordx2 v[56:57], v0, s[24:27], s52 offen offset:8
L_parallel_sum__linear_kernel_hedgehog__glu_gated_glu__prompt_kernel_01_sb1:
    ds_read_b128 v[40:43], v0 offset:37504
    s_waitcnt lgkmcnt(9)
    v_mfma_f32_32x32x16_bf16 v[96:111], v[44:47], v[244:247], v[96:111]
    v_mul_f32 v84, v84, v24
    v_mul_f32 v85, v85, v24
    v_mul_f32 v86, v86, v24
    v_mul_f32 v87, v87, v24
    v_exp_f32 v80, v80
    s_waitcnt lgkmcnt(5)
    s_lshl1_add_u32 m0, s39, 135808
    s_add_u32 s42, s18, 65536
    buffer_load_dwordx4 v27, s[48:51], s42 offen lds
    s_waitcnt lgkmcnt(3)
    v_mfma_f32_32x32x16_bf16 v[96:111], v[32:35], v[248:251], v[96:111]
    v_exp_f32 v81, v81
    v_exp_f32 v82, v82
    v_exp_f32 v83, v83
    s_lshl1_add_u32 m0, s39, 135808
    s_add_u32 s42, s18, 72704
    buffer_load_dwordx4 v27, s[48:51], s42 offen offset:1024 lds
    s_waitcnt lgkmcnt(1)
    v_mfma_f32_32x32x16_bf16 v[96:111], v[36:39], v[252:255], v[96:111]
    v_exp_f32 v84, v84
    v_exp_f32 v85, v85
    v_exp_f32 v86, v86
    s_waitcnt lgkmcnt(0)
    v_mfma_f32_32x32x16_bf16 v[96:111], v[40:43], v[8:11], v[96:111]
    v_exp_f32 v87, v87
    v_fma_f32 v80, v80, v25, v25
    v_fma_f32 v81, v81, v25, v25
    v_fma_f32 v82, v82, v25, v25
    v_fma_f32 v83, v83, v25, v25
    s_barrier
    v_fma_f32 v84, v84, v25, v25
    v_fma_f32 v85, v85, v25, v25
    v_fma_f32 v86, v86, v25, v25
    v_fma_f32 v87, v87, v25, v25
    v_rcp_f32 v80, v80
    v_rcp_f32 v81, v81
    v_rcp_f32 v82, v82
    v_rcp_f32 v83, v83
    v_rcp_f32 v84, v84
    v_rcp_f32 v85, v85
    v_rcp_f32 v86, v86
    v_rcp_f32 v87, v87
    v_mul_f32 v80, v80, v88
    v_mul_f32 v81, v81, v89
    v_mul_f32 v82, v82, v90
    v_mul_f32 v83, v83, v91
    v_mul_f32 v84, v84, v92
    v_mul_f32 v85, v85, v93
    v_mul_f32 v86, v86, v94
    v_mul_f32 v87, v87, v95
    v_cvt_pk_bf16_f32 v80, v80, v81
    v_cvt_pk_bf16_f32 v81, v82, v83
    v_cvt_pk_bf16_f32 v82, v84, v85
    v_cvt_pk_bf16_f32 v83, v86, v87
    s_cmp_lg_u32 s101, 0
    s_cbranch_scc1 L_parallel_sum__linear_kernel_hedgehog__glu_gated_glu__prompt_kernel_01_ss2
    buffer_store_dwordx4 v[80:83], v0, s[24:27], s52 offen offset:1024
L_parallel_sum__linear_kernel_hedgehog__glu_gated_glu__prompt_kernel_01_sb2:
    v_mul_f32 v96, v96, v24
    v_mul_f32 v97, v97, v24
    v_mul_f32 v98, v98, v24
    v_mul_f32 v99, v99, v24
    v_mul_f32 v100, v100, v24
    v_mul_f32 v101, v101, v24
    v_mul_f32 v102, v102, v24
    v_mul_f32 v103, v103, v24
    v_exp_f32 v96, v96
    v_exp_f32 v97, v97
    v_exp_f32 v98, v98
    v_exp_f32 v99, v99
    v_exp_f32 v100, v100
    v_exp_f32 v101, v101
    v_exp_f32 v102, v102
    v_exp_f32 v103, v103
    v_fma_f32 v96, v96, v25, v25
    v_fma_f32 v97, v97, v25, v25
    v_fma_f32 v98, v98, v25, v25
    v_fma_f32 v99, v99, v25, v25
    v_fma_f32 v100, v100, v25, v25
    v_fma_f32 v101, v101, v25, v25
    v_fma_f32 v102, v102, v25, v25
    v_fma_f32 v103, v103, v25, v25
    v_rcp_f32 v96, v96
    v_rcp_f32 v97, v97
    v_rcp_f32 v98, v98
    v_rcp_f32 v99, v99
    v_rcp_f32 v100, v100
    v_rcp_f32 v101, v101
    v_rcp_f32 v102, v102
    v_rcp_f32 v103, v103
    v_mul_f32 v96, v96, v104
    v_mul_f32 v97, v97, v105
    v_mul_f32 v98, v98, v106
    v_mul_f32 v99, v99, v107
    v_mul_f32 v100, v100, v108
    v_mul_f32 v101, v101, v109
    v_mul_f32 v102, v102, v110
    v_mul_f32 v103, v103, v111
    v_cvt_pk_bf16_f32 v96, v96, v97
    v_cvt_pk_bf16_f32 v97, v98, v99
    v_cvt_pk_bf16_f32 v98, v100, v101
    v_cvt_pk_bf16_f32 v99, v102, v103
    buffer_load_dword v29, v28, s[24:27], s31 offen sc1
    s_cmp_lg_u32 s101, 0
    s_cbranch_scc1 L_parallel_sum__linear_kernel_hedgehog__glu_gated_glu__prompt_kernel_01_ss3
    buffer_store_dwordx4 v[96:99], v0, s[24:27], s52 offen offset:2048
L_parallel_sum__linear_kernel_hedgehog__glu_gated_glu__prompt_kernel_01_sb3:
    v_mov_b32 v30, 3
    s_waitcnt vmcnt(0)
    s_mov_b64 exec, 1
    s_cmp_lg_u32 s101, 0
    s_cbranch_scc1 L_parallel_sum__linear_kernel_hedgehog__glu_gated_glu__prompt_kernel_01_ss4
    buffer_store_dword v30, off, s[24:27], s33
L_parallel_sum__linear_kernel_hedgehog__glu_gated_glu__prompt_kernel_01_sb4:
    s_mov_b64 exec, -1
    v_cmp_gt_u32 vcc, 3, v29
    s_and_b32 s57, vcc_lo, 240
    s_cbranch_scc1 L_parallel_sum__linear_kernel_hedgehog__glu_gated_glu__prompt_kernel_01_fp1
L_parallel_sum__linear_kernel_hedgehog__glu_gated_glu__prompt_kernel_01_fb1:
    s_add_u32 s42, s28, 0
    buffer_load_dwordx4 v[112:115], v0, s[24:27], s42 offen
    s_add_u32 s42, s28, 120832
    buffer_load_dwordx4 v[116:119], v0, s[24:27], s42 offen
    s_add_u32 s42, s28, 3072
    buffer_load_dwordx4 v[120:123], v0, s[24:27], s42 offen
    s_add_u32 s42, s28, 123904
    buffer_load_dwordx4 v[124:127], v0, s[24:27], s42 offen
    s_add_u32 s42, s28, 1024
    buffer_load_dwordx4 v[48:51], v0, s[24:27], s42 offen
    s_add_u32 s42, s28, 121856
    buffer_load_dwordx4 v[52:55], v0, s[24:27], s42 offen
    s_add_u32 s42, s28, 4096
    buffer_load_dwordx4 v[56:59], v0, s[24:27], s42 offen
    s_add_u32 s42, s28, 124928
    buffer_load_dwordx4 v[60:63], v0, s[24:27], s42 offen
    s_add_u32 s42, s28, 2048
    buffer_load_dwordx4 v[80:83], v0, s[24:27], s42 offen
    s_add_u32 s42, s28, 122880
    buffer_load_dwordx4 v[84:87], v0, s[24:27], s42 offen
    s_add_u32 s42, s28, 5120
    buffer_load_dwordx4 v[88:91], v0, s[24:27], s42 offen
    s_add_u32 s42, s28, 125952
    buffer_load_dwordx4 v[92:95], v0, s[24:27], s42 offen
    buffer_load_dword v29, v28, s[24:27], s31 offen sc1
    s_waitcnt vmcnt(12)
    v_mfma_f32_32x32x16_bf16 v[208:223], v[128:131], v[112:115], 0
    s_waitcnt vmcnt(11)
    v_mfma_f32_32x32x16_bf16 v[240:255], v[128:131], v[116:119], 0
    v_mfma_f32_32x32x16_bf16 v[224:239], v[132:135], v[112:115], 0
    v_mfma_f32_32x32x16_bf16 v[32:47], v[132:135], v[116:119], 0
    s_waitcnt vmcnt(10)
    v_mfma_f32_32x32x16_bf16 v[208:223], v[136:139], v[120:123], v[208:223]
    s_waitcnt vmcnt(9)
    v_mfma_f32_32x32x16_bf16 v[240:255], v[136:139], v[124:127], v[240:255]
    v_mfma_f32_32x32x16_bf16 v[224:239], v[140:143], v[120:123], v[224:239]
    v_mfma_f32_32x32x16_bf16 v[32:47], v[140:143], v[124:127], v[32:47]
    s_waitcnt vmcnt(8)
    v_mfma_f32_32x32x16_bf16 v[208:223], v[144:147], v[48:51], v[208:223]
    s_waitcnt vmcnt(7)
    v_mfma_f32_32x32x16_bf16 v[240:255], v[144:147], v[52:55], v[240:255]
    v_mfma_f32_32x32x16_bf16 v[224:239], v[148:151], v[48:51], v[224:239]
    v_mfma_f32_32x32x16_bf16 v[32:47], v[148:151], v[52:55], v[32:47]
    s_waitcnt vmcnt(6)
    v_mfma_f32_32x32x16_bf16 v[208:223], v[152:155], v[56:59], v[208:223]
    s_waitcnt vmcnt(5)
    v_mfma_f32_32x32x16_bf16 v[240:255], v[152:155], v[60:63], v[240:255]
    v_mfma_f32_32x32x16_bf16 v[224:239], v[156:159], v[56:59], v[224:239]
    v_mfma_f32_32x32x16_bf16 v[32:47], v[156:159], v[60:63], v[32:47]
    ds_read_b64_tr_b16 v[128:129], v31 offset:0
    ds_read_b64_tr_b16 v[130:131], v31 offset:512
    ds_read_b64_tr_b16 v[132:133], v26 offset:0
    ds_read_b64_tr_b16 v[134:135], v26 offset:512
    ds_read_b64_tr_b16 v[136:137], v31 offset:16384
    ds_read_b64_tr_b16 v[138:139], v31 offset:16896
    ds_read_b64_tr_b16 v[140:141], v26 offset:16384
    ds_read_b64_tr_b16 v[142:143], v26 offset:16896
    ds_read_b64_tr_b16 v[144:145], v31 offset:32768
    ds_read_b64_tr_b16 v[146:147], v31 offset:33280
    ds_read_b64_tr_b16 v[148:149], v26 offset:32768
    ds_read_b64_tr_b16 v[150:151], v26 offset:33280
    s_waitcnt vmcnt(0)
    v_cmp_gt_u32 vcc, 4, v29
    s_and_b32 s57, vcc_lo, 240
    s_cbranch_scc1 L_parallel_sum__linear_kernel_hedgehog__glu_gated_glu__prompt_kernel_01_fp2
L_parallel_sum__linear_kernel_hedgehog__glu_gated_glu__prompt_kernel_01_fb2:
    s_add_u32 s42, s29, 0
    buffer_load_dwordx4 v[96:99], v0, s[24:27], s42 offen
    s_add_u32 s42, s29, 120832
    buffer_load_dwordx4 v[100:103], v0, s[24:27], s42 offen
    v_mfma_f32_32x32x16_bf16 v[208:223], v[160:163], v[80:83], v[208:223]
    v_mfma_f32_32x32x16_bf16 v[240:255], v[160:163], v[84:87], v[240:255]
    v_mfma_f32_32x32x16_bf16 v[224:239], v[164:167], v[80:83], v[224:239]
    v_mfma_f32_32x32x16_bf16 v[32:47], v[164:167], v[84:87], v[32:47]
    s_add_u32 s42, s29, 1024
    buffer_load_dwordx4 v[104:107], v0, s[24:27], s42 offen
    s_add_u32 s42, s29, 121856
    buffer_load_dwordx4 v[108:111], v0, s[24:27], s42 offen
    s_add_u32 s42, s29, 2048
    buffer_load_dwordx4 v[112:115], v0, s[24:27], s42 offen
    s_add_u32 s42, s29, 122880
    buffer_load_dwordx4 v[116:119], v0, s[24:27], s42 offen
    v_mfma_f32_32x32x16_bf16 v[208:223], v[168:171], v[88:91], v[208:223]
    v_mfma_f32_32x32x16_bf16 v[240:255], v[168:171], v[92:95], v[240:255]
    v_mfma_f32_32x32x16_bf16 v[224:239], v[172:175], v[88:91], v[224:239]
    v_mfma_f32_32x32x16_bf16 v[32:47], v[172:175], v[92:95], v[32:47]
    s_add_u32 s42, s29, 3072
    buffer_load_dwordx4 v[120:123], v0, s[24:27], s42 offen
    s_add_u32 s42, s29, 123904
    buffer_load_dwordx4 v[124:127], v0, s[24:27], s42 offen
    v_and_b32 v4, 48, v0
    v_bfe_u32 v13, v0, 6, 2
    v_lshl_add_u32 v4, v13, 10, v4
    v_bfe_u32 v7, v0, 8, 1
    v_lshl_add_u32 v4, v7, 6, v4
    v_bfe_u32 v7, v0, 9, 1
    v_lshl_add_u32 v4, v7, 12, v4
    buffer_load_dwordx4 v[8:11], v4, s[8:11], s0 offen
    v_bfe_u32 v7, v0, 8, 2
    v_lshlrev_b32 v7, 11, v7
    v_lshl_add_u32 v7, v13, 4, v7
    v_lshl_add_u32 v7, s37, 7, v7
    v_bfe_u32 v13, v0, 4, 2
    v_mov_b32 v12, 65536
    v_mov_b32 v14, 103232
    v_cmp_eq_u32 vcc, 1, v13
    s_nop 1
    v_cndmask_b32 v12, v12, v14, vcc
    v_mov_b32 v14, 119424
    v_cmp_eq_u32 vcc, 2, v13
    s_nop 1
    v_cndmask_b32 v12, v12, v14, vcc
    v_mov_b32 v14, 135872
    v_cmp_eq_u32 vcc, 3, v13
    s_nop 1
    v_cndmask_b32 v12, v12, v14, vcc
    v_add_u32 v12, v12, v7
    v_and_b32 v14, 16, v0
    v_mov_b32 v7, 0x3f80
    v_lshlrev_b32 v14, v14, v7
    v_bfe_u32 v7, v0, 5, 3
    v_cmp_eq_u32 vcc, 0, v7
    s_nop 1
    v_cndmask_b32 v168, 0, v14, vcc
    v_cmp_eq_u32 vcc, 1, v7
    s_nop 1
    v_cndmask_b32 v169, 0, v14, vcc
    v_cmp_eq_u32 vcc, 2, v7
    s_nop 1
    v_cndmask_b32 v170, 0, v14, vcc
    v_cmp_eq_u32 vcc, 3, v7
    s_nop 1
    v_cndmask_b32 v171, 0, v14, vcc
    v_cmp_eq_u32 vcc, 4, v7
    s_nop 1
    v_cndmask_b32 v172, 0, v14, vcc
    v_cmp_eq_u32 vcc, 5, v7
    s_nop 1
    v_cndmask_b32 v173, 0, v14, vcc
    v_cmp_eq_u32 vcc, 6, v7
    s_nop 1
    v_cndmask_b32 v174, 0, v14, vcc
    v_cmp_eq_u32 vcc, 7, v7
    s_nop 1
    v_cndmask_b32 v175, 0, v14, vcc
    v_cmp_gt_u32 vcc, 3, v29
    s_and_b32 s57, vcc_lo, 15
    s_cbranch_scc1 L_parallel_sum__linear_kernel_hedgehog__glu_gated_glu__prompt_kernel_01_fp3
L_parallel_sum__linear_kernel_hedgehog__glu_gated_glu__prompt_kernel_01_fb3:
    s_add_u32 s42, s30, 2048
    buffer_load_dwordx4 v[48:51], v0, s[24:27], s42 offen
    s_add_u32 s42, s30, 122880
    buffer_load_dwordx4 v[52:55], v0, s[24:27], s42 offen
    s_waitcnt vmcnt(10)
    v_mfma_f32_32x32x16_bf16 v[208:223], v[176:179], v[96:99], v[208:223]
    s_waitcnt vmcnt(9)
    v_mfma_f32_32x32x16_bf16 v[240:255], v[176:179], v[100:103], v[240:255]
    v_mfma_f32_32x32x16_bf16 v[224:239], v[180:183], v[96:99], v[224:239]
    v_mfma_f32_32x32x16_bf16 v[32:47], v[180:183], v[100:103], v[32:47]
    s_add_u32 s42, s36, 0
    buffer_load_dwordx4 v[56:59], v0, s[24:27], s42 offen
    s_add_u32 s42, s36, 120832
    buffer_load_dwordx4 v[60:63], v0, s[24:27], s42 offen
    s_waitcnt vmcnt(10)
    v_mfma_f32_32x32x16_bf16 v[208:223], v[184:187], v[104:107], v[208:223]
    s_waitcnt vmcnt(9)
    v_mfma_f32_32x32x16_bf16 v[240:255], v[184:187], v[108:111], v[240:255]
    v_mfma_f32_32x32x16_bf16 v[224:239], v[188:191], v[104:107], v[224:239]
    v_mfma_f32_32x32x16_bf16 v[32:47], v[188:191], v[108:111], v[32:47]
    s_add_u32 s42, s30, 3072
    buffer_load_dwordx4 v[152:155], v0, s[24:27], s42 offen
    s_add_u32 s42, s30, 123904
    buffer_load_dwordx4 v[156:159], v0, s[24:27], s42 offen
    s_waitcnt vmcnt(10)
    v_mfma_f32_32x32x16_bf16 v[208:223], v[64:67], v[112:115], v[208:223]
    s_waitcnt vmcnt(9)
    v_mfma_f32_32x32x16_bf16 v[240:255], v[64:67], v[116:119], v[240:255]
    v_mfma_f32_32x32x16_bf16 v[224:239], v[68:71], v[112:115], v[224:239]
    v_mfma_f32_32x32x16_bf16 v[32:47], v[68:71], v[116:119], v[32:47]
    s_add_u32 s42, s36, 1024
    buffer_load_dwordx4 v[80:83], v0, s[24:27], s42 offen
    s_add_u32 s42, s36, 121856
    buffer_load_dwordx4 v[84:87], v0, s[24:27], s42 offen
    s_waitcnt vmcnt(10)
    v_mfma_f32_32x32x16_bf16 v[208:223], v[72:75], v[120:123], v[208:223]
    s_waitcnt vmcnt(9)
    v_mfma_f32_32x32x16_bf16 v[240:255], v[72:75], v[124:127], v[240:255]
    v_mfma_f32_32x32x16_bf16 v[224:239], v[76:79], v[120:123], v[224:239]
    v_mfma_f32_32x32x16_bf16 v[32:47], v[76:79], v[124:127], v[32:47]
    s_add_u32 s42, s30, 4096
    buffer_load_dwordx4 v[88:91], v0, s[24:27], s42 offen
    s_add_u32 s42, s30, 124928
    buffer_load_dwordx4 v[92:95], v0, s[24:27], s42 offen
    s_waitcnt vmcnt(9)
    v_mfma_f32_32x32x16_bf16 v[208:223], v[192:195], v[48:51], v[208:223]
    s_waitcnt vmcnt(8)
    v_mfma_f32_32x32x16_bf16 v[240:255], v[192:195], v[52:55], v[240:255]
    v_mfma_f32_32x32x16_bf16 v[224:239], v[196:199], v[48:51], v[224:239]
    v_mfma_f32_32x32x16_bf16 v[32:47], v[196:199], v[52:55], v[32:47]
    s_waitcnt vmcnt(7)
    v_mfma_f32_32x32x16_bf16 v[208:223], v[200:203], v[56:59], v[208:223]
    s_waitcnt vmcnt(6)
    v_mfma_f32_32x32x16_bf16 v[240:255], v[200:203], v[60:63], v[240:255]
    v_mfma_f32_32x32x16_bf16 v[224:239], v[204:207], v[56:59], v[224:239]
    v_mfma_f32_32x32x16_bf16 v[32:47], v[204:207], v[60:63], v[32:47]
    s_waitcnt vmcnt(5) lgkmcnt(10)
    v_mfma_f32_32x32x16_bf16 v[208:223], v[128:131], v[152:155], v[208:223]
    s_waitcnt vmcnt(4)
    v_mfma_f32_32x32x16_bf16 v[240:255], v[128:131], v[156:159], v[240:255]
    s_waitcnt lgkmcnt(8)
    v_mfma_f32_32x32x16_bf16 v[224:239], v[132:135], v[152:155], v[224:239]
    v_mfma_f32_32x32x16_bf16 v[32:47], v[132:135], v[156:159], v[32:47]
    s_lshl_b32 s56, s39, 1
    s_sub_u32 s56, s56, 122880
    v_add_u32 v5, s56, v0
    v_add_u32 v6, 65536, v5
    v_add_u32 v7, 119424, v5
    s_waitcnt vmcnt(3) lgkmcnt(6)
    v_mfma_f32_32x32x16_bf16 v[208:223], v[136:139], v[80:83], v[208:223]
    s_waitcnt vmcnt(1) lgkmcnt(2)
    v_mfma_f32_32x32x16_bf16 v[208:223], v[144:147], v[88:91], v[208:223]
    v_mfma_f32_32x32x16_bf16 v[240:255], v[136:139], v[84:87], v[240:255]
    s_waitcnt vmcnt(0)
    v_mfma_f32_32x32x16_bf16 v[240:255], v[144:147], v[92:95], v[240:255]
    s_nop 8
    v_cvt_pk_bf16_f32 v208, v208, v209
    v_cvt_pk_bf16_f32 v209, v210, v211
    v_cvt_pk_bf16_f32 v210, v212, v213
    v_cvt_pk_bf16_f32 v211, v214, v215
    ds_write_b128 v5, v[208:211] offset:0
    v_cvt_pk_bf16_f32 v216, v216, v217
    v_cvt_pk_bf16_f32 v217, v218, v219
    v_cvt_pk_bf16_f32 v218, v220, v221
    v_cvt_pk_bf16_f32 v219, v222, v223
    ds_write_b128 v5, v[216:219] offset:16448
    v_mfma_f32_32x32x16_bf16 v[224:239], v[140:143], v[80:83], v[224:239]
    s_waitcnt lgkmcnt(2)
    v_mfma_f32_32x32x16_bf16 v[224:239], v[148:151], v[88:91], v[224:239]
    v_cvt_pk_bf16_f32 v240, v240, v241
    v_cvt_pk_bf16_f32 v241, v242, v243
    v_cvt_pk_bf16_f32 v242, v244, v245
    v_cvt_pk_bf16_f32 v243, v246, v247
    ds_write_b128 v6, v[240:243] offset:0
    v_cvt_pk_bf16_f32 v248, v248, v249
    v_cvt_pk_bf16_f32 v249, v250, v251
    v_cvt_pk_bf16_f32 v250, v252, v253
    v_cvt_pk_bf16_f32 v251, v254, v255
    ds_write_b128 v6, v[248:251] offset:37696
    v_mfma_f32_32x32x16_bf16 v[32:47], v[140:143], v[84:87], v[32:47]
    v_mfma_f32_32x32x16_bf16 v[32:47], v[148:151], v[92:95], v[32:47]
    v_cvt_pk_bf16_f32 v224, v224, v225
    v_cvt_pk_bf16_f32 v225, v226, v227
    v_cvt_pk_bf16_f32 v226, v228, v229
    v_cvt_pk_bf16_f32 v227, v230, v231
    ds_write_b128 v5, v[224:227] offset:32896
    v_cvt_pk_bf16_f32 v232, v232, v233
    v_cvt_pk_bf16_f32 v233, v234, v235
    v_cvt_pk_bf16_f32 v234, v236, v237
    v_cvt_pk_bf16_f32 v235, v238, v239
    ds_write_b128 v5, v[232:235] offset:49344
    v_lshlrev_b32 v16, 16, v8
    v_and_b32 v17, s55, v8
    v_lshlrev_b32 v18, 16, v9
    v_and_b32 v19, s55, v9
    v_lshlrev_b32 v20, 16, v10
    v_and_b32 v21, s55, v10
    v_lshlrev_b32 v22, 16, v11
    v_and_b32 v23, s55, v11
    v_cvt_pk_bf16_f32 v32, v32, v33
    v_cvt_pk_bf16_f32 v33, v34, v35
    v_cvt_pk_bf16_f32 v34, v36, v37
    v_cvt_pk_bf16_f32 v35, v38, v39
    ds_write_b128 v7, v[32:35] offset:0
    v_cvt_pk_bf16_f32 v40, v40, v41
    v_cvt_pk_bf16_f32 v41, v42, v43
    v_cvt_pk_bf16_f32 v42, v44, v45
    v_cvt_pk_bf16_f32 v43, v46, v47
    ds_write_b128 v7, v[40:43] offset:16448
    s_waitcnt lgkmcnt(0)
    s_barrier
    ds_read_b128 v[128:131], v12 offset:0
    ds_read_b128 v[132:135], v12 offset:512
    ds_read_b128 v[136:139], v12 offset:64
    ds_read_b128 v[140:143], v12 offset:576
    ds_read_b128 v[144:147], v12 offset:8192
    ds_read_b128 v[148:151], v12 offset:8704
    ds_read_b128 v[152:155], v12 offset:8256
    ds_read_b128 v[156:159], v12 offset:8768
    s_waitcnt lgkmcnt(7)
    v_mfma_f32_16x16x32_bf16 v[16:19], v[168:171], v[128:131], v[16:19]
    s_waitcnt lgkmcnt(6)
    v_mfma_f32_16x16x32_bf16 v[20:23], v[168:171], v[132:135], v[20:23]
    s_waitcnt lgkmcnt(5)
    v_mfma_f32_16x16x32_bf16 v[16:19], v[172:175], v[136:139], v[16:19]
    s_waitcnt lgkmcnt(4)
    v_mfma_f32_16x16x32_bf16 v[20:23], v[172:175], v[140:143], v[20:23]
    s_waitcnt lgkmcnt(3)
    v_mfma_f32_16x16x32_bf16 v[16:19], v[168:171], v[144:147], v[16:19]
    s_waitcnt lgkmcnt(2)
    v_mfma_f32_16x16x32_bf16 v[20:23], v[168:171], v[148:151], v[20:23]
    s_waitcnt lgkmcnt(1)
    v_mfma_f32_16x16x32_bf16 v[16:19], v[172:175], v[152:155], v[16:19]
    s_waitcnt lgkmcnt(0)
    v_mfma_f32_16x16x32_bf16 v[20:23], v[172:175], v[156:159], v[20:23]
    s_nop 5
    v_cvt_pk_bf16_f32 v16, v16, v17
    v_cvt_pk_bf16_f32 v17, v18, v19
    v_cvt_pk_bf16_f32 v18, v20, v21
    v_cvt_pk_bf16_f32 v19, v22, v23
    buffer_store_dwordx4 v[16:19], v4, s[12:15], s0 offen sc1
    s_endpgm
.p2align 6
L_parallel_sum__linear_kernel_hedgehog__glu_gated_glu__prompt_kernel_r2:
    s_mov_b32 s30, 16384
    s_mov_b32 s31, 0x20000
    s_mov_b32 s18, 1409024
    s_mov_b32 s19, 0x20000
    s_mov_b32 s26, 16777216
    s_mov_b32 s27, 0x20000
    s_mov_b32 s6, 256
    s_mov_b32 s7, 0x20000
    s_mov_b32 s50, 1409024
    s_mov_b32 s51, 0x20000
    s_mov_b32 s55, 0xffff0000
    s_getreg_b32 s100, hwreg(HW_REG_XCC_ID, 0, 4)
    s_mul_i32 s101, s100, s100
    s_lshl_b32 s101, s101, 9
    s_add_u32 s100, s100, s101
    s_lshl_b32 s100, s100, 8
    s_add_u32 s100, s100, 1
    s_lshl_b32 s3, s37, 2
    v_mov_b32 v121, v2
    v_lshrrev_b32 v116, 5, v82
    v_and_b32 v117, 1, v2
    v_bfe_u32 v118, v82, 2, 2
    v_bfe_u32 v112, v82, 1, 1
    v_and_b32 v113, 1, v82
    v_lshl_or_b32 v119, v113, 1, v112
    v_lshlrev_b32 v119, 3, v119
    v_lshl_add_u32 v120, v116, 3, v118
    v_lshl_or_b32 v114, v117, 1, v112
    v_lshlrev_b32 v114, 3, v114
    v_lshl_add_u32 v114, v120, 5, v114
    v_lshl_add_u32 v114, v113, 11, v114
    v_add_u32 v27, 158336, v114
    v_and_b32 v113, 2, v118
    v_or_b32 v113, v113, v117
    v_lshl_add_u32 v113, v113, 5, v119
    v_lshl_add_u32 v113, v120, 7, v113
    s_lshl_b32 s56, s37, 11
    v_xor_b32 v104, s56, v113
    v_and_b32 v112, 31, v82
    v_bfe_u32 v113, v82, 1, 3
    v_xor_b32 v113, v113, v116
    v_lshlrev_b32 v113, 4, v113
    v_lshl_add_u32 v113, v112, 7, v113
    s_mul_i32 s56, s37, 4128
    v_xor_b32 v96, s56, v113
    v_xor_b32 v97, 32, v96
    v_xor_b32 v105, 2048, v104
    v_xor_b32 v98, 64, v96
    v_xor_b32 v106, 4096, v104
    v_xor_b32 v99, 96, v96
    v_xor_b32 v107, 6144, v104
    v_add_u32 v100, 73920, v96
    v_add_u32 v108, 90304, v104
    v_add_u32 v104, 16384, v104
    v_add_u32 v101, 73920, v97
    v_add_u32 v109, 90304, v105
    v_add_u32 v105, 16384, v105
    v_add_u32 v102, 73920, v98
    v_add_u32 v110, 90304, v106
    v_add_u32 v106, 16384, v106
    v_add_u32 v103, 73920, v99
    v_add_u32 v111, 90304, v107
    v_add_u32 v107, 16384, v107
    s_lshl_b32 s56, s37, 9
    s_add_u32 s56, s56, 131072
    v_lshlrev_b32 v113, 4, v112
    v_add_u32 v71, s56, v113
    v_lshl_add_u32 v70, v116, 2, v71
    v_lshl_add_u32 v70, v117, 3, v70
    v_mul_u32_u24 v113, 192, v120
    v_mul_u32_u24 v114, 12320, v117
    v_add3_u32 v113, v113, v114, v119
    s_xor_b32 s56, s37, 0
    s_mul_i32 s56, s56, 3072
    v_add_u32 v4, s56, v113
    s_xor_b32 s56, s37, 1
    s_mul_i32 s56, s56, 3072
    v_add_u32 v5, s56, v113
    s_xor_b32 s56, s37, 2
    s_mul_i32 s56, s56, 3072
    v_add_u32 v6, s56, v113
    s_xor_b32 s56, s37, 3
    s_mul_i32 s56, s56, 3072
    v_add_u32 v7, s56, v113
    s_mul_i32 s40, s37, 3072
    s_mul_i32 s58, s34, 6
    s_mul_i32 s56, s37, 44032
    s_lshl_b32 s57, s58, 5
    s_add_u32 s56, s56, s57
    s_mov_b32 s57, 2560
    v_lshlrev_b32 v112, 4, v82
    v_add_u32 v0, 122880, v112
    v_add_u32 v112, s56, v112
    v_mul_u32_u24 v113, 171, v82
    v_lshrrev_b32 v114, 11, v113
    v_mad_u32_u24 v1, v114, s57, v112
    v_add_u32 v113, 10944, v113
    v_lshrrev_b32 v114, 11, v113
    v_mad_u32_u24 v2, v114, s57, v112
    v_add_u32 v113, 10944, v113
    v_lshrrev_b32 v114, 11, v113
    v_mad_u32_u24 v3, v114, s57, v112
    v_and_b32 v112, 15, v82
    v_lshlrev_b32 v113, 2, v121
    v_mov_b32 v114, 0x3f803f80
    v_cmp_eq_u32 vcc, v112, v113
    s_nop 1
    v_cndmask_b32 v12, 0, v114, vcc
    v_cndmask_b32 v13, 0, v114, vcc
    v_cndmask_b32 v14, 0, v114, vcc
    v_cndmask_b32 v15, 0, v114, vcc
    v_xor_b32 v113, s3, v113
    v_or_b32 v72, v113, v0
    s_lshl2_add_u32 s56, s33, s37
    s_mul_i32 s56, s56, 118
    s_add_u32 s57, s56, s58
    s_add_u32 s57, s57, 32
    s_lshl_b32 s52, s57, 10
    s_lshr_b32 s57, s32, 1
    s_lshl2_add_u32 s57, s34, s57
    s_mul_i32 s57, s57, 17408
    s_and_b32 s58, s32, 1
    s_add_u32 s54, s57, 12476416
    s_lshl_b32 s58, s58, 13
    s_add_u32 s53, s57, s58
    s_add_u32 s53, s53, 12460032
    s_lshl2_add_u32 s56, s34, s56
    s_add_u32 s56, s56, 0
    s_lshl_b32 s35, s56, 10
    v_lshlrev_b32 v112, 2, v82
    s_lshl_b32 s56, s32, 8
    s_lshl_b32 s57, s34, 11
    s_add_u32 s57, s57, s56
    s_add_u32 s56, s56, 158336
    v_add_u32 v92, s56, v112
    s_lshr_b32 s56, s37, 1
    s_lshl1_add_u32 s56, s33, s56
    s_lshl3_add_u32 s56, s56, s34
    s_lshl_b32 s56, s56, 7
    s_and_b32 s58, s37, 1
    s_lshl2_add_u32 s56, s58, s56
    s_add_u32 s33, s56, 13631504
    v_mov_b32 v113, 0
    v_and_b32 v114, 7, v82
    v_lshlrev_b32 v114, 4, v114
    v_and_b32 v115, 16, v82
    v_lshlrev_b32 v115, 1, v115
    v_xor_b32 v114, v114, v115
    v_lshrrev_b32 v115, 3, v82
    v_lshl_add_u32 v28, v115, 10, v114
    v_and_b32 v114, 16, v82
    v_and_b32 v115, 1, v82
    v_lshl_add_u32 v114, v115, 3, v114
    v_and_b32 v115, 14, v82
    v_lshl_add_u32 v114, v115, 5, v114
    v_and_b32 v115, 8, v82
    v_lshl_add_u32 v114, v115, 2, v114
    v_lshrrev_b32 v115, 5, v82
    v_lshl_add_u32 v114, v115, 10, v114
    v_lshl_add_u32 v114, s39, 1, v114
    v_xor_b32 v115, 32, v114
    v_add_u32 v29, 90304, v114
    v_add_u32 v30, 90304, v115
    v_lshlrev_b32 v93, 7, v82
    s_waitcnt lgkmcnt(0)
    s_add_u32 s41, s36, 1
    s_and_b32 s41, s41, 7
    s_add_u32 m0, s38, 73920
    s_lshl_b32 s42, s41, 7
    buffer_load_dwordx4 v80, s[8:11], s42 offen lds
    s_add_u32 s42, s42, 14336
    buffer_load_dwordx4 v80, s[8:11], s42 offen offset:2048 lds
    buffer_load_dword v91, v112, s[28:31], s57 offen
    s_add_u32 s41, s36, 1
    s_and_b32 s41, s41, 7
    s_add_u32 m0, s39, 90304
    s_mul_i32 s43, s41, 196608
    buffer_load_dwordx4 v81, s[12:15], s43 offen lds
    s_add_u32 s41, s36, 2
    s_and_b32 s41, s41, 7
    s_add_u32 m0, s38, 98560
    s_lshl_b32 s42, s41, 7
    buffer_load_dwordx4 v80, s[8:11], s42 offen lds
    s_add_u32 s42, s42, 14336
    buffer_load_dwordx4 v80, s[8:11], s42 offen offset:2048 lds
    s_lshr_b32 s56, s2, 3
    s_lshl2_add_u32 s56, s56, s37
    s_mul_i32 s56, s56, 12288
    v_lshlrev_b32 v112, 3, v93
    s_mov_b64 exec, 0xfff
    buffer_load_dword v75, v112, s[12:15], s56 offen offset:896
    s_mov_b64 exec, 1
    buffer_store_dword v113, off, s[24:27], s33 sc1
    s_mov_b64 exec, -1
    s_mov_b32 s0, 0xaaaaaaaa
    s_mov_b32 s1, 0xaaaaaaaa
    s_mov_b32 s28, 0xcccccccc
    s_mov_b32 s29, 0xcccccccc
    s_mov_b32 s30, 0xff00ff00
    s_mov_b32 s31, 0xff00ff00
    s_mov_b32 s20, 0xffff0000
    s_mov_b32 s21, 0xffff0000
    s_mov_b32 s22, 0xf0f0f0f
    s_mov_b32 s23, 0xf0f0f0f0
    s_waitcnt vmcnt(9)
    s_waitcnt vmcnt(8)
    s_barrier
    ds_read_b128 v[128:131], v96 offset:49280
    ds_read_b64_tr_b16 v[32:33], v104 offset:49280
    ds_read_b64_tr_b16 v[34:35], v104 offset:49792
    ds_read_b128 v[132:135], v97 offset:49280
    ds_read_b128 v[136:139], v98 offset:49280
    ds_read_b128 v[140:143], v99 offset:49280
    ds_read_b64_tr_b16 v[36:37], v105 offset:49280
    ds_read_b64_tr_b16 v[38:39], v105 offset:49792
    ds_read_b64_tr_b16 v[40:41], v106 offset:49280
    ds_read_b64_tr_b16 v[42:43], v106 offset:49792
    ds_read_b64_tr_b16 v[44:45], v107 offset:49280
    ds_read_b64_tr_b16 v[46:47], v107 offset:49792
    s_waitcnt lgkmcnt(9)
    v_mfma_f32_16x16x32_bf16 v[16:19], v[12:15], v[32:35], 0
    v_mfma_f32_32x32x16_bf16 v[48:63], v[32:35], v[128:131], 0
    v_mov_b32 v66, 0
    v_mov_b32 v67, 0
    v_lshlrev_b32 v77, 3, v93
    s_waitcnt lgkmcnt(4)
    v_mfma_f32_16x16x32_bf16 v[20:23], v[12:15], v[128:131], 0
    v_mfma_f32_32x32x16_bf16 v[48:63], v[36:39], v[132:135], v[48:63]
    s_waitcnt lgkmcnt(2)
    v_mfma_f32_16x16x32_bf16 v[20:23], v[12:15], v[132:135], v[20:23]
    v_mfma_f32_32x32x16_bf16 v[48:63], v[40:43], v[136:139], v[48:63]
    s_add_u32 s41, s36, 2
    s_and_b32 s41, s41, 7
    s_add_u32 m0, s39, 114944
    s_mul_i32 s43, s41, 196608
    buffer_load_dwordx4 v81, s[12:15], s43 offen lds
    s_add_u32 s41, s36, 3
    s_and_b32 s41, s41, 7
    s_add_u32 m0, s38, 0
    s_lshl_b32 s42, s41, 7
    buffer_load_dwordx4 v80, s[8:11], s42 offen lds
    s_add_u32 s42, s42, 14336
    buffer_load_dwordx4 v80, s[8:11], s42 offen offset:2048 lds
    s_waitcnt vmcnt(9)
    s_waitcnt vmcnt(7)
    s_waitcnt vmcnt(5)
    s_barrier
    ds_read_b128 v[144:147], v100 offset:0
    ds_read_b64_tr_b16 v[40:41], v108 offset:0
    ds_read_b64_tr_b16 v[42:43], v108 offset:512
    ds_read_b128 v[148:151], v101 offset:0
    ds_read_b128 v[152:155], v102 offset:0
    ds_read_b128 v[156:159], v103 offset:0
    s_waitcnt lgkmcnt(6)
    v_mfma_f32_32x32x16_bf16 v[48:63], v[44:47], v[140:143], v[48:63]
    s_add_u32 s41, s36, 3
    s_and_b32 s41, s41, 7
    s_add_u32 m0, s39, 16384
    s_mul_i32 s43, s41, 196608
    buffer_load_dwordx4 v81, s[12:15], s43 offen lds
    ds_read_b64_tr_b16 v[44:45], v109 offset:0
    ds_read_b64_tr_b16 v[46:47], v109 offset:512
    v_mfma_f32_32x32x16_bf16 v[112:127], v[128:131], v[128:131], 0
    s_add_u32 s41, s36, 4
    s_and_b32 s41, s41, 7
    s_add_u32 m0, s38, 24640
    s_lshl_b32 s42, s41, 7
    buffer_load_dwordx4 v80, s[8:11], s42 offen lds
    ds_read_b64_tr_b16 v[32:33], v110 offset:0
    ds_read_b64_tr_b16 v[34:35], v110 offset:512
    v_mfma_f32_32x32x16_bf16 v[112:127], v[132:135], v[132:135], v[112:127]
    s_add_u32 s42, s42, 14336
    buffer_load_dwordx4 v80, s[8:11], s42 offen offset:2048 lds
    ds_read_b64_tr_b16 v[36:37], v111 offset:0
    ds_read_b64_tr_b16 v[38:39], v111 offset:512
    s_waitcnt lgkmcnt(9)
    v_mfma_f32_16x16x32_bf16 v[16:19], v[12:15], v[40:43], v[16:19]
    v_mfma_f32_32x32x16_bf16 v[48:63], v[40:43], v[144:147], v[48:63]
    ds_read_b128 v[160:163], v100 offset:24640
    ds_read_b128 v[164:167], v101 offset:24640
    s_waitcnt lgkmcnt(6)
    v_mfma_f32_16x16x32_bf16 v[20:23], v[12:15], v[144:147], v[20:23]
    v_mfma_f32_32x32x16_bf16 v[48:63], v[44:47], v[148:151], v[48:63]
    ds_read_b128 v[168:171], v102 offset:24640
    ds_read_b128 v[172:175], v103 offset:24640
    s_waitcnt lgkmcnt(6)
    v_mfma_f32_16x16x32_bf16 v[20:23], v[12:15], v[148:151], v[20:23]
    v_mfma_f32_32x32x16_bf16 v[48:63], v[32:35], v[152:155], v[48:63]
    s_waitcnt vmcnt(5)
    s_waitcnt vmcnt(3)
    s_barrier
    ds_read_b64_tr_b16 v[32:33], v108 offset:24640
    ds_read_b64_tr_b16 v[34:35], v108 offset:25152
    s_waitcnt lgkmcnt(5)
    v_mfma_f32_16x16x32_bf16 v[20:23], v[12:15], v[160:163], v[20:23]
    v_mfma_f32_32x32x16_bf16 v[48:63], v[36:39], v[156:159], v[48:63]
    s_add_u32 s41, s36, 4
    s_and_b32 s41, s41, 7
    s_add_u32 m0, s39, 41024
    s_mul_i32 s43, s41, 196608
    buffer_load_dwordx4 v81, s[12:15], s43 offen lds
    ds_write_b32 v92, v91
    ds_read_b64_tr_b16 v[36:37], v109 offset:24640
    ds_read_b64_tr_b16 v[38:39], v109 offset:25152
    s_waitcnt lgkmcnt(7)
    v_mfma_f32_16x16x32_bf16 v[20:23], v[12:15], v[164:167], v[20:23]
    v_mfma_f32_32x32x16_bf16 v[112:127], v[144:147], v[144:147], v[112:127]
    v_xor_b32 v91, 0x80008000, v91
    s_add_u32 s41, s36, 5
    s_and_b32 s41, s41, 7
    s_add_u32 m0, s38, 49280
    s_lshl_b32 s42, s41, 7
    buffer_load_dwordx4 v80, s[8:11], s42 offen lds
    ds_read_b128 v[176:179], v96 offset:0
    ds_read_b128 v[180:183], v97 offset:0
    ds_read_b64_tr_b16 v[40:41], v110 offset:24640
    ds_read_b64_tr_b16 v[42:43], v110 offset:25152
    v_mfma_f32_32x32x16_bf16 v[112:127], v[148:151], v[148:151], v[112:127]
    s_add_u32 s42, s42, 14336
    buffer_load_dwordx4 v80, s[8:11], s42 offen offset:2048 lds
    ds_read_b128 v[184:187], v98 offset:0
    ds_read_b128 v[188:191], v99 offset:0
    ds_read_b64_tr_b16 v[44:45], v111 offset:24640
    ds_read_b64_tr_b16 v[46:47], v111 offset:25152
    s_waitcnt lgkmcnt(11)
    v_mfma_f32_16x16x32_bf16 v[16:19], v[12:15], v[32:35], v[16:19]
    v_mfma_f32_32x32x16_bf16 v[48:63], v[32:35], v[160:163], v[48:63]
    ds_write_b32 v92, v91 offset:2048
    s_waitcnt lgkmcnt(8)
    v_mfma_f32_16x16x32_bf16 v[20:23], v[12:15], v[176:179], v[20:23]
    v_mfma_f32_32x32x16_bf16 v[48:63], v[36:39], v[164:167], v[48:63]
    s_waitcnt lgkmcnt(5)
    v_mfma_f32_16x16x32_bf16 v[20:23], v[12:15], v[180:183], v[20:23]
    v_mfma_f32_32x32x16_bf16 v[48:63], v[40:43], v[168:171], v[48:63]
    s_waitcnt lgkmcnt(1)
    v_mfma_f32_32x32x16_bf16 v[48:63], v[44:47], v[172:175], v[48:63]
    v_mfma_f32_32x32x16_bf16 v[112:127], v[160:163], v[160:163], v[112:127]
    s_waitcnt vmcnt(5)
    s_waitcnt vmcnt(3)
    s_barrier
    ds_read_b64_tr_b16 v[32:33], v104 offset:0
    ds_read_b64_tr_b16 v[34:35], v104 offset:512
    v_mfma_f32_32x32x16_bf16 v[112:127], v[164:167], v[164:167], v[112:127]
    s_add_u32 s41, s36, 5
    s_and_b32 s41, s41, 7
    s_add_u32 m0, s39, 65664
    s_mul_i32 s43, s41, 196608
    buffer_load_dwordx4 v81, s[12:15], s43 offen lds
    ds_read_b64_tr_b16 v[36:37], v105 offset:0
    ds_read_b64_tr_b16 v[38:39], v105 offset:512
    v_mfma_f32_32x32x16_bf16 v[112:127], v[176:179], v[176:179], v[112:127]
    s_add_u32 s41, s36, 6
    s_and_b32 s41, s41, 7
    s_add_u32 m0, s38, 73920
    s_lshl_b32 s42, s41, 7
    buffer_load_dwordx4 v80, s[8:11], s42 offen lds
    ds_read_b128 v[192:195], v96 offset:24640
    ds_read_b128 v[196:199], v97 offset:24640
    ds_read_b64_tr_b16 v[40:41], v106 offset:0
    ds_read_b64_tr_b16 v[42:43], v106 offset:512
    v_mfma_f32_32x32x16_bf16 v[112:127], v[180:183], v[180:183], v[112:127]
    s_add_u32 s42, s42, 14336
    buffer_load_dwordx4 v80, s[8:11], s42 offen offset:2048 lds
    ds_read_b128 v[200:203], v98 offset:24640
    ds_read_b128 v[204:207], v99 offset:24640
    ds_read_b64_tr_b16 v[44:45], v107 offset:0
    ds_read_b64_tr_b16 v[46:47], v107 offset:512
    s_waitcnt lgkmcnt(10)
    v_mfma_f32_16x16x32_bf16 v[16:19], v[12:15], v[32:35], v[16:19]
    v_mfma_f32_32x32x16_bf16 v[48:63], v[32:35], v[176:179], v[48:63]
    s_waitcnt lgkmcnt(7)
    v_mfma_f32_16x16x32_bf16 v[20:23], v[12:15], v[192:195], v[20:23]
    v_mfma_f32_32x32x16_bf16 v[48:63], v[36:39], v[180:183], v[48:63]
    s_waitcnt lgkmcnt(4)
    v_mfma_f32_16x16x32_bf16 v[20:23], v[12:15], v[196:199], v[20:23]
    v_mfma_f32_32x32x16_bf16 v[48:63], v[40:43], v[184:187], v[48:63]
    s_waitcnt vmcnt(5)
    s_waitcnt vmcnt(3)
    s_barrier
    ds_read_b64_tr_b16 v[40:41], v104 offset:24640
    ds_read_b64_tr_b16 v[42:43], v104 offset:25152
    s_waitcnt lgkmcnt(2)
    v_mfma_f32_32x32x16_bf16 v[48:63], v[44:47], v[188:191], v[48:63]
    s_add_u32 s41, s36, 6
    s_and_b32 s41, s41, 7
    s_add_u32 m0, s39, 90304
    s_mul_i32 s43, s41, 196608
    buffer_load_dwordx4 v81, s[12:15], s43 offen lds
    ds_read_b64_tr_b16 v[44:45], v105 offset:24640
    ds_read_b64_tr_b16 v[46:47], v105 offset:25152
    v_mfma_f32_32x32x16_bf16 v[112:127], v[192:195], v[192:195], v[112:127]
    s_add_u32 s41, s36, 7
    s_and_b32 s41, s41, 7
    s_add_u32 m0, s38, 98560
    s_lshl_b32 s42, s41, 7
    buffer_load_dwordx4 v80, s[8:11], s42 offen lds
    ds_read_b128 v[208:211], v96 offset:49280
    ds_read_b128 v[212:215], v97 offset:49280
    ds_read_b64_tr_b16 v[32:33], v106 offset:24640
    ds_read_b64_tr_b16 v[34:35], v106 offset:25152
    v_mfma_f32_32x32x16_bf16 v[112:127], v[196:199], v[196:199], v[112:127]
    s_add_u32 s42, s42, 14336
    buffer_load_dwordx4 v80, s[8:11], s42 offen offset:2048 lds
    ds_read_b128 v[216:219], v98 offset:49280
    ds_read_b128 v[220:223], v99 offset:49280
    ds_read_b64_tr_b16 v[36:37], v107 offset:24640
    ds_read_b64_tr_b16 v[38:39], v107 offset:25152
    s_waitcnt lgkmcnt(10)
    v_mfma_f32_16x16x32_bf16 v[16:19], v[12:15], v[40:43], v[16:19]
    v_mfma_f32_32x32x16_bf16 v[48:63], v[40:43], v[192:195], v[48:63]
    s_waitcnt lgkmcnt(7)
    v_mfma_f32_16x16x32_bf16 v[20:23], v[12:15], v[208:211], v[20:23]
    v_mfma_f32_32x32x16_bf16 v[48:63], v[44:47], v[196:199], v[48:63]
    s_waitcnt lgkmcnt(4)
    v_mfma_f32_16x16x32_bf16 v[20:23], v[12:15], v[212:215], v[20:23]
    v_mfma_f32_32x32x16_bf16 v[48:63], v[32:35], v[200:203], v[48:63]
    s_waitcnt vmcnt(5)
    s_waitcnt vmcnt(3)
    s_barrier
    ds_read_b64_tr_b16 v[32:33], v104 offset:49280
    ds_read_b64_tr_b16 v[34:35], v104 offset:49792
    s_waitcnt lgkmcnt(2)
    v_mfma_f32_32x32x16_bf16 v[48:63], v[36:39], v[204:207], v[48:63]
    s_add_u32 s41, s36, 7
    s_and_b32 s41, s41, 7
    s_add_u32 m0, s39, 114944
    s_mul_i32 s43, s41, 196608
    buffer_load_dwordx4 v81, s[12:15], s43 offen lds
    s_mov_b32 s12, s46
    s_mov_b32 s13, s47
    s_mov_b32 s14, 2097152
    s_mov_b32 s46, 524288
    s_mov_b32 s47, 0x20000
    ds_read_b64_tr_b16 v[36:37], v105 offset:49280
    ds_read_b64_tr_b16 v[38:39], v105 offset:49792
    v_mfma_f32_32x32x16_bf16 v[112:127], v[208:211], v[208:211], v[112:127]
    s_add_u32 s41, s36, 8
    s_and_b32 s41, s41, 7
    s_add_u32 m0, s40, 0
    s_mul_i32 s43, s41, 176128
    buffer_load_dwordx4 v1, s[16:19], s43 offen lds
    ds_read_b128 v[224:227], v100 offset:0
    ds_read_b128 v[228:231], v101 offset:0
    ds_read_b64_tr_b16 v[40:41], v106 offset:49280
    ds_read_b64_tr_b16 v[42:43], v106 offset:49792
    v_mfma_f32_32x32x16_bf16 v[112:127], v[212:215], v[212:215], v[112:127]
    buffer_load_dwordx4 v2, s[16:19], s43 offen offset:1024 lds
    ds_read_b128 v[232:235], v102 offset:0
    ds_read_b128 v[236:239], v103 offset:0
    ds_read_b64_tr_b16 v[44:45], v107 offset:49280
    ds_read_b64_tr_b16 v[46:47], v107 offset:49792
    s_waitcnt lgkmcnt(10)
    v_mfma_f32_16x16x32_bf16 v[16:19], v[12:15], v[32:35], v[16:19]
    v_mfma_f32_32x32x16_bf16 v[48:63], v[32:35], v[208:211], v[48:63]
    s_waitcnt lgkmcnt(7)
    v_mfma_f32_16x16x32_bf16 v[20:23], v[12:15], v[224:227], v[20:23]
    v_mfma_f32_32x32x16_bf16 v[48:63], v[36:39], v[212:215], v[48:63]
    s_waitcnt lgkmcnt(4)
    v_mfma_f32_16x16x32_bf16 v[20:23], v[12:15], v[228:231], v[20:23]
    v_mfma_f32_32x32x16_bf16 v[48:63], v[40:43], v[216:219], v[48:63]
    s_waitcnt vmcnt(5)
    s_waitcnt vmcnt(3)
    s_barrier
    ds_read_b64_tr_b16 v[40:41], v108 offset:0
    ds_read_b64_tr_b16 v[42:43], v108 offset:512
    s_waitcnt lgkmcnt(2)
    v_mfma_f32_32x32x16_bf16 v[48:63], v[44:47], v[220:223], v[48:63]
    buffer_load_dwordx4 v3, s[16:19], s43 offen offset:2048 lds
    v_mfma_f32_32x32x16_bf16 v[112:127], v[224:227], v[224:227], v[112:127]
    ds_read_b128 v[240:243], v100 offset:24640
    ds_read_b128 v[244:247], v101 offset:24640
    s_lshl3_add_u32 s56, s2, s32
    s_sub_u32 s56, s56, 1024
    s_lshl_b32 s57, s56, 9
    s_mov_b64 exec, 15
    buffer_load_dword v26, v93, s[44:47], s57 offen
    s_mov_b64 exec, -1
    v_mfma_f32_32x32x16_bf16 v[112:127], v[228:231], v[228:231], v[112:127]
    s_add_u32 s41, s36, 9
    s_and_b32 s41, s41, 7
    s_add_u32 m0, s40, 24640
    s_mul_i32 s43, s41, 176128
    buffer_load_dwordx4 v1, s[16:19], s43 offen lds
    ds_read_b128 v[248:251], v102 offset:24640
    ds_read_b128 v[252:255], v103 offset:24640
    ds_read_b64_tr_b16 v[36:37], v109 offset:0
    ds_read_b64_tr_b16 v[38:39], v109 offset:512
    s_waitcnt lgkmcnt(6)
    v_mfma_f32_16x16x32_bf16 v[16:19], v[12:15], v[40:43], v[16:19]
    v_mfma_f32_32x32x16_bf16 v[48:63], v[40:43], v[224:227], v[48:63]
    s_mul_i32 s57, s56, 1408
    s_mov_b64 exec, 0x7ff
    buffer_load_dword v31, v93, s[48:51], s57 offen
    s_mov_b64 exec, -1
    ds_read_b64_tr_b16 v[40:41], v110 offset:0
    ds_read_b64_tr_b16 v[42:43], v110 offset:512
    s_waitcnt lgkmcnt(7)
    v_mfma_f32_16x16x32_bf16 v[20:23], v[12:15], v[240:243], v[20:23]
    v_mfma_f32_32x32x16_bf16 v[112:127], v[240:243], v[240:243], v[112:127]
    buffer_load_dwordx4 v2, s[16:19], s43 offen offset:1024 lds
    ds_read_b64_tr_b16 v[44:45], v111 offset:0
    ds_read_b64_tr_b16 v[46:47], v111 offset:512
    s_waitcnt lgkmcnt(8)
    v_mfma_f32_16x16x32_bf16 v[20:23], v[12:15], v[244:247], v[20:23]
    v_mfma_f32_32x32x16_bf16 v[112:127], v[244:247], v[244:247], v[112:127]
    s_waitcnt vmcnt(7)
    s_barrier
    ds_read_b64_tr_b16 v[32:33], v108 offset:24640
    ds_read_b64_tr_b16 v[34:35], v108 offset:25152
    s_waitcnt lgkmcnt(6)
    v_mfma_f32_32x32x16_bf16 v[48:63], v[36:39], v[228:231], v[48:63]
    s_nop 0
    v_mov_b32 v64, v20
    buffer_load_dwordx4 v3, s[16:19], s43 offen offset:2048 lds
    ds_read_b64_tr_b16 v[36:37], v109 offset:24640
    ds_read_b64_tr_b16 v[38:39], v109 offset:25152
    s_waitcnt lgkmcnt(6)
    v_mfma_f32_32x32x16_bf16 v[48:63], v[40:43], v[232:235], v[48:63]
    v_cndmask_b32 v112, v112, v113, s[0:1]
    v_cndmask_b32 v114, v114, v115, s[0:1]
    v_cndmask_b32 v116, v116, v117, s[0:1]
    v_cndmask_b32 v118, v118, v119, s[0:1]
    s_add_u32 s41, s36, 10
    s_and_b32 s41, s41, 7
    s_add_u32 m0, s40, 49280
    s_mul_i32 s43, s41, 176128
    buffer_load_dwordx4 v1, s[16:19], s43 offen lds
    ds_read_b64_tr_b16 v[40:41], v110 offset:24640
    ds_read_b64_tr_b16 v[42:43], v110 offset:25152
    s_waitcnt lgkmcnt(6)
    v_mfma_f32_32x32x16_bf16 v[48:63], v[44:47], v[236:239], v[48:63]
    v_cndmask_b32 v120, v120, v121, s[0:1]
    v_cndmask_b32 v122, v122, v123, s[0:1]
    v_cndmask_b32 v124, v124, v125, s[0:1]
    v_cndmask_b32 v126, v126, v127, s[0:1]
    buffer_load_dwordx4 v2, s[16:19], s43 offen offset:1024 lds
    ds_read_b64_tr_b16 v[44:45], v111 offset:24640
    ds_read_b64_tr_b16 v[46:47], v111 offset:25152
    s_waitcnt lgkmcnt(6)
    v_mfma_f32_16x16x32_bf16 v[16:19], v[12:15], v[32:35], v[16:19]
    v_mfma_f32_32x32x16_bf16 v[48:63], v[32:35], v[240:243], v[48:63]
    v_cndmask_b32 v112, v112, v114, s[28:29]
    v_cndmask_b32 v116, v116, v118, s[28:29]
    v_cndmask_b32 v120, v120, v122, s[28:29]
    v_cndmask_b32 v124, v124, v126, s[28:29]
    s_waitcnt vmcnt(7)
    s_barrier
    ds_read_b64_tr_b16 v[32:33], v4 offset:0
    ds_read_b64_tr_b16 v[34:35], v4 offset:768
    s_waitcnt lgkmcnt(6)
    v_mfma_f32_32x32x16_bf16 v[48:63], v[36:39], v[244:247], v[48:63]
    v_and_b32 v73, s55, v16
    v_sub_f32 v74, v16, v73
    v_cvt_pk_bf16_f32 v73, v73, v74
    v_cndmask_b32 v112, v112, v116, s[30:31]
    v_cndmask_b32 v120, v120, v124, s[30:31]
    v_cndmask_b32 v112, v112, v120, s[20:21]
    buffer_load_dwordx4 v3, s[16:19], s43 offen offset:2048 lds
    ds_write_b32 v72, v73 offset:33408
    ds_read_b64_tr_b16 v[36:37], v4 offset:32
    ds_read_b64_tr_b16 v[38:39], v4 offset:800
    s_waitcnt lgkmcnt(7)
    v_mfma_f32_32x32x16_bf16 v[48:63], v[40:43], v[248:251], v[48:63]
    v_cndmask_b32 v65, 0, v112, s[22:23]
    s_nop 1
    v_permlane32_swap_b32 v64, v65
    v_add_f32 v64, v64, v65
    v_mov_b32 v65, 0
    ds_write_b32 v70, v64
    ds_read_b64_tr_b16 v[40:41], v4 offset:64
    ds_read_b64_tr_b16 v[42:43], v4 offset:832
    s_waitcnt lgkmcnt(8)
    v_mfma_f32_32x32x16_bf16 v[48:63], v[44:47], v[252:255], v[48:63]
    v_mov_b32 v64, 0
    ds_read_b64_tr_b16 v[44:45], v5 offset:0
    ds_read_b64_tr_b16 v[46:47], v5 offset:768
    s_waitcnt lgkmcnt(8)
    v_mfma_f32_16x16x32_bf16 v[16:19], v[12:15], v[32:35], 0
    v_mfma_f32_32x32x16_bf16 v[80:95], v[32:35], v[128:131], 0
    s_add_u32 s41, s36, 11
    s_and_b32 s41, s41, 7
    s_add_u32 m0, s40, 73920
    s_mul_i32 s43, s41, 176128
    buffer_load_dwordx4 v1, s[16:19], s43 offen lds
    ds_read_b64_tr_b16 v[32:33], v5 offset:32
    ds_read_b64_tr_b16 v[34:35], v5 offset:800
    s_waitcnt lgkmcnt(7)
    v_mfma_f32_16x16x32_bf16 v[18:21], v[12:15], v[36:39], 0
    v_mfma_f32_32x32x16_bf16 v[96:111], v[36:39], v[128:131], 0
    buffer_store_dwordx4 v[64:67], v0, s[24:27], s52 offen offset:0
    ds_read_b64_tr_b16 v[36:37], v5 offset:64
    ds_read_b64_tr_b16 v[38:39], v5 offset:832
    s_waitcnt lgkmcnt(6)
    s_nop 2
    v_mfma_f32_16x16x32_bf16 v[20:23], v[12:15], v[40:43], 0
    v_mfma_f32_32x32x16_bf16 v[112:127], v[40:43], v[128:131], 0
    buffer_store_dwordx4 v[64:67], v0, s[24:27], s52 offen offset:1024
    ds_read_b64_tr_b16 v[40:41], v6 offset:0
    ds_read_b64_tr_b16 v[42:43], v6 offset:768
    s_waitcnt lgkmcnt(6)
    v_mfma_f32_32x32x16_bf16 v[80:95], v[44:47], v[132:135], v[80:95]
    buffer_load_dwordx4 v2, s[16:19], s43 offen offset:1024 lds
    ds_read_b64_tr_b16 v[44:45], v6 offset:32
    ds_read_b64_tr_b16 v[46:47], v6 offset:800
    s_waitcnt lgkmcnt(6)
    v_mfma_f32_32x32x16_bf16 v[96:111], v[32:35], v[132:135], v[96:111]
    buffer_store_dwordx4 v[64:67], v0, s[24:27], s52 offen offset:2048
    ds_read_b64_tr_b16 v[32:33], v6 offset:64
    ds_read_b64_tr_b16 v[34:35], v6 offset:832
    s_waitcnt lgkmcnt(6)
    v_mfma_f32_32x32x16_bf16 v[112:127], v[36:39], v[132:135], v[112:127]
    buffer_store_dwordx4 v[64:67], v0, s[24:27], s35 offen offset:0
    ds_read_b64_tr_b16 v[36:37], v7 offset:0
    ds_read_b64_tr_b16 v[38:39], v7 offset:768
    s_waitcnt lgkmcnt(6)
    v_mfma_f32_32x32x16_bf16 v[80:95], v[40:43], v[136:139], v[80:95]
    buffer_load_dwordx4 v3, s[16:19], s43 offen offset:2048 lds
    ds_read_b64_tr_b16 v[40:41], v7 offset:32
    ds_read_b64_tr_b16 v[42:43], v7 offset:800
    s_waitcnt lgkmcnt(6)
    v_mfma_f32_32x32x16_bf16 v[96:111], v[44:47], v[136:139], v[96:111]
    buffer_store_dwordx4 v[64:67], v0, s[24:27], s35 offen offset:1024
    ds_read_b64_tr_b16 v[44:45], v7 offset:64
    ds_read_b64_tr_b16 v[46:47], v7 offset:832
    s_waitcnt lgkmcnt(6)
    v_mfma_f32_32x32x16_bf16 v[112:127], v[32:35], v[136:139], v[112:127]
    s_waitcnt vmcnt(11)
    s_barrier
    ds_read_b128 v[8:11], v71
    ds_read_b64_tr_b16 v[32:33], v4 offset:24640
    ds_read_b64_tr_b16 v[34:35], v4 offset:25408
    s_waitcnt lgkmcnt(7)
    v_mfma_f32_32x32x16_bf16 v[80:95], v[36:39], v[140:143], v[80:95]
    s_add_u32 s41, s36, 12
    s_and_b32 s41, s41, 7
    s_add_u32 m0, s40, 98560
    s_mul_i32 s43, s41, 176128
    buffer_load_dwordx4 v1, s[16:19], s43 offen lds
    ds_read_b128 v[36:39], v0 offset:33408
    s_waitcnt lgkmcnt(6)
    v_mfma_f32_32x32x16_bf16 v[96:111], v[40:43], v[140:143], v[96:111]
    ds_read_b64_tr_b16 v[40:41], v4 offset:24672
    ds_read_b64_tr_b16 v[42:43], v4 offset:25440
    s_waitcnt lgkmcnt(5)
    v_mfma_f32_32x32x16_bf16 v[112:127], v[44:47], v[140:143], v[112:127]
    v_add_f32 v8, v8, v10
    v_add_f32 v24, v9, v11
    v_mul_f32 v25, 0xbb000000, v8
    v_mul_f32 v24, 0x3b000000, v24
    v_cvt_pk_bf16_f32 v8, v25, v25
    v_cvt_pk_bf16_f32 v9, v25, v25
    ds_read_b64_tr_b16 v[44:45], v4 offset:24704
    ds_read_b64_tr_b16 v[46:47], v4 offset:25472
    s_waitcnt lgkmcnt(5)
    v_mfma_f32_16x16x32_bf16 v[16:19], v[12:15], v[32:35], v[16:19]
    v_mfma_f32_32x32x16_bf16 v[80:95], v[32:35], v[144:147], v[80:95]
    v_cvt_pk_bf16_f32 v10, v25, v25
    v_cvt_pk_bf16_f32 v11, v25, v25
    v_fma_f32 v24, -v25, v25, v24
    v_max_f32 v24, 0, v24
    v_add_f32 v24, 0x3727c5ac, v24
    ds_read_b64_tr_b16 v[32:33], v5 offset:24640
    ds_read_b64_tr_b16 v[34:35], v5 offset:25408
    s_waitcnt lgkmcnt(6)
    v_mfma_f32_32x32x16_bf16 v[48:63], v[36:39], v[8:11], v[48:63]
    v_rsq_f32 v26, v24
    s_nop 0
    v_mul_f32 v25, v24, v26
    v_mul_f32 v24, 0xbfb8aa3b, v26
    s_add_u32 m0, s40, 98560
    s_nop 0
    buffer_load_dwordx4 v2, s[16:19], s43 offen offset:1024 lds
    ds_read_b64_tr_b16 v[36:37], v5 offset:24672
    ds_read_b64_tr_b16 v[38:39], v5 offset:25440
    s_waitcnt lgkmcnt(6)
    v_mfma_f32_16x16x32_bf16 v[18:21], v[12:15], v[40:43], v[18:21]
    v_mfma_f32_32x32x16_bf16 v[96:111], v[40:43], v[144:147], v[96:111]
    s_and_b32 s56, s2, 0x78
    s_add_u32 s56, s56, s32
    s_mul_i32 s57, s56, 11264
    s_mov_b64 exec, 0x7ff
    buffer_load_dword v79, v77, s[48:51], s57 offen offset:384
    s_lshl_b32 s57, s56, 12
    s_mov_b64 exec, 15
    buffer_load_dword v78, v77, s[44:47], s57 offen offset:384
    s_mov_b64 exec, -1
    s_and_b32 s56, s2, 0x38
    s_cmp_eq_u32 s56, 24
    s_cselect_b32 s58, 0xa0, 0
    s_xor_b32 s58, s58, s2
    s_and_b32 s56, s2, 7
    s_lshr_b32 s57, s58, 6
    s_lshl2_add_u32 s56, s56, s57
    s_bfe_u32 s57, s58, 0x30003
    s_lshl_b32 s57, s57, 7
    s_lshl3_add_u32 s31, s56, s32
    s_lshl_b32 s31, s31, 7
    s_add_u32 s31, s31, 13631488
    s_lshl_b32 s0, s56, 16
    s_add_u32 s0, s0, s57
    s_lshl_b32 s58, s37, 13
    s_add_u32 s0, s0, s58
    s_mul_i32 s29, s56, 241664
    s_mul_i32 s58, s32, 6144
    s_add_u32 s28, s29, s58
    s_add_u32 s28, s28, 32768
    s_mul_i32 s58, s32, 5
    s_min_u32 s58, s58, 33
    s_add_u32 s58, s58, 48
    s_lshl_b32 s22, s58, 14
    s_add_u32 s22, s22, s57
    s_lshl_b32 s58, s58, 10
    s_add_u32 s30, s29, s58
    s_add_u32 s30, s30, 32768
    s_lshl_b32 s58, s32, 12
    s_add_u32 s29, s29, s58
    s_mul_i32 s20, s32, 98304
    s_add_u32 s20, s20, s57
    s_lshl_b32 s21, s32, 16
    s_add_u32 s21, s21, s57
    s_cmp_eq_u32 s32, 7
    s_cselect_b32 s23, 0x2000000, s22
    s_lshl_b32 s1, s37, 14
    s_sub_u32 s1, s1, 122880
    s_lshr_b32 s56, s32, 1
    s_lshl_b32 s56, s56, 11
    s_and_b32 s58, s32, 1
    s_lshl_b32 s58, s58, 5
    s_add_u32 s58, s58, s56
    s_add_u32 s58, s58, 106688
    s_sub_u32 s56, s56, 16192
    ds_read_b64_tr_b16 v[40:41], v5 offset:24704
    ds_read_b64_tr_b16 v[42:43], v5 offset:25472
    s_waitcnt lgkmcnt(6)
    v_mfma_f32_16x16x32_bf16 v[20:23], v[12:15], v[44:47], v[20:23]
    v_mfma_f32_32x32x16_bf16 v[112:127], v[44:47], v[144:147], v[112:127]
    v_cvt_pk_bf16_f32 v48, v48, v49
    v_cvt_pk_bf16_f32 v49, v50, v51
    v_cvt_pk_bf16_f32 v50, v52, v53
    v_cvt_pk_bf16_f32 v51, v54, v55
    v_cvt_pk_bf16_f32 v52, v56, v57
    v_cvt_pk_bf16_f32 v53, v58, v59
    ds_read_b64_tr_b16 v[44:45], v6 offset:24640
    ds_read_b64_tr_b16 v[46:47], v6 offset:25408
    s_waitcnt lgkmcnt(6)
    v_mfma_f32_32x32x16_bf16 v[80:95], v[32:35], v[148:151], v[80:95]
    v_cvt_pk_bf16_f32 v54, v60, v61
    v_cvt_pk_bf16_f32 v55, v62, v63
    ds_read_b64_tr_b16 v[32:33], v6 offset:24672
    ds_read_b64_tr_b16 v[34:35], v6 offset:25440
    s_waitcnt lgkmcnt(6)
    v_mfma_f32_32x32x16_bf16 v[96:111], v[36:39], v[148:151], v[96:111]
    ds_read_b64_tr_b16 v[36:37], v6 offset:24704
    ds_read_b64_tr_b16 v[38:39], v6 offset:25472
    s_waitcnt lgkmcnt(6)
    v_mfma_f32_32x32x16_bf16 v[112:127], v[40:43], v[148:151], v[112:127]
    s_add_u32 m0, s40, 98560
    s_nop 0
    buffer_load_dwordx4 v3, s[16:19], s43 offen offset:2048 lds
    ds_read_b64_tr_b16 v[40:41], v27 offset:0
    ds_read_b64_tr_b16 v[42:43], v27 offset:128
    s_waitcnt lgkmcnt(6)
    v_mfma_f32_32x32x16_bf16 v[80:95], v[44:47], v[152:155], v[80:95]
    ds_read_b64_tr_b16 v[44:45], v7 offset:24640
    ds_read_b64_tr_b16 v[46:47], v7 offset:25408
    s_waitcnt lgkmcnt(6)
    v_mfma_f32_32x32x16_bf16 v[96:111], v[32:35], v[152:155], v[96:111]
    ds_read_b64_tr_b16 v[32:33], v7 offset:24672
    ds_read_b64_tr_b16 v[34:35], v7 offset:25440
    s_waitcnt lgkmcnt(6)
    v_mfma_f32_32x32x16_bf16 v[112:127], v[36:39], v[152:155], v[112:127]
    ds_read_b64_tr_b16 v[36:37], v7 offset:24704
    ds_read_b64_tr_b16 v[38:39], v7 offset:25472
    s_waitcnt vmcnt(1) lgkmcnt(6)
    v_mfma_f32_32x32x16_bf16 v[64:79], v[40:43], v[48:51], 0
    s_barrier
    ds_read_b64_tr_b16 v[40:41], v4 offset:49280
    ds_read_b64_tr_b16 v[42:43], v4 offset:50048
    s_waitcnt lgkmcnt(6)
    v_mfma_f32_32x32x16_bf16 v[80:95], v[44:47], v[156:159], v[80:95]
    s_add_u32 s41, s36, 13
    s_and_b32 s41, s41, 7
    s_add_u32 m0, s40, 0
    s_mul_i32 s43, s41, 176128
    buffer_load_dwordx4 v1, s[16:19], s43 offen lds
    ds_read_b64_tr_b16 v[44:45], v4 offset:49312
    ds_read_b64_tr_b16 v[46:47], v4 offset:50080
    s_waitcnt lgkmcnt(6)
    v_mfma_f32_32x32x16_bf16 v[96:111], v[32:35], v[156:159], v[96:111]
    v_max_f32 v26, v64, v65
    v_max_f32 v31, v66, v67
    v_max3_f32 v26, v26, v68, v69
    v_max3_f32 v31, v31, v70, v71
    v_max3_f32 v26, v26, v72, v73
    v_max3_f32 v31, v31, v74, v75
    s_lshl1_add_u32 m0, s39, 123200
    s_add_u32 s42, s20, 0
    buffer_load_dwordx4 v28, s[48:51], s42 offen lds
    ds_read_b64_tr_b16 v[32:33], v4 offset:49344
    ds_read_b64_tr_b16 v[34:35], v4 offset:50112
    s_waitcnt lgkmcnt(6)
    v_mfma_f32_32x32x16_bf16 v[112:127], v[36:39], v[156:159], v[112:127]
    v_add_u32 v4, 73920, v4
    v_max3_f32 v26, v26, v76, v77
    v_max3_f32 v31, v31, v78, v79
    v_max_f32 v26, v26, v31
    v_mul_f32 v26, v26, v24
    s_lshl1_add_u32 m0, s39, 123200
    s_add_u32 s42, s20, 7168
    buffer_load_dwordx4 v28, s[48:51], s42 offen offset:1024 lds
    ds_read_b64_tr_b16 v[36:37], v5 offset:49280
    ds_read_b64_tr_b16 v[38:39], v5 offset:50048
    s_waitcnt lgkmcnt(6)
    v_mfma_f32_16x16x32_bf16 v[16:19], v[12:15], v[40:43], v[16:19]
    v_mfma_f32_32x32x16_bf16 v[80:95], v[40:43], v[160:163], v[80:95]
    v_fma_f32 v64, v64, -v24, v26
    v_fma_f32 v65, v65, -v24, v26
    v_fma_f32 v66, v66, -v24, v26
    v_fma_f32 v67, v67, -v24, v26
    s_lshl1_add_u32 m0, s39, 139584
    s_add_u32 s42, s20, 49152
    buffer_load_dwordx4 v28, s[48:51], s42 offen lds
    ds_read_b64_tr_b16 v[40:41], v5 offset:49312
    ds_read_b64_tr_b16 v[42:43], v5 offset:50080
    s_waitcnt lgkmcnt(6)
    v_mfma_f32_16x16x32_bf16 v[18:21], v[12:15], v[44:47], v[18:21]
    v_mfma_f32_32x32x16_bf16 v[96:111], v[44:47], v[160:163], v[96:111]
    v_exp_f32 v64, v64
    v_fma_f32 v68, v68, -v24, v26
    v_fma_f32 v69, v69, -v24, v26
    v_fma_f32 v70, v70, -v24, v26
    v_fma_f32 v71, v71, -v24, v26
    s_add_u32 m0, s40, 0
    s_nop 0
    buffer_load_dwordx4 v2, s[16:19], s43 offen offset:1024 lds
    ds_read_b64_tr_b16 v[44:45], v5 offset:49344
    ds_read_b64_tr_b16 v[46:47], v5 offset:50112
    s_waitcnt lgkmcnt(6)
    v_mfma_f32_16x16x32_bf16 v[20:23], v[12:15], v[32:35], v[20:23]
    v_mfma_f32_32x32x16_bf16 v[112:127], v[32:35], v[160:163], v[112:127]
    v_add_u32 v5, 73920, v5
    v_exp_f32 v65, v65
    v_fma_f32 v72, v72, -v24, v26
    v_fma_f32 v73, v73, -v24, v26
    v_fma_f32 v74, v74, -v24, v26
    s_lshl1_add_u32 m0, s39, 139584
    s_add_u32 s42, s20, 56320
    buffer_load_dwordx4 v28, s[48:51], s42 offen offset:1024 lds
    ds_read_b64_tr_b16 v[32:33], v6 offset:49280
    ds_read_b64_tr_b16 v[34:35], v6 offset:50048
    s_waitcnt lgkmcnt(6)
    v_mfma_f32_32x32x16_bf16 v[80:95], v[36:39], v[164:167], v[80:95]
    v_exp_f32 v66, v66
    v_fma_f32 v75, v75, -v24, v26
    v_fma_f32 v76, v76, -v24, v26
    v_fma_f32 v77, v77, -v24, v26
    v_fma_f32 v78, v78, -v24, v26
    ds_read_b64_tr_b16 v[36:37], v6 offset:49312
    ds_read_b64_tr_b16 v[38:39], v6 offset:50080
    s_waitcnt lgkmcnt(6)
    v_mfma_f32_32x32x16_bf16 v[96:111], v[40:43], v[164:167], v[96:111]
    v_add_f32 v31, v64, v65
    v_exp_f32 v67, v67
    v_fma_f32 v79, v79, -v24, v26
    v_add_f32 v31, v31, v66
    v_add_f32 v31, v31, v67
    ds_read_b64_tr_b16 v[40:41], v6 offset:49344
    ds_read_b64_tr_b16 v[42:43], v6 offset:50112
    s_waitcnt lgkmcnt(6)
    v_mfma_f32_32x32x16_bf16 v[112:127], v[44:47], v[164:167], v[112:127]
    v_add_u32 v6, 73920, v6
    v_exp_f32 v68, v68
    v_exp_f32 v69, v69
    v_add_f32 v31, v31, v68
    s_add_u32 m0, s40, 0
    s_nop 0
    buffer_load_dwordx4 v3, s[16:19], s43 offen offset:2048 lds
    ds_read_b64_tr_b16 v[44:45], v7 offset:49280
    ds_read_b64_tr_b16 v[46:47], v7 offset:50048
    s_waitcnt lgkmcnt(6)
    v_mfma_f32_32x32x16_bf16 v[80:95], v[32:35], v[168:171], v[80:95]
    v_exp_f32 v70, v70
    v_add_f32 v31, v31, v69
    v_exp_f32 v71, v71
    v_add_f32 v31, v31, v70
    ds_read_b64_tr_b16 v[32:33], v7 offset:49312
    ds_read_b64_tr_b16 v[34:35], v7 offset:50080
    s_waitcnt lgkmcnt(6)
    v_mfma_f32_32x32x16_bf16 v[96:111], v[36:39], v[168:171], v[96:111]
    v_exp_f32 v72, v72
    v_add_f32 v31, v31, v71
    v_exp_f32 v73, v73
    v_add_f32 v31, v31, v72
    ds_read_b64_tr_b16 v[36:37], v7 offset:49344
    ds_read_b64_tr_b16 v[38:39], v7 offset:50112
    s_waitcnt lgkmcnt(6)
    v_mfma_f32_32x32x16_bf16 v[112:127], v[40:43], v[168:171], v[112:127]
    s_barrier
    ds_read_b64_tr_b16 v[40:41], v4 offset:0
    ds_read_b64_tr_b16 v[42:43], v4 offset:768
    s_waitcnt lgkmcnt(6)
    v_mfma_f32_32x32x16_bf16 v[80:95], v[44:47], v[172:175], v[80:95]
    v_add_u32 v7, 73920, v7
    v_exp_f32 v74, v74
    v_add_f32 v31, v31, v73
    v_exp_f32 v75, v75
    s_add_u32 s41, s36, 14
    s_and_b32 s41, s41, 7
    s_add_u32 m0, s40, 24640
    s_mul_i32 s43, s41, 176128
    buffer_load_dwordx4 v1, s[16:19], s43 offen lds
    s_waitcnt vmcnt(5)
    ds_read_b64_tr_b16 v[128:129], v29 offset:32896
    ds_read_b64_tr_b16 v[130:131], v29 offset:33408
    ds_read_b64_tr_b16 v[132:133], v30 offset:32896
    ds_read_b64_tr_b16 v[134:135], v30 offset:33408
    ds_read_b64_tr_b16 v[44:45], v4 offset:32
    ds_read_b64_tr_b16 v[46:47], v4 offset:800
    s_waitcnt lgkmcnt(10)
    v_mfma_f32_32x32x16_bf16 v[96:111], v[32:35], v[172:175], v[96:111]
    v_add_f32 v31, v31, v74
    v_exp_f32 v76, v76
    v_add_f32 v31, v31, v75
    v_exp_f32 v77, v77
    ds_read_b64_tr_b16 v[32:33], v4 offset:64
    ds_read_b64_tr_b16 v[34:35], v4 offset:832
    s_waitcnt lgkmcnt(10)
    v_mfma_f32_32x32x16_bf16 v[112:127], v[36:39], v[172:175], v[112:127]
    v_add_f32 v31, v31, v76
    v_exp_f32 v78, v78
    v_add_f32 v31, v31, v77
    v_exp_f32 v79, v79
    s_waitcnt lgkmcnt(4)
    s_lshl1_add_u32 m0, s39, 123200
    s_add_u32 s42, s20, 16384
    buffer_load_dwordx4 v28, s[48:51], s42 offen lds
    ds_read_b64_tr_b16 v[36:37], v5 offset:0
    ds_read_b64_tr_b16 v[38:39], v5 offset:768
    v_mfma_f32_16x16x32_bf16 v[16:19], v[12:15], v[40:43], v[16:19]
    v_mfma_f32_32x32x16_bf16 v[80:95], v[40:43], v[176:179], v[80:95]
    v_add_f32 v31, v31, v78
    v_add_f32 v31, v31, v79
    v_rcp_f32 v31, v31
    s_nop 0
    v_mul_f32 v64, v64, v31
    s_waitcnt vmcnt(3)
    ds_read_b64_tr_b16 v[136:137], v29 offset:49280
    ds_read_b64_tr_b16 v[138:139], v29 offset:49792
    ds_read_b64_tr_b16 v[140:141], v30 offset:49280
    ds_read_b64_tr_b16 v[142:143], v30 offset:49792
    s_lshl1_add_u32 m0, s39, 123200
    s_add_u32 s42, s20, 23552
    buffer_load_dwordx4 v28, s[48:51], s42 offen offset:1024 lds
    ds_read_b64_tr_b16 v[40:41], v5 offset:32
    ds_read_b64_tr_b16 v[42:43], v5 offset:800
    s_waitcnt lgkmcnt(10)
    v_mfma_f32_16x16x32_bf16 v[18:21], v[12:15], v[44:47], v[18:21]
    v_mfma_f32_32x32x16_bf16 v[96:111], v[44:47], v[176:179], v[96:111]
    v_mul_f32 v65, v65, v31
    v_cvt_pk_bf16_f32 v56, v64, v65
    v_mul_f32 v66, v66, v31
    v_mul_f32 v67, v67, v31
    v_cvt_pk_bf16_f32 v57, v66, v67
    v_mul_f32 v68, v68, v31
    s_add_u32 m0, s40, 24640
    s_nop 0
    buffer_load_dwordx4 v2, s[16:19], s43 offen offset:1024 lds
    ds_read_b64_tr_b16 v[44:45], v27 offset:512
    ds_read_b64_tr_b16 v[46:47], v27 offset:640
    s_waitcnt lgkmcnt(10)
    v_mfma_f32_16x16x32_bf16 v[20:23], v[12:15], v[32:35], v[20:23]
    v_mfma_f32_32x32x16_bf16 v[112:127], v[32:35], v[176:179], v[112:127]
    v_mul_f32 v69, v69, v31
    v_cvt_pk_bf16_f32 v58, v68, v69
    v_mul_f32 v70, v70, v31
    v_mul_f32 v71, v71, v31
    v_cvt_pk_bf16_f32 v59, v70, v71
    v_mul_f32 v72, v72, v31
    s_waitcnt lgkmcnt(4)
    s_lshl1_add_u32 m0, s39, 139584
    s_add_u32 s42, s20, 65536
    buffer_load_dwordx4 v28, s[48:51], s42 offen lds
    ds_read_b64_tr_b16 v[32:33], v5 offset:64
    ds_read_b64_tr_b16 v[34:35], v5 offset:832
    v_mfma_f32_32x32x16_bf16 v[80:95], v[36:39], v[180:183], v[80:95]
    v_mul_f32 v73, v73, v31
    v_cvt_pk_bf16_f32 v60, v72, v73
    v_mul_f32 v74, v74, v31
    v_mul_f32 v75, v75, v31
    v_cvt_pk_bf16_f32 v61, v74, v75
    v_mul_f32 v76, v76, v31
    s_lshl1_add_u32 m0, s39, 139584
    s_add_u32 s42, s20, 72704
    buffer_load_dwordx4 v28, s[48:51], s42 offen offset:1024 lds
    ds_read_b64_tr_b16 v[36:37], v6 offset:0
    ds_read_b64_tr_b16 v[38:39], v6 offset:768
    s_waitcnt lgkmcnt(6)
    v_mfma_f32_32x32x16_bf16 v[96:111], v[40:43], v[180:183], v[96:111]
    v_mul_f32 v77, v77, v31
    v_cvt_pk_bf16_f32 v62, v76, v77
    v_mul_f32 v78, v78, v31
    v_mul_f32 v79, v79, v31
    v_cvt_pk_bf16_f32 v63, v78, v79
    ds_read_b64_tr_b16 v[40:41], v6 offset:32
    ds_read_b64_tr_b16 v[42:43], v6 offset:800
    s_waitcnt lgkmcnt(6)
    v_mfma_f32_32x32x16_bf16 v[64:79], v[44:47], v[52:55], 0
    s_add_u32 m0, s40, 24640
    s_nop 0
    buffer_load_dwordx4 v3, s[16:19], s43 offen offset:2048 lds
    ds_read_b64_tr_b16 v[44:45], v6 offset:64
    ds_read_b64_tr_b16 v[46:47], v6 offset:832
    s_waitcnt lgkmcnt(6)
    v_mfma_f32_32x32x16_bf16 v[112:127], v[32:35], v[180:183], v[112:127]
    ds_read_b64_tr_b16 v[32:33], v7 offset:0
    ds_read_b64_tr_b16 v[34:35], v7 offset:768
    s_waitcnt lgkmcnt(6)
    v_mfma_f32_32x32x16_bf16 v[80:95], v[36:39], v[184:187], v[80:95]
    s_nop 0
    v_max_f32 v26, v64, v65
    v_max_f32 v31, v66, v67
    v_max3_f32 v26, v26, v68, v69
    v_max3_f32 v31, v31, v70, v71
    v_max3_f32 v26, v26, v72, v73
    v_max3_f32 v31, v31, v74, v75
    ds_read_b64_tr_b16 v[36:37], v7 offset:32
    ds_read_b64_tr_b16 v[38:39], v7 offset:800
    s_waitcnt lgkmcnt(6)
    v_mfma_f32_32x32x16_bf16 v[96:111], v[40:43], v[184:187], v[96:111]
    v_max3_f32 v26, v26, v76, v77
    v_max3_f32 v31, v31, v78, v79
    v_max_f32 v26, v26, v31
    v_mul_f32 v26, v26, v24
    ds_read_b64_tr_b16 v[40:41], v7 offset:64
    ds_read_b64_tr_b16 v[42:43], v7 offset:832
    s_waitcnt lgkmcnt(6)
    v_mfma_f32_32x32x16_bf16 v[112:127], v[44:47], v[184:187], v[112:127]
    s_barrier
    ds_read_b64_tr_b16 v[44:45], v4 offset:24640
    ds_read_b64_tr_b16 v[46:47], v4 offset:25408
    s_waitcnt lgkmcnt(6)
    v_mfma_f32_32x32x16_bf16 v[80:95], v[32:35], v[188:191], v[80:95]
    v_fma_f32 v64, v64, -v24, v26
    v_fma_f32 v65, v65, -v24, v26
    v_fma_f32 v66, v66, -v24, v26
    v_fma_f32 v67, v67, -v24, v26
    s_add_u32 s41, s36, 15
    s_and_b32 s41, s41, 7
    s_add_u32 m0, s40, 49280
    s_mul_i32 s43, s41, 176128
    buffer_load_dwordx4 v1, s[16:19], s43 offen lds
    s_waitcnt vmcnt(5)
    ds_read_b64_tr_b16 v[144:145], v29 offset:32896
    ds_read_b64_tr_b16 v[146:147], v29 offset:33408
    ds_read_b64_tr_b16 v[148:149], v30 offset:32896
    ds_read_b64_tr_b16 v[150:151], v30 offset:33408
    ds_read_b64_tr_b16 v[32:33], v4 offset:24672
    ds_read_b64_tr_b16 v[34:35], v4 offset:25440
    s_waitcnt lgkmcnt(10)
    v_mfma_f32_32x32x16_bf16 v[96:111], v[36:39], v[188:191], v[96:111]
    v_exp_f32 v64, v64
    v_fma_f32 v68, v68, -v24, v26
    v_fma_f32 v69, v69, -v24, v26
    v_fma_f32 v70, v70, -v24, v26
    v_fma_f32 v71, v71, -v24, v26
    ds_read_b64_tr_b16 v[36:37], v4 offset:24704
    ds_read_b64_tr_b16 v[38:39], v4 offset:25472
    s_waitcnt lgkmcnt(10)
    v_mfma_f32_32x32x16_bf16 v[112:127], v[40:43], v[188:191], v[112:127]
    v_subrev_u32 v4, 73920, v4
    v_exp_f32 v65, v65
    v_fma_f32 v72, v72, -v24, v26
    v_fma_f32 v73, v73, -v24, v26
    v_fma_f32 v74, v74, -v24, v26
    s_waitcnt lgkmcnt(4)
    s_lshl1_add_u32 m0, s39, 123200
    s_add_u32 s42, s20, 32768
    buffer_load_dwordx4 v28, s[48:51], s42 offen lds
    ds_read_b64_tr_b16 v[40:41], v5 offset:24640
    ds_read_b64_tr_b16 v[42:43], v5 offset:25408
    v_mfma_f32_16x16x32_bf16 v[16:19], v[12:15], v[44:47], v[16:19]
    v_mfma_f32_32x32x16_bf16 v[80:95], v[44:47], v[192:195], v[80:95]
    v_exp_f32 v66, v66
    v_fma_f32 v75, v75, -v24, v26
    v_fma_f32 v76, v76, -v24, v26
    v_fma_f32 v77, v77, -v24, v26
    v_fma_f32 v78, v78, -v24, v26
    s_waitcnt vmcnt(3)
    ds_read_b64_tr_b16 v[152:153], v29 offset:49280
    ds_read_b64_tr_b16 v[154:155], v29 offset:49792
    ds_read_b64_tr_b16 v[156:157], v30 offset:49280
    ds_read_b64_tr_b16 v[158:159], v30 offset:49792
    s_lshl1_add_u32 m0, s39, 123200
    s_add_u32 s42, s20, 39936
    buffer_load_dwordx4 v28, s[48:51], s42 offen offset:1024 lds
    ds_read_b64_tr_b16 v[44:45], v5 offset:24672
    ds_read_b64_tr_b16 v[46:47], v5 offset:25440
    s_waitcnt lgkmcnt(10)
    v_mfma_f32_16x16x32_bf16 v[18:21], v[12:15], v[32:35], v[18:21]
    v_mfma_f32_32x32x16_bf16 v[96:111], v[32:35], v[192:195], v[96:111]
    v_add_f32 v31, v64, v65
    v_exp_f32 v67, v67
    v_fma_f32 v79, v79, -v24, v26
    v_add_f32 v31, v31, v66
    v_add_f32 v31, v31, v67
    s_add_u32 m0, s40, 49280
    s_nop 0
    buffer_load_dwordx4 v2, s[16:19], s43 offen offset:1024 lds
    ds_read_b64_tr_b16 v[32:33], v5 offset:24704
    ds_read_b64_tr_b16 v[34:35], v5 offset:25472
    s_waitcnt lgkmcnt(10)
    v_mfma_f32_16x16x32_bf16 v[20:23], v[12:15], v[36:39], v[20:23]
    v_mfma_f32_32x32x16_bf16 v[112:127], v[36:39], v[192:195], v[112:127]
    v_subrev_u32 v5, 73920, v5
    v_exp_f32 v68, v68
    v_exp_f32 v69, v69
    v_add_f32 v31, v31, v68
    s_waitcnt lgkmcnt(4)
    s_lshl1_add_u32 m0, s39, 139584
    s_add_u32 s42, s20, 81920
    buffer_load_dwordx4 v28, s[48:51], s42 offen lds
    ds_read_b64_tr_b16 v[36:37], v6 offset:24640
    ds_read_b64_tr_b16 v[38:39], v6 offset:25408
    v_mfma_f32_32x32x16_bf16 v[80:95], v[40:43], v[196:199], v[80:95]
    v_exp_f32 v70, v70
    v_add_f32 v31, v31, v69
    v_exp_f32 v71, v71
    v_add_f32 v31, v31, v70
    s_lshl1_add_u32 m0, s39, 139584
    s_add_u32 s42, s20, 89088
    buffer_load_dwordx4 v28, s[48:51], s42 offen offset:1024 lds
    ds_read_b64_tr_b16 v[40:41], v6 offset:24672
    ds_read_b64_tr_b16 v[42:43], v6 offset:25440
    s_waitcnt lgkmcnt(6)
    v_mfma_f32_32x32x16_bf16 v[96:111], v[44:47], v[196:199], v[96:111]
    v_exp_f32 v72, v72
    v_add_f32 v31, v31, v71
    v_exp_f32 v73, v73
    v_add_f32 v31, v31, v72
    ds_read_b64_tr_b16 v[44:45], v6 offset:24704
    ds_read_b64_tr_b16 v[46:47], v6 offset:25472
    s_waitcnt lgkmcnt(6)
    v_mfma_f32_32x32x16_bf16 v[112:127], v[32:35], v[196:199], v[112:127]
    v_subrev_u32 v6, 73920, v6
    v_exp_f32 v74, v74
    v_add_f32 v31, v31, v73
    v_exp_f32 v75, v75
    s_add_u32 m0, s40, 49280
    s_nop 0
    buffer_load_dwordx4 v3, s[16:19], s43 offen offset:2048 lds
    ds_read_b64_tr_b16 v[32:33], v7 offset:24640
    ds_read_b64_tr_b16 v[34:35], v7 offset:25408
    s_waitcnt lgkmcnt(6)
    v_mfma_f32_32x32x16_bf16 v[80:95], v[36:39], v[200:203], v[80:95]
    v_add_f32 v31, v31, v74
    v_exp_f32 v76, v76
    v_add_f32 v31, v31, v75
    v_exp_f32 v77, v77
    ds_read_b64_tr_b16 v[36:37], v7 offset:24672
    ds_read_b64_tr_b16 v[38:39], v7 offset:25440
    s_waitcnt lgkmcnt(6)
    v_mfma_f32_32x32x16_bf16 v[96:111], v[40:43], v[200:203], v[96:111]
    v_add_f32 v31, v31, v76
    v_exp_f32 v78, v78
    v_add_f32 v31, v31, v77
    v_exp_f32 v79, v79
    ds_read_b64_tr_b16 v[40:41], v7 offset:24704
    ds_read_b64_tr_b16 v[42:43], v7 offset:25472
    s_waitcnt lgkmcnt(6)
    v_mfma_f32_32x32x16_bf16 v[112:127], v[44:47], v[200:203], v[112:127]
    s_barrier
    ds_read_b64_tr_b16 v[44:45], v4 offset:0
    ds_read_b64_tr_b16 v[46:47], v4 offset:768
    s_waitcnt lgkmcnt(6)
    v_mfma_f32_32x32x16_bf16 v[80:95], v[32:35], v[204:207], v[80:95]
    v_subrev_u32 v7, 73920, v7
    v_add_f32 v31, v31, v78
    v_add_f32 v31, v31, v79
    v_rcp_f32 v31, v31
    v_bfe_u32 v52, v0, 4, 6
    s_lshl1_add_u32 m0, s39, 73920
    s_add_u32 s42, s22, 49152
    buffer_load_dwordx4 v28, s[48:51], s42 offen lds
    s_cmp_eq_u32 s23, 0x2000000
    s_cselect_b32 s36, 2.0, s30
    ds_read_b64_tr_b16 v[32:33], v4 offset:32
    ds_read_b64_tr_b16 v[34:35], v4 offset:800
    s_waitcnt lgkmcnt(6)
    v_mfma_f32_32x32x16_bf16 v[96:111], v[36:39], v[204:207], v[96:111]
    v_mul_f32 v64, v64, v31
    v_mul_f32 v65, v65, v31
    v_cvt_pk_bf16_f32 v64, v64, v65
    v_mul_f32 v66, v66, v31
    v_mul_f32 v67, v67, v31
    v_cvt_pk_bf16_f32 v65, v66, v67
    s_waitcnt vmcnt(5)
    ds_read_b64_tr_b16 v[160:161], v29 offset:32896
    ds_read_b64_tr_b16 v[162:163], v29 offset:33408
    ds_read_b64_tr_b16 v[164:165], v30 offset:32896
    ds_read_b64_tr_b16 v[166:167], v30 offset:33408
    s_lshl1_add_u32 m0, s39, 73920
    s_add_u32 s42, s22, 56320
    buffer_load_dwordx4 v28, s[48:51], s42 offen offset:1024 lds
    ds_read_b64_tr_b16 v[36:37], v4 offset:64
    ds_read_b64_tr_b16 v[38:39], v4 offset:832
    s_waitcnt lgkmcnt(10)
    v_mfma_f32_32x32x16_bf16 v[112:127], v[40:43], v[204:207], v[112:127]
    v_mul_f32 v68, v68, v31
    v_mul_f32 v69, v69, v31
    v_cvt_pk_bf16_f32 v66, v68, v69
    v_mul_f32 v70, v70, v31
    v_mul_f32 v71, v71, v31
    v_cvt_pk_bf16_f32 v67, v70, v71
    ds_read_b64_tr_b16 v[40:41], v5 offset:0
    ds_read_b64_tr_b16 v[42:43], v5 offset:768
    s_waitcnt lgkmcnt(10)
    v_mfma_f32_16x16x32_bf16 v[16:19], v[12:15], v[44:47], v[16:19]
    v_mfma_f32_32x32x16_bf16 v[80:95], v[44:47], v[208:211], v[80:95]
    v_mul_f32 v72, v72, v31
    v_mul_f32 v73, v73, v31
    v_cvt_pk_bf16_f32 v68, v72, v73
    v_mul_f32 v74, v74, v31
    v_mul_f32 v75, v75, v31
    v_cvt_pk_bf16_f32 v69, v74, v75
    s_waitcnt lgkmcnt(4)
    s_lshl1_add_u32 m0, s39, 123200
    s_add_u32 s42, s21, 0
    buffer_load_dwordx4 v28, s[44:47], s42 offen lds
    ds_read_b64_tr_b16 v[44:45], v6 offset:0
    ds_read_b64_tr_b16 v[46:47], v6 offset:768
    v_mfma_f32_16x16x32_bf16 v[18:21], v[12:15], v[32:35], v[18:21]
    v_mfma_f32_32x32x16_bf16 v[96:111], v[32:35], v[208:211], v[96:111]
    v_mul_f32 v76, v76, v31
    v_mul_f32 v77, v77, v31
    v_cvt_pk_bf16_f32 v70, v76, v77
    v_mul_f32 v78, v78, v31
    v_mul_f32 v79, v79, v31
    v_cvt_pk_bf16_f32 v71, v78, v79
    s_waitcnt vmcnt(4)
    ds_read_b64_tr_b16 v[168:169], v29 offset:49280
    ds_read_b64_tr_b16 v[170:171], v29 offset:49792
    ds_read_b64_tr_b16 v[172:173], v30 offset:49280
    ds_read_b64_tr_b16 v[174:175], v30 offset:49792
    s_lshl1_add_u32 m0, s39, 123200
    s_add_u32 s42, s21, 7168
    buffer_load_dwordx4 v28, s[44:47], s42 offen offset:1024 lds
    ds_read_b64_tr_b16 v[32:33], v7 offset:0
    ds_read_b64_tr_b16 v[34:35], v7 offset:768
    s_waitcnt lgkmcnt(10)
    v_mfma_f32_16x16x32_bf16 v[20:23], v[12:15], v[36:39], v[20:23]
    v_mfma_f32_32x32x16_bf16 v[112:127], v[36:39], v[208:211], v[112:127]
    s_waitcnt vmcnt(4)
    s_barrier
    ds_read_b64_tr_b16 v[36:37], v4 offset:24640
    ds_read_b64_tr_b16 v[38:39], v4 offset:25408
    s_waitcnt lgkmcnt(10)
    v_mfma_f32_32x32x16_bf16 v[80:95], v[40:43], v[212:215], v[80:95]
    v_lshrrev_b32 v31, 2, v0
    v_and_b32 v31, 28, v31
    v_and_b32 v49, 15, v52
    v_lshrrev_b32 v50, 1, v52
    v_and_b32 v50, 8, v50
    v_xor_b32 v50, v49, v50
    s_waitcnt lgkmcnt(4)
    s_lshl1_add_u32 m0, s39, 139584
    s_add_u32 s42, s21, 16384
    buffer_load_dwordx4 v28, s[44:47], s42 offen lds
    ds_read_b64_tr_b16 v[40:41], v4 offset:24672
    ds_read_b64_tr_b16 v[42:43], v4 offset:25440
    v_mfma_f32_32x32x16_bf16 v[80:95], v[44:47], v[216:219], v[80:95]
    v_and_b32 v51, 1, v50
    v_lshlrev_b32 v51, 4, v51
    v_mov_b32 v49, 0x3f80
    v_lshlrev_b32 v51, v51, v49
    v_lshrrev_b32 v50, 1, v50
    v_cmp_eq_u32 vcc, 0, v50
    s_lshl1_add_u32 m0, s39, 139584
    s_add_u32 s42, s21, 23552
    buffer_load_dwordx4 v28, s[44:47], s42 offen offset:1024 lds
    ds_read_b64_tr_b16 v[44:45], v4 offset:24704
    ds_read_b64_tr_b16 v[46:47], v4 offset:25472
    s_waitcnt lgkmcnt(6)
    v_mfma_f32_32x32x16_bf16 v[80:95], v[32:35], v[220:223], v[80:95]
    v_add_u32 v2, s56, v0
    v_and_b32 v49, 7, v52
    v_cndmask_b32 v72, 0, v51, vcc
    v_cmp_eq_u32 vcc, 1, v50
    s_nop 1
    v_cndmask_b32 v73, 0, v51, vcc
    v_cmp_eq_u32 vcc, 2, v50
    s_lshl1_add_u32 m0, s39, 90304
    s_add_u32 s42, s23, 16384
    buffer_load_dwordx4 v28, s[48:51], s42 offen lds
    ds_read_b64_tr_b16 v[32:33], v4 offset:49280
    ds_read_b64_tr_b16 v[34:35], v4 offset:50048
    s_waitcnt lgkmcnt(6)
    v_mfma_f32_16x16x32_bf16 v[16:19], v[12:15], v[36:39], v[16:19]
    v_mfma_f32_32x32x16_bf16 v[80:95], v[36:39], v[224:227], v[80:95]
    v_lshlrev_b32 v49, 7, v49
    v_lshlrev_b32 v26, 3, v31
    v_cndmask_b32 v74, 0, v51, vcc
    v_cmp_eq_u32 vcc, 3, v50
    s_nop 1
    v_cndmask_b32 v75, 0, v51, vcc
    v_and_b32 v50, 16, v52
    s_lshl1_add_u32 m0, s39, 90304
    s_add_u32 s42, s23, 23552
    buffer_load_dwordx4 v28, s[48:51], s42 offen offset:1024 lds
    ds_read_b64_tr_b16 v[36:37], v4 offset:49312
    ds_read_b64_tr_b16 v[38:39], v4 offset:50080
    s_waitcnt lgkmcnt(6)
    v_mfma_f32_16x16x32_bf16 v[18:21], v[12:15], v[40:43], v[18:21]
    v_mfma_f32_32x32x16_bf16 v[96:111], v[40:43], v[224:227], v[96:111]
    v_lshrrev_b32 v48, 6, v0
    v_and_b32 v48, 12, v48
    v_lshl_add_u32 v49, v50, 2, v49
    v_and_b32 v50, 8, v52
    v_add_u32 v49, v49, v50
    v_lshrrev_b32 v50, 1, v52
    buffer_load_dword v27, v26, s[4:7], 0 offen
    ds_read_b64_tr_b16 v[40:41], v4 offset:49344
    ds_read_b64_tr_b16 v[42:43], v4 offset:50112
    s_waitcnt lgkmcnt(6)
    v_mfma_f32_16x16x32_bf16 v[20:23], v[12:15], v[44:47], v[20:23]
    v_mfma_f32_32x32x16_bf16 v[112:127], v[44:47], v[224:227], v[112:127]
    v_and_b32 v50, 16, v50
    v_xor_b32 v48, s3, v48
    v_add3_u32 v1, v49, v50, s58
    v_and_b32 v49, 19, v52
    v_bfe_u32 v50, v52, 2, 1
    v_lshl_or_b32 v49, v50, 3, v49
    ds_read_b64_tr_b16 v[44:45], v5 offset:24640
    ds_read_b64_tr_b16 v[46:47], v5 offset:25408
    s_waitcnt lgkmcnt(6)
    v_mfma_f32_16x16x32_bf16 v[16:19], v[12:15], v[32:35], v[16:19]
    v_mfma_f32_32x32x16_bf16 v[80:95], v[32:35], v[240:243], v[80:95]
    v_bfe_u32 v50, v52, 3, 1
    v_or_b32 v48, v48, v0
    v_lshl_or_b32 v49, v50, 2, v49
    v_lshlrev_b32 v49, 6, v49
    v_and_b32 v50, 32, v52
    v_add_u32 v49, v49, v50
    ds_read_b64_tr_b16 v[32:33], v6 offset:24640
    ds_read_b64_tr_b16 v[34:35], v6 offset:25408
    s_waitcnt lgkmcnt(6)
    v_mfma_f32_16x16x32_bf16 v[18:21], v[12:15], v[36:39], v[18:21]
    v_mfma_f32_32x32x16_bf16 v[96:111], v[36:39], v[240:243], v[96:111]
    v_add_u32 v3, 106688, v49
    v_and_b32 v50, s55, v16
    v_sub_f32 v51, v16, v50
    v_cvt_pk_bf16_f32 v50, v50, v51
    ds_write_b32 v48, v50 offset:33408
    ds_read_b64_tr_b16 v[36:37], v7 offset:24640
    ds_read_b64_tr_b16 v[38:39], v7 offset:25408
    s_waitcnt lgkmcnt(7)
    v_mfma_f32_16x16x32_bf16 v[20:23], v[12:15], v[40:43], v[20:23]
    v_mfma_f32_32x32x16_bf16 v[112:127], v[40:43], v[240:243], v[112:127]
    v_and_b32 v52, s55, v18
    v_sub_f32 v53, v18, v52
    v_cvt_pk_bf16_f32 v52, v52, v53
    ds_write_b32 v48, v52 offset:34432
    s_waitcnt vmcnt(5)
    ds_read_b64_tr_b16 v[176:177], v29 offset:32896
    ds_read_b64_tr_b16 v[178:179], v29 offset:33408
    ds_read_b64_tr_b16 v[40:41], v5 offset:49280
    ds_read_b64_tr_b16 v[42:43], v5 offset:50048
    s_waitcnt lgkmcnt(10)
    v_mfma_f32_32x32x16_bf16 v[80:95], v[44:47], v[228:231], v[80:95]
    v_and_b32 v54, s55, v20
    v_sub_f32 v55, v20, v54
    v_cvt_pk_bf16_f32 v54, v54, v55
    ds_write_b32 v48, v54 offset:35456
    ds_read_b64_tr_b16 v[180:181], v30 offset:32896
    ds_read_b64_tr_b16 v[182:183], v30 offset:33408
    ds_read_b64_tr_b16 v[44:45], v6 offset:49280
    ds_read_b64_tr_b16 v[46:47], v6 offset:50048
    s_waitcnt lgkmcnt(13)
    v_mfma_f32_32x32x16_bf16 v[80:95], v[32:35], v[232:235], v[80:95]
    s_waitcnt lgkmcnt(4)
    s_barrier
    ds_read_b128 v[32:35], v0 offset:33408
    v_mfma_f32_32x32x16_bf16 v[80:95], v[36:39], v[236:239], v[80:95]
    s_waitcnt vmcnt(3)
    ds_read_b64_tr_b16 v[184:185], v29 offset:49280
    ds_read_b64_tr_b16 v[186:187], v29 offset:49792
    ds_read_b64_tr_b16 v[188:189], v30 offset:49280
    ds_read_b64_tr_b16 v[190:191], v30 offset:49792
    s_waitcnt lgkmcnt(7)
    s_lshl1_add_u32 m0, s39, 123200
    s_add_u32 s42, s21, 32768
    buffer_load_dwordx4 v28, s[44:47], s42 offen lds
    ds_read_b64_tr_b16 v[36:37], v7 offset:49280
    ds_read_b64_tr_b16 v[38:39], v7 offset:50048
    v_mfma_f32_32x32x16_bf16 v[80:95], v[40:43], v[244:247], v[80:95]
    s_lshl1_add_u32 m0, s39, 123200
    s_add_u32 s42, s21, 39936
    buffer_load_dwordx4 v28, s[44:47], s42 offen offset:1024 lds
    s_and_b32 s101, s2, 7
    s_waitcnt vmcnt(2)
    v_readlane_b32 s101, v27, s101
    v_and_b32 v27, 0xff, v27
    v_cmp_gt_u32 vcc, 32, v27
    s_lshl_b32 s57, s100, 5
    s_sub_u32 s101, s101, s57
    s_cbranch_vccnz L_parallel_sum__linear_kernel_hedgehog__glu_gated_glu__prompt_kernel_10_cp
L_parallel_sum__linear_kernel_hedgehog__glu_gated_glu__prompt_kernel_10_cb:
    ds_read_b64_tr_b16 v[40:41], v5 offset:32
    ds_read_b64_tr_b16 v[42:43], v5 offset:800
    s_waitcnt lgkmcnt(9)
    v_mfma_f32_32x32x16_bf16 v[80:95], v[44:47], v[248:251], v[80:95]
    s_waitcnt lgkmcnt(4)
    s_lshl1_add_u32 m0, s39, 139584
    s_add_u32 s42, s21, 49152
    buffer_load_dwordx4 v28, s[44:47], s42 offen lds
    ds_read_b64_tr_b16 v[44:45], v6 offset:32
    ds_read_b64_tr_b16 v[46:47], v6 offset:800
    v_mfma_f32_32x32x16_bf16 v[80:95], v[32:35], v[8:11], v[80:95]
    s_lshl1_add_u32 m0, s39, 139584
    s_add_u32 s42, s21, 56320
    buffer_load_dwordx4 v28, s[44:47], s42 offen offset:1024 lds
    ds_read_b64_tr_b16 v[32:33], v7 offset:32
    ds_read_b64_tr_b16 v[34:35], v7 offset:800
    s_waitcnt lgkmcnt(6)
    v_mfma_f32_32x32x16_bf16 v[80:95], v[36:39], v[252:255], v[80:95]
    ds_read_b64_tr_b16 v[36:37], v5 offset:24672
    ds_read_b64_tr_b16 v[38:39], v5 offset:25440
    s_waitcnt lgkmcnt(6)
    v_mfma_f32_32x32x16_bf16 v[96:111], v[40:43], v[212:215], v[96:111]
    ds_read_b64_tr_b16 v[40:41], v6 offset:24672
    ds_read_b64_tr_b16 v[42:43], v6 offset:25440
    s_waitcnt lgkmcnt(6)
    v_mfma_f32_32x32x16_bf16 v[96:111], v[44:47], v[216:219], v[96:111]
    s_nop 3
    v_mul_f32 v80, v80, v24
    v_mul_f32 v81, v81, v24
    v_mul_f32 v82, v82, v24
    v_mul_f32 v83, v83, v24
    v_mul_f32 v84, v84, v24
    v_mul_f32 v85, v85, v24
    ds_read_b64_tr_b16 v[44:45], v7 offset:24672
    ds_read_b64_tr_b16 v[46:47], v7 offset:25440
    s_waitcnt lgkmcnt(6)
    v_mfma_f32_32x32x16_bf16 v[96:111], v[32:35], v[220:223], v[96:111]
    v_mul_f32 v86, v86, v24
    v_mul_f32 v87, v87, v24
    v_exp_f32 v80, v80
    v_exp_f32 v81, v81
    ds_read_b64_tr_b16 v[32:33], v5 offset:49312
    ds_read_b64_tr_b16 v[34:35], v5 offset:50080
    s_waitcnt lgkmcnt(6)
    v_mfma_f32_32x32x16_bf16 v[96:111], v[36:39], v[228:231], v[96:111]
    v_exp_f32 v82, v82
    v_exp_f32 v83, v83
    v_exp_f32 v84, v84
    ds_read_b64_tr_b16 v[36:37], v6 offset:49312
    ds_read_b64_tr_b16 v[38:39], v6 offset:50080
    s_waitcnt lgkmcnt(6)
    v_mfma_f32_32x32x16_bf16 v[96:111], v[40:43], v[232:235], v[96:111]
    v_exp_f32 v85, v85
    v_exp_f32 v86, v86
    v_exp_f32 v87, v87
    ds_read_b64_tr_b16 v[40:41], v7 offset:49312
    ds_read_b64_tr_b16 v[42:43], v7 offset:50080
    s_waitcnt lgkmcnt(6)
    v_mfma_f32_32x32x16_bf16 v[96:111], v[44:47], v[236:239], v[96:111]
    v_fma_f32 v80, v80, v25, v25
    v_fma_f32 v81, v81, v25, v25
    v_fma_f32 v82, v82, v25, v25
    v_fma_f32 v83, v83, v25, v25
    ds_read_b128 v[44:47], v0 offset:34432
    s_waitcnt lgkmcnt(5)
    v_mfma_f32_32x32x16_bf16 v[96:111], v[32:35], v[244:247], v[96:111]
    v_rcp_f32 v80, v80
    v_fma_f32 v84, v84, v25, v25
    v_fma_f32 v85, v85, v25, v25
    v_fma_f32 v86, v86, v25, v25
    v_fma_f32 v87, v87, v25, v25
    s_waitcnt vmcnt(2)
    ds_read_b64_tr_b16 v[192:193], v29 offset:32896
    ds_read_b64_tr_b16 v[194:195], v29 offset:33408
    ds_read_b64_tr_b16 v[196:197], v30 offset:32896
    ds_read_b64_tr_b16 v[198:199], v30 offset:33408
    ds_read_b64_tr_b16 v[32:33], v5 offset:64
    ds_read_b64_tr_b16 v[34:35], v5 offset:832
    s_waitcnt lgkmcnt(9)
    v_mfma_f32_32x32x16_bf16 v[96:111], v[36:39], v[248:251], v[96:111]
    v_rcp_f32 v81, v81
    v_rcp_f32 v82, v82
    v_rcp_f32 v83, v83
    ds_read_b64_tr_b16 v[36:37], v6 offset:64
    ds_read_b64_tr_b16 v[38:39], v6 offset:832
    s_waitcnt lgkmcnt(9)
    v_mfma_f32_32x32x16_bf16 v[96:111], v[40:43], v[252:255], v[96:111]
    v_rcp_f32 v84, v84
    v_rcp_f32 v85, v85
    v_rcp_f32 v86, v86
    s_waitcnt vmcnt(0)
    ds_read_b64_tr_b16 v[200:201], v29 offset:49280
    ds_read_b64_tr_b16 v[202:203], v29 offset:49792
    ds_read_b64_tr_b16 v[204:205], v30 offset:49280
    ds_read_b64_tr_b16 v[206:207], v30 offset:49792
    s_waitcnt lgkmcnt(8)
    s_lshl1_add_u32 m0, s39, 123200
    s_add_u32 s42, s22, 32768
    buffer_load_dwordx4 v28, s[48:51], s42 offen lds
    ds_read_b64_tr_b16 v[40:41], v7 offset:64
    ds_read_b64_tr_b16 v[42:43], v7 offset:832
    v_mfma_f32_32x32x16_bf16 v[96:111], v[44:47], v[8:11], v[96:111]
    v_rcp_f32 v87, v87
    v_mul_f32 v80, v80, v88
    v_mul_f32 v81, v81, v89
    v_mul_f32 v82, v82, v90
    v_mul_f32 v83, v83, v91
    s_lshl1_add_u32 m0, s39, 123200
    s_add_u32 s42, s22, 39936
    buffer_load_dwordx4 v28, s[48:51], s42 offen offset:1024 lds
    ds_read_b64_tr_b16 v[44:45], v5 offset:24704
    ds_read_b64_tr_b16 v[46:47], v5 offset:25472
    s_waitcnt lgkmcnt(10)
    v_mfma_f32_32x32x16_bf16 v[112:127], v[32:35], v[212:215], v[112:127]
    v_mul_f32 v84, v84, v92
    v_mul_f32 v85, v85, v93
    v_mul_f32 v86, v86, v94
    v_mul_f32 v87, v87, v95
    v_cvt_pk_bf16_f32 v80, v80, v81
    v_cvt_pk_bf16_f32 v81, v82, v83
    s_waitcnt lgkmcnt(4)
    s_lshl1_add_u32 m0, s39, 139584
    s_add_u32 s42, s23, 0
    buffer_load_dwordx4 v28, s[48:51], s42 offen lds
    ds_read_b64_tr_b16 v[32:33], v6 offset:24704
    ds_read_b64_tr_b16 v[34:35], v6 offset:25472
    v_mfma_f32_32x32x16_bf16 v[112:127], v[36:39], v[216:219], v[112:127]
    v_cvt_pk_bf16_f32 v82, v84, v85
    v_cvt_pk_bf16_f32 v83, v86, v87
    v_mul_f32 v96, v96, v24
    v_mul_f32 v97, v97, v24
    v_mul_f32 v98, v98, v24
    v_mul_f32 v99, v99, v24
    s_cmp_lg_u32 s101, 0
    s_cbranch_scc1 L_parallel_sum__linear_kernel_hedgehog__glu_gated_glu__prompt_kernel_10_ss1
    buffer_store_dwordx4 v[80:83], v0, s[24:27], s52 offen offset:0
L_parallel_sum__linear_kernel_hedgehog__glu_gated_glu__prompt_kernel_10_sb1:
    ds_read_b64_tr_b16 v[36:37], v7 offset:24704
    ds_read_b64_tr_b16 v[38:39], v7 offset:25472
    s_waitcnt lgkmcnt(6)
    v_mfma_f32_32x32x16_bf16 v[112:127], v[40:43], v[220:223], v[112:127]
    v_mul_f32 v100, v100, v24
    v_mul_f32 v101, v101, v24
    v_mul_f32 v102, v102, v24
    v_mul_f32 v103, v103, v24
    v_exp_f32 v96, v96
    s_lshl1_add_u32 m0, s39, 139584
    s_add_u32 s42, s23, 7168
    buffer_load_dwordx4 v28, s[48:51], s42 offen offset:1024 lds
    ds_read_b64_tr_b16 v[40:41], v5 offset:49344
    ds_read_b64_tr_b16 v[42:43], v5 offset:50112
    s_waitcnt lgkmcnt(6)
    v_mfma_f32_32x32x16_bf16 v[112:127], v[44:47], v[228:231], v[112:127]
    v_exp_f32 v97, v97
    v_exp_f32 v98, v98
    v_exp_f32 v99, v99
    buffer_load_dwordx4 v[76:79], v0, s[24:27], s54 offen sc1
    ds_read_b64_tr_b16 v[44:45], v6 offset:49344
    ds_read_b64_tr_b16 v[46:47], v6 offset:50112
    s_waitcnt lgkmcnt(6)
    v_mfma_f32_32x32x16_bf16 v[112:127], v[32:35], v[232:235], v[112:127]
    v_exp_f32 v100, v100
    v_exp_f32 v101, v101
    v_exp_f32 v102, v102
    ds_read_b64_tr_b16 v[32:33], v7 offset:49344
    ds_read_b64_tr_b16 v[34:35], v7 offset:50112
    s_waitcnt lgkmcnt(6)
    v_mfma_f32_32x32x16_bf16 v[112:127], v[36:39], v[236:239], v[112:127]
    v_exp_f32 v103, v103
    v_fma_f32 v96, v96, v25, v25
    v_fma_f32 v97, v97, v25, v25
    v_fma_f32 v98, v98, v25, v25
    v_fma_f32 v99, v99, v25, v25
    ds_read_b128 v[36:39], v0 offset:35456
    s_waitcnt lgkmcnt(5)
    v_mfma_f32_32x32x16_bf16 v[112:127], v[40:43], v[244:247], v[112:127]
    v_rcp_f32 v96, v96
    v_fma_f32 v100, v100, v25, v25
    v_fma_f32 v101, v101, v25, v25
    v_fma_f32 v102, v102, v25, v25
    v_fma_f32 v103, v103, v25, v25
    s_waitcnt lgkmcnt(3)
    v_mfma_f32_32x32x16_bf16 v[112:127], v[44:47], v[248:251], v[112:127]
    v_rcp_f32 v97, v97
    v_rcp_f32 v98, v98
    v_rcp_f32 v99, v99
    s_waitcnt lgkmcnt(1)
    v_mfma_f32_32x32x16_bf16 v[112:127], v[32:35], v[252:255], v[112:127]
    v_rcp_f32 v100, v100
    v_rcp_f32 v101, v101
    v_rcp_f32 v102, v102
    s_waitcnt lgkmcnt(0)
    v_mfma_f32_32x32x16_bf16 v[112:127], v[36:39], v[8:11], v[112:127]
    v_rcp_f32 v103, v103
    v_mul_f32 v96, v96, v104
    v_mul_f32 v97, v97, v105
    v_mul_f32 v98, v98, v106
    v_mul_f32 v99, v99, v107
    v_mul_f32 v100, v100, v108
    v_mul_f32 v101, v101, v109
    v_mul_f32 v102, v102, v110
    v_mul_f32 v103, v103, v111
    v_cvt_pk_bf16_f32 v96, v96, v97
    v_cvt_pk_bf16_f32 v97, v98, v99
    v_cvt_pk_bf16_f32 v98, v100, v101
    v_cvt_pk_bf16_f32 v99, v102, v103
    s_cmp_lg_u32 s101, 0
    s_cbranch_scc1 L_parallel_sum__linear_kernel_hedgehog__glu_gated_glu__prompt_kernel_10_ss2
    buffer_store_dwordx4 v[96:99], v0, s[24:27], s52 offen offset:1024
L_parallel_sum__linear_kernel_hedgehog__glu_gated_glu__prompt_kernel_10_sb2:
    v_mul_f32 v112, v112, v24
    v_mul_f32 v113, v113, v24
    v_mul_f32 v114, v114, v24
    v_mul_f32 v115, v115, v24
    v_mul_f32 v116, v116, v24
    v_mul_f32 v117, v117, v24
    v_mul_f32 v118, v118, v24
    v_mul_f32 v119, v119, v24
    s_waitcnt vmcnt(1)
    v_cmp_eq_u32 vcc, -1, v76
    s_nop 1
    s_cbranch_vccnz L_parallel_sum__linear_kernel_hedgehog__glu_gated_glu__prompt_kernel_10_zp
L_parallel_sum__linear_kernel_hedgehog__glu_gated_glu__prompt_kernel_10_zb:
    buffer_load_dwordx4 v[80:83], v0, s[24:27], s53 offen offset:0
    buffer_load_dwordx4 v[84:87], v0, s[24:27], s53 offen offset:1024
    buffer_load_dwordx4 v[88:91], v0, s[24:27], s53 offen offset:2048
    buffer_load_dwordx4 v[92:95], v0, s[24:27], s53 offen offset:3072
    s_add_u32 s58, s53, 4096
    buffer_load_dwordx4 v[96:99], v0, s[24:27], s58 offen offset:0
    buffer_load_dwordx4 v[100:103], v0, s[24:27], s58 offen offset:1024
    buffer_load_dwordx4 v[104:107], v0, s[24:27], s58 offen offset:2048
    buffer_load_dwordx4 v[108:111], v0, s[24:27], s58 offen offset:3072
    v_exp_f32 v112, v112
    v_exp_f32 v113, v113
    v_exp_f32 v114, v114
    v_exp_f32 v115, v115
    v_exp_f32 v116, v116
    v_exp_f32 v117, v117
    v_exp_f32 v118, v118
    v_exp_f32 v119, v119
    v_fma_f32 v112, v112, v25, v25
    v_fma_f32 v113, v113, v25, v25
    v_fma_f32 v114, v114, v25, v25
    v_fma_f32 v115, v115, v25, v25
    v_fma_f32 v116, v116, v25, v25
    v_fma_f32 v117, v117, v25, v25
    v_fma_f32 v118, v118, v25, v25
    v_fma_f32 v119, v119, v25, v25
    v_rcp_f32 v112, v112
    v_rcp_f32 v113, v113
    v_rcp_f32 v114, v114
    v_rcp_f32 v115, v115
    v_rcp_f32 v116, v116
    v_rcp_f32 v117, v117
    v_rcp_f32 v118, v118
    v_rcp_f32 v119, v119
    v_mul_f32 v112, v112, v120
    v_mul_f32 v113, v113, v121
    v_mul_f32 v114, v114, v122
    v_mul_f32 v115, v115, v123
    v_mul_f32 v116, v116, v124
    v_mul_f32 v117, v117, v125
    v_mul_f32 v118, v118, v126
    v_mul_f32 v119, v119, v127
    v_cvt_pk_bf16_f32 v112, v112, v113
    v_cvt_pk_bf16_f32 v113, v114, v115
    v_cvt_pk_bf16_f32 v114, v116, v117
    v_cvt_pk_bf16_f32 v115, v118, v119
    buffer_load_dword v26, v31, s[24:27], s31 offen sc1
    s_cmp_lg_u32 s101, 0
    s_cbranch_scc1 L_parallel_sum__linear_kernel_hedgehog__glu_gated_glu__prompt_kernel_10_ss3
    buffer_store_dwordx4 v[112:115], v0, s[24:27], s52 offen offset:2048
L_parallel_sum__linear_kernel_hedgehog__glu_gated_glu__prompt_kernel_10_sb3:
    s_mov_b32 s56, 0
L_parallel_sum__linear_kernel_hedgehog__glu_gated_glu__prompt_kernel_10_pre:
    s_waitcnt vmcnt(9)
    v_mfma_f32_16x16x32_bf16 v[12:15], v[72:75], v[80:83], 0
    s_waitcnt vmcnt(8)
    v_mfma_f32_16x16x32_bf16 v[12:15], v[72:75], v[84:87], v[12:15]
    s_waitcnt vmcnt(7)
    v_mfma_f32_16x16x32_bf16 v[12:15], v[72:75], v[88:91], v[12:15]
    s_waitcnt vmcnt(6)
    v_mfma_f32_16x16x32_bf16 v[12:15], v[72:75], v[92:95], v[12:15]
    s_waitcnt vmcnt(5)
    v_mfma_f32_16x16x32_bf16 v[12:15], v[72:75], v[96:99], v[12:15]
    s_waitcnt vmcnt(4)
    v_mfma_f32_16x16x32_bf16 v[12:15], v[72:75], v[100:103], v[12:15]
    s_waitcnt vmcnt(3)
    v_mfma_f32_16x16x32_bf16 v[12:15], v[72:75], v[104:107], v[12:15]
    s_waitcnt vmcnt(2)
    v_mfma_f32_16x16x32_bf16 v[12:15], v[72:75], v[108:111], v[12:15]
    ds_write_b128 v2, v[76:79] offset:1024
    v_mfma_f32_16x16x32_bf16 v[80:83], v[72:75], v[76:79], v[12:15]
    s_nop 5
    v_cvt_pk_bf16_f32 v84, v12, v13
    v_cvt_pk_bf16_f32 v85, v14, v15
    ds_write_b64 v1, v[84:85]
    v_cmp_u_f32 vcc, v80, v80
    s_nop 1
    s_cbranch_vccnz L_parallel_sum__linear_kernel_hedgehog__glu_gated_glu__prompt_kernel_10_rt
L_parallel_sum__linear_kernel_hedgehog__glu_gated_glu__prompt_kernel_10_go:
    v_mov_b32 v27, 3
    s_waitcnt vmcnt(0)
    s_mov_b64 exec, 1
    s_cmp_lg_u32 s101, 0
    s_cbranch_scc1 L_parallel_sum__linear_kernel_hedgehog__glu_gated_glu__prompt_kernel_10_ss4
    buffer_store_dword v27, off, s[24:27], s33
L_parallel_sum__linear_kernel_hedgehog__glu_gated_glu__prompt_kernel_10_sb4:
    s_mov_b64 exec, -1
    s_waitcnt lgkmcnt(0)
    s_barrier
    ds_read_b128 v[80:83], v3 offset:0
    ds_read_b128 v[84:87], v3 offset:16
    ds_read_b128 v[88:91], v3 offset:2048
    ds_read_b128 v[92:95], v3 offset:2064
    s_waitcnt lgkmcnt(3)
    v_mfma_f32_32x32x16_bf16 v[208:223], v[80:83], v[56:59], 0
    s_waitcnt lgkmcnt(2)
    v_mfma_f32_32x32x16_bf16 v[208:223], v[84:87], v[60:63], v[208:223]
    s_waitcnt lgkmcnt(1)
    v_mfma_f32_32x32x16_bf16 v[224:239], v[88:91], v[64:67], 0
    s_waitcnt lgkmcnt(0)
    v_mfma_f32_32x32x16_bf16 v[224:239], v[92:95], v[68:71], v[224:239]
    buffer_load_dword v26, v31, s[24:27], s31 offen sc1
    s_lshl1_add_u32 m0, s39, 49152
    s_add_u32 s42, s22, 65536
    buffer_load_dwordx4 v28, s[48:51], s42 offen lds
    s_lshl1_add_u32 m0, s39, 49152
    s_add_u32 s42, s22, 72704
    buffer_load_dwordx4 v28, s[48:51], s42 offen offset:1024 lds
    s_nop 0
    v_add_f32 v216, v216, v220
    v_add_f32 v217, v217, v221
    v_add_f32 v218, v218, v222
    v_add_f32 v219, v219, v223
    v_add_f32 v216, v216, v217
    v_add_f32 v218, v218, v219
    v_add_f32 v216, v216, v218
    v_mov_b32 v217, v216
    s_nop 1
    v_permlane32_swap_b32 v216, v217
    v_add_f32 v216, v216, v217
    v_add_f32 v216, 0x358637bd, v216
    v_rcp_f32 v216, v216
    s_nop 0
    v_mul_f32 v208, v208, v216
    v_mul_f32 v209, v209, v216
    v_mul_f32 v210, v210, v216
    v_mul_f32 v211, v211, v216
    v_mul_f32 v212, v212, v216
    v_mul_f32 v213, v213, v216
    v_mul_f32 v214, v214, v216
    v_mul_f32 v215, v215, v216
    v_cvt_pk_bf16_f32 v208, v208, v209
    v_cvt_pk_bf16_f32 v209, v210, v211
    v_cvt_pk_bf16_f32 v210, v212, v213
    v_cvt_pk_bf16_f32 v211, v214, v215
    s_cmp_lg_u32 s101, 0
    s_cbranch_scc1 L_parallel_sum__linear_kernel_hedgehog__glu_gated_glu__prompt_kernel_10_ss5
    buffer_store_dwordx4 v[208:211], v0, s[24:27], s35 offen offset:0
L_parallel_sum__linear_kernel_hedgehog__glu_gated_glu__prompt_kernel_10_sb5:
    v_add_f32 v232, v232, v236
    v_add_f32 v233, v233, v237
    v_add_f32 v234, v234, v238
    v_add_f32 v235, v235, v239
    v_add_f32 v232, v232, v233
    v_add_f32 v234, v234, v235
    v_add_f32 v232, v232, v234
    v_mov_b32 v233, v232
    s_nop 1
    v_permlane32_swap_b32 v232, v233
    v_add_f32 v232, v232, v233
    v_add_f32 v232, 0x358637bd, v232
    v_rcp_f32 v232, v232
    s_nop 0
    v_mul_f32 v224, v224, v232
    v_mul_f32 v225, v225, v232
    v_mul_f32 v226, v226, v232
    v_mul_f32 v227, v227, v232
    v_mul_f32 v228, v228, v232
    v_mul_f32 v229, v229, v232
    v_mul_f32 v230, v230, v232
    v_mul_f32 v231, v231, v232
    v_cvt_pk_bf16_f32 v224, v224, v225
    v_cvt_pk_bf16_f32 v225, v226, v227
    v_cvt_pk_bf16_f32 v226, v228, v229
    v_cvt_pk_bf16_f32 v227, v230, v231
    s_cmp_lg_u32 s101, 0
    s_cbranch_scc1 L_parallel_sum__linear_kernel_hedgehog__glu_gated_glu__prompt_kernel_10_ss6
    buffer_store_dwordx4 v[224:227], v0, s[24:27], s35 offen offset:1024
L_parallel_sum__linear_kernel_hedgehog__glu_gated_glu__prompt_kernel_10_sb6:
    s_waitcnt vmcnt(4)
    v_cmp_gt_u32 vcc, 3, v26
    s_and_b32 s57, vcc_lo, 240
    s_cbranch_scc1 L_parallel_sum__linear_kernel_hedgehog__glu_gated_glu__prompt_kernel_10_fp1
L_parallel_sum__linear_kernel_hedgehog__glu_gated_glu__prompt_kernel_10_fb1:
    s_add_u32 s42, s28, 0
    buffer_load_dwordx4 v[96:99], v0, s[24:27], s42 offen
    s_add_u32 s42, s28, 120832
    buffer_load_dwordx4 v[100:103], v0, s[24:27], s42 offen
    v_mov_b32 v27, 4
    s_waitcnt vmcnt(2)
    s_mov_b64 exec, 1
    s_cmp_lg_u32 s101, 0
    s_cbranch_scc1 L_parallel_sum__linear_kernel_hedgehog__glu_gated_glu__prompt_kernel_10_ss7
    buffer_store_dword v27, off, s[24:27], s33
L_parallel_sum__linear_kernel_hedgehog__glu_gated_glu__prompt_kernel_10_sb7:
    s_mov_b64 exec, -1
    s_add_u32 s42, s28, 3072
    buffer_load_dwordx4 v[104:107], v0, s[24:27], s42 offen
    s_add_u32 s42, s28, 123904
    buffer_load_dwordx4 v[108:111], v0, s[24:27], s42 offen
    s_add_u32 s42, s28, 1024
    buffer_load_dwordx4 v[112:115], v0, s[24:27], s42 offen
    s_add_u32 s42, s28, 121856
    buffer_load_dwordx4 v[116:119], v0, s[24:27], s42 offen
    s_add_u32 s42, s28, 4096
    buffer_load_dwordx4 v[120:123], v0, s[24:27], s42 offen
    s_add_u32 s42, s28, 124928
    buffer_load_dwordx4 v[124:127], v0, s[24:27], s42 offen
    s_add_u32 s42, s28, 2048
    buffer_load_dwordx4 v[80:83], v0, s[24:27], s42 offen
    s_add_u32 s42, s28, 122880
    buffer_load_dwordx4 v[84:87], v0, s[24:27], s42 offen
    s_add_u32 s42, s28, 5120
    buffer_load_dwordx4 v[88:91], v0, s[24:27], s42 offen
    s_add_u32 s42, s28, 125952
    buffer_load_dwordx4 v[92:95], v0, s[24:27], s42 offen
    buffer_load_dword v26, v31, s[24:27], s31 offen sc1
    s_waitcnt vmcnt(13)
    v_mfma_f32_32x32x16_bf16 v[208:223], v[128:131], v[96:99], 0
    s_waitcnt vmcnt(12)
    v_mfma_f32_32x32x16_bf16 v[240:255], v[128:131], v[100:103], 0
    v_mfma_f32_32x32x16_bf16 v[224:239], v[132:135], v[96:99], 0
    v_mfma_f32_32x32x16_bf16 v[32:47], v[132:135], v[100:103], 0
    s_waitcnt vmcnt(10)
    v_mfma_f32_32x32x16_bf16 v[208:223], v[136:139], v[104:107], v[208:223]
    s_waitcnt vmcnt(9)
    v_mfma_f32_32x32x16_bf16 v[240:255], v[136:139], v[108:111], v[240:255]
    v_mfma_f32_32x32x16_bf16 v[224:239], v[140:143], v[104:107], v[224:239]
    v_mfma_f32_32x32x16_bf16 v[32:47], v[140:143], v[108:111], v[32:47]
    s_waitcnt vmcnt(8)
    v_mfma_f32_32x32x16_bf16 v[208:223], v[144:147], v[112:115], v[208:223]
    s_waitcnt vmcnt(7)
    v_mfma_f32_32x32x16_bf16 v[240:255], v[144:147], v[116:119], v[240:255]
    v_mfma_f32_32x32x16_bf16 v[224:239], v[148:151], v[112:115], v[224:239]
    v_mfma_f32_32x32x16_bf16 v[32:47], v[148:151], v[116:119], v[32:47]
    s_waitcnt vmcnt(6)
    v_mfma_f32_32x32x16_bf16 v[208:223], v[152:155], v[120:123], v[208:223]
    s_waitcnt vmcnt(5)
    v_mfma_f32_32x32x16_bf16 v[240:255], v[152:155], v[124:127], v[240:255]
    v_mfma_f32_32x32x16_bf16 v[224:239], v[156:159], v[120:123], v[224:239]
    v_mfma_f32_32x32x16_bf16 v[32:47], v[156:159], v[124:127], v[32:47]
    ds_read_b64_tr_b16 v[128:129], v29 offset:32896
    ds_read_b64_tr_b16 v[130:131], v29 offset:33408
    ds_read_b64_tr_b16 v[132:133], v30 offset:32896
    ds_read_b64_tr_b16 v[134:135], v30 offset:33408
    ds_read_b64_tr_b16 v[136:137], v29 offset:49280
    ds_read_b64_tr_b16 v[138:139], v29 offset:49792
    ds_read_b64_tr_b16 v[140:141], v30 offset:49280
    ds_read_b64_tr_b16 v[142:143], v30 offset:49792
    v_add_u32 v5, 4294950912, v29
    v_add_u32 v6, 4294950912, v30
    ds_read_b64_tr_b16 v[144:145], v5 offset:0
    ds_read_b64_tr_b16 v[146:147], v5 offset:512
    ds_read_b64_tr_b16 v[148:149], v6 offset:0
    ds_read_b64_tr_b16 v[150:151], v6 offset:512
    ds_read_b64_tr_b16 v[152:153], v29 offset:0
    ds_read_b64_tr_b16 v[154:155], v29 offset:512
    ds_read_b64_tr_b16 v[156:157], v30 offset:0
    ds_read_b64_tr_b16 v[158:159], v30 offset:512
    s_waitcnt vmcnt(0)
    v_cmp_gt_u32 vcc, 4, v26
    s_and_b32 s57, vcc_lo, 240
    s_cbranch_scc1 L_parallel_sum__linear_kernel_hedgehog__glu_gated_glu__prompt_kernel_10_fp2
L_parallel_sum__linear_kernel_hedgehog__glu_gated_glu__prompt_kernel_10_fb2:
    s_add_u32 s42, s29, 0
    buffer_load_dwordx4 v[48:51], v0, s[24:27], s42 offen
    s_add_u32 s42, s29, 120832
    buffer_load_dwordx4 v[52:55], v0, s[24:27], s42 offen
    v_mfma_f32_32x32x16_bf16 v[208:223], v[160:163], v[80:83], v[208:223]
    v_mfma_f32_32x32x16_bf16 v[240:255], v[160:163], v[84:87], v[240:255]
    v_mfma_f32_32x32x16_bf16 v[224:239], v[164:167], v[80:83], v[224:239]
    v_mfma_f32_32x32x16_bf16 v[32:47], v[164:167], v[84:87], v[32:47]
    s_add_u32 s42, s29, 1024
    buffer_load_dwordx4 v[56:59], v0, s[24:27], s42 offen
    s_add_u32 s42, s29, 121856
    buffer_load_dwordx4 v[60:63], v0, s[24:27], s42 offen
    s_add_u32 s42, s29, 2048
    buffer_load_dwordx4 v[64:67], v0, s[24:27], s42 offen
    s_add_u32 s42, s29, 122880
    buffer_load_dwordx4 v[68:71], v0, s[24:27], s42 offen
    v_mfma_f32_32x32x16_bf16 v[208:223], v[168:171], v[88:91], v[208:223]
    v_mfma_f32_32x32x16_bf16 v[240:255], v[168:171], v[92:95], v[240:255]
    v_mfma_f32_32x32x16_bf16 v[224:239], v[172:175], v[88:91], v[224:239]
    v_mfma_f32_32x32x16_bf16 v[32:47], v[172:175], v[92:95], v[32:47]
    s_add_u32 s42, s29, 3072
    buffer_load_dwordx4 v[72:75], v0, s[24:27], s42 offen
    s_add_u32 s42, s29, 123904
    buffer_load_dwordx4 v[76:79], v0, s[24:27], s42 offen
    v_add_u32 v5, 4294926144, v29
    v_add_u32 v6, 4294926144, v30
    ds_read_b64_tr_b16 v[160:161], v5 offset:0
    ds_read_b64_tr_b16 v[162:163], v5 offset:512
    ds_read_b64_tr_b16 v[164:165], v6 offset:0
    ds_read_b64_tr_b16 v[166:167], v6 offset:512
    v_and_b32 v4, 48, v0
    v_bfe_u32 v13, v0, 6, 2
    v_lshl_add_u32 v4, v13, 10, v4
    v_bfe_u32 v7, v0, 8, 1
    v_lshl_add_u32 v4, v7, 6, v4
    v_bfe_u32 v7, v0, 9, 1
    v_lshl_add_u32 v4, v7, 12, v4
    buffer_load_dwordx4 v[8:11], v4, s[8:11], s0 offen
    v_bfe_u32 v7, v0, 8, 2
    v_lshlrev_b32 v7, 11, v7
    v_lshl_add_u32 v7, v13, 4, v7
    v_lshl_add_u32 v7, s37, 7, v7
    v_bfe_u32 v13, v0, 4, 2
    v_mov_b32 v12, 0
    v_mov_b32 v14, 16448
    v_cmp_eq_u32 vcc, 1, v13
    s_nop 1
    v_cndmask_b32 v12, v12, v14, vcc
    v_mov_b32 v14, 32896
    v_cmp_eq_u32 vcc, 2, v13
    s_nop 1
    v_cndmask_b32 v12, v12, v14, vcc
    v_mov_b32 v14, 49344
    v_cmp_eq_u32 vcc, 3, v13
    s_nop 1
    v_cndmask_b32 v12, v12, v14, vcc
    v_add_u32 v12, v12, v7
    v_and_b32 v14, 16, v0
    v_mov_b32 v7, 0x3f80
    v_lshlrev_b32 v14, v14, v7
    v_bfe_u32 v7, v0, 5, 3
    v_cmp_eq_u32 vcc, 0, v7
    s_nop 1
    v_cndmask_b32 v168, 0, v14, vcc
    v_cmp_eq_u32 vcc, 1, v7
    s_nop 1
    v_cndmask_b32 v169, 0, v14, vcc
    v_cmp_eq_u32 vcc, 2, v7
    s_nop 1
    v_cndmask_b32 v170, 0, v14, vcc
    v_cmp_eq_u32 vcc, 3, v7
    s_nop 1
    v_cndmask_b32 v171, 0, v14, vcc
    v_cmp_eq_u32 vcc, 4, v7
    s_nop 1
    v_cndmask_b32 v172, 0, v14, vcc
    v_cmp_eq_u32 vcc, 5, v7
    s_nop 1
    v_cndmask_b32 v173, 0, v14, vcc
    v_cmp_eq_u32 vcc, 6, v7
    s_nop 1
    v_cndmask_b32 v174, 0, v14, vcc
    v_cmp_eq_u32 vcc, 7, v7
    s_nop 1
    v_cndmask_b32 v175, 0, v14, vcc
    v_cmp_gt_u32 vcc, 3, v26
    s_and_b32 s57, vcc_lo, 15
    s_cbranch_scc1 L_parallel_sum__linear_kernel_hedgehog__glu_gated_glu__prompt_kernel_10_fp3
L_parallel_sum__linear_kernel_hedgehog__glu_gated_glu__prompt_kernel_10_fb3:
    s_add_u32 s42, s30, 2048
    buffer_load_dwordx4 v[96:99], v0, s[24:27], s42 offen
    s_add_u32 s42, s30, 122880
    buffer_load_dwordx4 v[100:103], v0, s[24:27], s42 offen
    s_waitcnt vmcnt(10)
    v_mfma_f32_32x32x16_bf16 v[208:223], v[176:179], v[48:51], v[208:223]
    s_waitcnt vmcnt(9)
    v_mfma_f32_32x32x16_bf16 v[240:255], v[176:179], v[52:55], v[240:255]
    v_mfma_f32_32x32x16_bf16 v[224:239], v[180:183], v[48:51], v[224:239]
    v_mfma_f32_32x32x16_bf16 v[32:47], v[180:183], v[52:55], v[32:47]
    s_add_u32 s42, s36, 0
    buffer_load_dwordx4 v[104:107], v0, s[24:27], s42 offen
    s_add_u32 s42, s36, 120832
    buffer_load_dwordx4 v[108:111], v0, s[24:27], s42 offen
    s_waitcnt vmcnt(10)
    v_mfma_f32_32x32x16_bf16 v[208:223], v[184:187], v[56:59], v[208:223]
    s_waitcnt vmcnt(9)
    v_mfma_f32_32x32x16_bf16 v[240:255], v[184:187], v[60:63], v[240:255]
    v_mfma_f32_32x32x16_bf16 v[224:239], v[188:191], v[56:59], v[224:239]
    v_mfma_f32_32x32x16_bf16 v[32:47], v[188:191], v[60:63], v[32:47]
    s_add_u32 s42, s30, 3072
    buffer_load_dwordx4 v[112:115], v0, s[24:27], s42 offen
    s_add_u32 s42, s30, 123904
    buffer_load_dwordx4 v[116:119], v0, s[24:27], s42 offen
    s_waitcnt vmcnt(10)
    v_mfma_f32_32x32x16_bf16 v[208:223], v[192:195], v[64:67], v[208:223]
    s_waitcnt vmcnt(9)
    v_mfma_f32_32x32x16_bf16 v[240:255], v[192:195], v[68:71], v[240:255]
    v_mfma_f32_32x32x16_bf16 v[224:239], v[196:199], v[64:67], v[224:239]
    v_mfma_f32_32x32x16_bf16 v[32:47], v[196:199], v[68:71], v[32:47]
    s_add_u32 s42, s36, 1024
    buffer_load_dwordx4 v[120:123], v0, s[24:27], s42 offen
    s_add_u32 s42, s36, 121856
    buffer_load_dwordx4 v[124:127], v0, s[24:27], s42 offen
    s_waitcnt vmcnt(10)
    v_mfma_f32_32x32x16_bf16 v[208:223], v[200:203], v[72:75], v[208:223]
    s_waitcnt vmcnt(9)
    v_mfma_f32_32x32x16_bf16 v[240:255], v[200:203], v[76:79], v[240:255]
    v_mfma_f32_32x32x16_bf16 v[224:239], v[204:207], v[72:75], v[224:239]
    v_mfma_f32_32x32x16_bf16 v[32:47], v[204:207], v[76:79], v[32:47]
    s_add_u32 s42, s30, 4096
    buffer_load_dwordx4 v[80:83], v0, s[24:27], s42 offen
    s_add_u32 s42, s30, 124928
    buffer_load_dwordx4 v[84:87], v0, s[24:27], s42 offen
    s_waitcnt vmcnt(9) lgkmcnt(15)
    v_mfma_f32_32x32x16_bf16 v[208:223], v[128:131], v[96:99], v[208:223]
    s_waitcnt vmcnt(8)
    v_mfma_f32_32x32x16_bf16 v[240:255], v[128:131], v[100:103], v[240:255]
    v_mfma_f32_32x32x16_bf16 v[224:239], v[132:135], v[96:99], v[224:239]
    v_mfma_f32_32x32x16_bf16 v[32:47], v[132:135], v[100:103], v[32:47]
    s_waitcnt vmcnt(7) lgkmcnt(14)
    v_mfma_f32_32x32x16_bf16 v[208:223], v[136:139], v[104:107], v[208:223]
    s_waitcnt vmcnt(6)
    v_mfma_f32_32x32x16_bf16 v[240:255], v[136:139], v[108:111], v[240:255]
    s_waitcnt lgkmcnt(12)
    v_mfma_f32_32x32x16_bf16 v[224:239], v[140:143], v[104:107], v[224:239]
    v_mfma_f32_32x32x16_bf16 v[32:47], v[140:143], v[108:111], v[32:47]
    s_waitcnt vmcnt(5) lgkmcnt(10)
    v_mfma_f32_32x32x16_bf16 v[208:223], v[144:147], v[112:115], v[208:223]
    s_waitcnt vmcnt(4)
    v_mfma_f32_32x32x16_bf16 v[240:255], v[144:147], v[116:119], v[240:255]
    s_waitcnt lgkmcnt(8)
    v_mfma_f32_32x32x16_bf16 v[224:239], v[148:151], v[112:115], v[224:239]
    v_mfma_f32_32x32x16_bf16 v[32:47], v[148:151], v[116:119], v[32:47]
    s_lshl_b32 s56, s39, 1
    s_sub_u32 s56, s56, 122880
    v_add_u32 v5, s56, v0
    v_add_u32 v6, 73920, v5
    v_add_u32 v7, 123200, v5
    s_waitcnt vmcnt(3) lgkmcnt(6)
    v_mfma_f32_32x32x16_bf16 v[208:223], v[152:155], v[120:123], v[208:223]
    s_waitcnt vmcnt(1) lgkmcnt(2)
    v_mfma_f32_32x32x16_bf16 v[208:223], v[160:163], v[80:83], v[208:223]
    v_mfma_f32_32x32x16_bf16 v[240:255], v[152:155], v[124:127], v[240:255]
    s_waitcnt vmcnt(0)
    v_mfma_f32_32x32x16_bf16 v[240:255], v[160:163], v[84:87], v[240:255]
    s_nop 8
    v_cvt_pk_bf16_f32 v208, v208, v209
    v_cvt_pk_bf16_f32 v209, v210, v211
    v_cvt_pk_bf16_f32 v210, v212, v213
    v_cvt_pk_bf16_f32 v211, v214, v215
    ds_write_b128 v5, v[208:211] offset:0
    v_cvt_pk_bf16_f32 v216, v216, v217
    v_cvt_pk_bf16_f32 v217, v218, v219
    v_cvt_pk_bf16_f32 v218, v220, v221
    v_cvt_pk_bf16_f32 v219, v222, v223
    ds_write_b128 v5, v[216:219] offset:16448
    v_mfma_f32_32x32x16_bf16 v[224:239], v[156:159], v[120:123], v[224:239]
    s_waitcnt lgkmcnt(2)
    v_mfma_f32_32x32x16_bf16 v[224:239], v[164:167], v[80:83], v[224:239]
    v_cvt_pk_bf16_f32 v240, v240, v241
    v_cvt_pk_bf16_f32 v241, v242, v243
    v_cvt_pk_bf16_f32 v242, v244, v245
    v_cvt_pk_bf16_f32 v243, v246, v247
    ds_write_b128 v6, v[240:243] offset:64
    v_cvt_pk_bf16_f32 v248, v248, v249
    v_cvt_pk_bf16_f32 v249, v250, v251
    v_cvt_pk_bf16_f32 v250, v252, v253
    v_cvt_pk_bf16_f32 v251, v254, v255
    ds_write_b128 v6, v[248:251] offset:16512
    v_mfma_f32_32x32x16_bf16 v[32:47], v[156:159], v[124:127], v[32:47]
    v_mfma_f32_32x32x16_bf16 v[32:47], v[164:167], v[84:87], v[32:47]
    v_cvt_pk_bf16_f32 v224, v224, v225
    v_cvt_pk_bf16_f32 v225, v226, v227
    v_cvt_pk_bf16_f32 v226, v228, v229
    v_cvt_pk_bf16_f32 v227, v230, v231
    ds_write_b128 v5, v[224:227] offset:32896
    v_cvt_pk_bf16_f32 v232, v232, v233
    v_cvt_pk_bf16_f32 v233, v234, v235
    v_cvt_pk_bf16_f32 v234, v236, v237
    v_cvt_pk_bf16_f32 v235, v238, v239
    ds_write_b128 v5, v[232:235] offset:49344
    v_lshlrev_b32 v16, 16, v8
    v_and_b32 v17, s55, v8
    v_lshlrev_b32 v18, 16, v9
    v_and_b32 v19, s55, v9
    v_lshlrev_b32 v20, 16, v10
    v_and_b32 v21, s55, v10
    v_lshlrev_b32 v22, 16, v11
    v_and_b32 v23, s55, v11
    v_cvt_pk_bf16_f32 v32, v32, v33
    v_cvt_pk_bf16_f32 v33, v34, v35
    v_cvt_pk_bf16_f32 v34, v36, v37
    v_cvt_pk_bf16_f32 v35, v38, v39
    ds_write_b128 v7, v[32:35] offset:64
    v_cvt_pk_bf16_f32 v40, v40, v41
    v_cvt_pk_bf16_f32 v41, v42, v43
    v_cvt_pk_bf16_f32 v42, v44, v45
    v_cvt_pk_bf16_f32 v43, v46, v47
    ds_write_b128 v7, v[40:43] offset:16512
    s_waitcnt lgkmcnt(0)
    s_barrier
    ds_read_b128 v[128:131], v12 offset:0
    ds_read_b128 v[132:135], v12 offset:512
    ds_read_b128 v[136:139], v12 offset:64
    ds_read_b128 v[140:143], v12 offset:576
    ds_read_b128 v[144:147], v12 offset:8192
    ds_read_b128 v[148:151], v12 offset:8704
    ds_read_b128 v[152:155], v12 offset:8256
    ds_read_b128 v[156:159], v12 offset:8768
    s_waitcnt lgkmcnt(7)
    v_mfma_f32_16x16x32_bf16 v[16:19], v[168:171], v[128:131], v[16:19]
    s_waitcnt lgkmcnt(6)
    v_mfma_f32_16x16x32_bf16 v[20:23], v[168:171], v[132:135], v[20:23]
    s_waitcnt lgkmcnt(5)
    v_mfma_f32_16x16x32_bf16 v[16:19], v[172:175], v[136:139], v[16:19]
    s_waitcnt lgkmcnt(4)
    v_mfma_f32_16x16x32_bf16 v[20:23], v[172:175], v[140:143], v[20:23]
    s_waitcnt lgkmcnt(3)
    v_mfma_f32_16x16x32_bf16 v[16:19], v[168:171], v[144:147], v[16:19]
    s_waitcnt lgkmcnt(2)
    v_mfma_f32_16x16x32_bf16 v[20:23], v[168:171], v[148:151], v[20:23]
    s_waitcnt lgkmcnt(1)
    v_mfma_f32_16x16x32_bf16 v[16:19], v[172:175], v[152:155], v[16:19]
    s_waitcnt lgkmcnt(0)
    v_mfma_f32_16x16x32_bf16 v[20:23], v[172:175], v[156:159], v[20:23]
    s_nop 5
    v_cvt_pk_bf16_f32 v16, v16, v17
    v_cvt_pk_bf16_f32 v17, v18, v19
    v_cvt_pk_bf16_f32 v18, v20, v21
    v_cvt_pk_bf16_f32 v19, v22, v23
    buffer_store_dwordx4 v[16:19], v4, s[12:15], s0 offen sc1
    s_endpgm
.p2align 6
L_parallel_sum__linear_kernel_hedgehog__glu_gated_glu__prompt_kernel_r3:
    s_mov_b32 s30, 16384
    s_mov_b32 s31, 0x20000
    s_mov_b32 s22, 1409024
    s_mov_b32 s23, 0x20000
    s_mov_b32 s26, 16777216
    s_mov_b32 s27, 0x20000
    s_mov_b32 s6, 256
    s_mov_b32 s7, 0x20000
    s_mov_b32 s50, 1409024
    s_mov_b32 s51, 0x20000
    s_mov_b32 s55, 0xffff0000
    s_getreg_b32 s100, hwreg(HW_REG_XCC_ID, 0, 4)
    s_mul_i32 s101, s100, s100
    s_lshl_b32 s101, s101, 9
    s_add_u32 s100, s100, s101
    s_lshl_b32 s100, s100, 8
    s_add_u32 s100, s100, 1
    s_lshl_b32 s3, s37, 2
    v_mov_b32 v121, v2
    v_lshrrev_b32 v116, 5, v82
    v_and_b32 v117, 1, v2
    v_bfe_u32 v118, v82, 2, 2
    v_bfe_u32 v112, v82, 1, 1
    v_and_b32 v113, 1, v82
    v_lshl_or_b32 v119, v113, 1, v112
    v_lshlrev_b32 v119, 3, v119
    v_lshl_add_u32 v120, v116, 3, v118
    v_lshl_or_b32 v114, v117, 1, v112
    v_lshlrev_b32 v114, 3, v114
    v_lshl_add_u32 v114, v120, 5, v114
    v_lshl_add_u32 v114, v113, 11, v114
    v_add_u32 v27, 159360, v114
    v_and_b32 v113, 2, v118
    v_or_b32 v113, v113, v117
    v_lshl_add_u32 v113, v113, 5, v119
    v_lshl_add_u32 v113, v120, 7, v113
    s_lshl_b32 s56, s37, 11
    s_add_u32 s56, s56, 64
    v_xor_b32 v104, s56, v113
    v_and_b32 v112, 31, v82
    v_bfe_u32 v113, v82, 1, 3
    v_xor_b32 v113, v113, v116
    v_lshlrev_b32 v113, 4, v113
    v_lshl_add_u32 v113, v112, 7, v113
    s_mul_i32 s56, s37, 4128
    v_xor_b32 v96, s56, v113
    v_xor_b32 v97, 32, v96
    v_xor_b32 v105, 2048, v104
    v_xor_b32 v98, 64, v96
    v_xor_b32 v106, 4096, v104
    v_xor_b32 v99, 96, v96
    v_xor_b32 v107, 6144, v104
    v_add_u32 v100, 73920, v96
    v_add_u32 v108, 90304, v104
    v_add_u32 v104, 16384, v104
    v_add_u32 v101, 73920, v97
    v_add_u32 v109, 90304, v105
    v_add_u32 v105, 16384, v105
    v_add_u32 v102, 73920, v98
    v_add_u32 v110, 90304, v106
    v_add_u32 v106, 16384, v106
    v_add_u32 v103, 73920, v99
    v_add_u32 v111, 90304, v107
    v_add_u32 v107, 16384, v107
    s_lshl_b32 s56, s37, 9
    s_add_u32 s56, s56, 131072
    v_lshlrev_b32 v113, 4, v112
    v_add_u32 v71, s56, v113
    v_lshl_add_u32 v70, v116, 2, v71
    v_lshl_add_u32 v70, v117, 3, v70
    v_xor_b32 v70, 8, v70
    v_mul_u32_u24 v113, 192, v120
    v_mul_u32_u24 v114, 12320, v117
    v_add3_u32 v113, v113, v114, v119
    s_xor_b32 s56, s37, 0
    s_mul_i32 s56, s56, 3072
    v_add_u32 v4, s56, v113
    s_xor_b32 s56, s37, 1
    s_mul_i32 s56, s56, 3072
    v_add_u32 v5, s56, v113
    s_xor_b32 s56, s37, 2
    s_mul_i32 s56, s56, 3072
    v_add_u32 v6, s56, v113
    s_xor_b32 s56, s37, 3
    s_mul_i32 s56, s56, 3072
    v_add_u32 v7, s56, v113
    s_mul_i32 s40, s37, 3072
    s_add_u32 s40, s40, 12320
    s_mul_i32 s58, s34, 6
    s_mul_i32 s56, s37, 44032
    s_lshl_b32 s57, s58, 5
    s_add_u32 s56, s56, s57
    s_mov_b32 s57, 2560
    v_lshlrev_b32 v112, 4, v82
    v_add_u32 v0, 122880, v112
    v_add_u32 v112, s56, v112
    v_mul_u32_u24 v113, 171, v82
    v_lshrrev_b32 v114, 11, v113
    v_mad_u32_u24 v1, v114, s57, v112
    v_add_u32 v113, 10944, v113
    v_lshrrev_b32 v114, 11, v113
    v_mad_u32_u24 v2, v114, s57, v112
    v_add_u32 v113, 10944, v113
    v_lshrrev_b32 v114, 11, v113
    v_mad_u32_u24 v3, v114, s57, v112
    v_and_b32 v112, 15, v82
    v_lshlrev_b32 v113, 2, v121
    v_mov_b32 v114, 0x3f803f80
    v_cmp_eq_u32 vcc, v112, v113
    s_nop 1
    v_cndmask_b32 v12, 0, v114, vcc
    v_cndmask_b32 v13, 0, v114, vcc
    v_cndmask_b32 v14, 0, v114, vcc
    v_cndmask_b32 v15, 0, v114, vcc
    v_xor_b32 v113, s3, v113
    v_or_b32 v72, v113, v0
    s_lshl2_add_u32 s56, s33, s37
    s_mul_i32 s56, s56, 118
    s_add_u32 s57, s56, s58
    s_add_u32 s57, s57, 35
    s_lshl_b32 s52, s57, 10
    s_lshr_b32 s57, s32, 1
    s_lshl2_add_u32 s57, s34, s57
    s_mul_i32 s57, s57, 17408
    s_and_b32 s58, s32, 1
    s_add_u32 s54, s57, 12476416
    s_lshl_b32 s58, s58, 13
    s_add_u32 s53, s57, s58
    s_add_u32 s53, s53, 12460032
    s_lshl2_add_u32 s56, s34, s56
    s_add_u32 s56, s56, 2
    s_lshl_b32 s35, s56, 10
    v_lshlrev_b32 v112, 2, v82
    s_lshl_b32 s56, s32, 8
    s_lshl_b32 s57, s34, 11
    s_add_u32 s57, s57, s56
    s_add_u32 s56, s56, 158336
    v_add_u32 v92, s56, v112
    s_lshr_b32 s56, s37, 1
    s_lshl1_add_u32 s56, s33, s56
    s_lshl3_add_u32 s56, s56, s34
    s_lshl_b32 s56, s56, 7
    s_and_b32 s58, s37, 1
    s_lshl2_add_u32 s56, s58, s56
    s_add_u32 s33, s56, 13631512
    v_mov_b32 v113, 0
    v_and_b32 v114, 7, v82
    v_lshlrev_b32 v114, 4, v114
    v_and_b32 v115, 16, v82
    v_lshlrev_b32 v115, 1, v115
    v_xor_b32 v114, v114, v115
    v_lshrrev_b32 v115, 3, v82
    v_lshl_add_u32 v28, v115, 10, v114
    v_and_b32 v114, 16, v82
    v_and_b32 v115, 1, v82
    v_lshl_add_u32 v114, v115, 3, v114
    v_and_b32 v115, 14, v82
    v_lshl_add_u32 v114, v115, 5, v114
    v_and_b32 v115, 8, v82
    v_lshl_add_u32 v114, v115, 2, v114
    v_lshrrev_b32 v115, 5, v82
    v_lshl_add_u32 v114, v115, 10, v114
    v_lshl_add_u32 v114, s39, 1, v114
    v_xor_b32 v115, 32, v114
    v_add_u32 v29, 90304, v114
    v_add_u32 v30, 90304, v115
    v_lshlrev_b32 v93, 7, v82
    s_waitcnt lgkmcnt(0)
    s_add_u32 s41, s36, 1
    s_and_b32 s41, s41, 7
    s_add_u32 m0, s38, 73920
    s_lshl_b32 s42, s41, 7
    buffer_load_dwordx4 v80, s[8:11], s42 offen lds
    s_add_u32 s42, s42, 14336
    buffer_load_dwordx4 v80, s[8:11], s42 offen offset:2048 lds
    buffer_load_dword v91, v112, s[28:31], s57 offen
    s_add_u32 s41, s36, 1
    s_and_b32 s41, s41, 7
    s_add_u32 m0, s39, 90304
    s_mul_i32 s43, s41, 196608
    buffer_load_dwordx4 v81, s[12:15], s43 offen lds
    s_add_u32 s41, s36, 2
    s_and_b32 s41, s41, 7
    s_add_u32 m0, s38, 98560
    s_lshl_b32 s42, s41, 7
    buffer_load_dwordx4 v80, s[8:11], s42 offen lds
    s_add_u32 s42, s42, 14336
    buffer_load_dwordx4 v80, s[8:11], s42 offen offset:2048 lds
    s_lshr_b32 s56, s2, 3
    s_lshl2_add_u32 s56, s56, s37
    s_mul_i32 s56, s56, 12288
    v_lshlrev_b32 v112, 3, v93
    s_mov_b64 exec, 0xfff
    buffer_load_dword v75, v112, s[12:15], s56 offen offset:384
    s_mov_b64 exec, 1
    buffer_store_dword v113, off, s[24:27], s33 sc1
    s_mov_b64 exec, -1
    s_mov_b32 s0, 0xaaaaaaaa
    s_mov_b32 s1, 0xaaaaaaaa
    s_mov_b32 s28, 0xcccccccc
    s_mov_b32 s29, 0xcccccccc
    s_mov_b32 s30, 0xff00ff00
    s_mov_b32 s31, 0xff00ff00
    s_mov_b32 s16, 0xffff0000
    s_mov_b32 s17, 0xffff0000
    s_mov_b32 s18, 0xf0f0f0f
    s_mov_b32 s19, 0xf0f0f0f0
    s_waitcnt vmcnt(9)
    s_waitcnt vmcnt(8)
    s_barrier
    ds_read_b128 v[128:131], v96 offset:49280
    ds_read_b64_tr_b16 v[32:33], v104 offset:49280
    ds_read_b64_tr_b16 v[34:35], v104 offset:49792
    ds_read_b128 v[132:135], v97 offset:49280
    ds_read_b128 v[136:139], v98 offset:49280
    ds_read_b128 v[140:143], v99 offset:49280
    ds_read_b64_tr_b16 v[36:37], v105 offset:49280
    ds_read_b64_tr_b16 v[38:39], v105 offset:49792
    ds_read_b64_tr_b16 v[40:41], v106 offset:49280
    ds_read_b64_tr_b16 v[42:43], v106 offset:49792
    ds_read_b64_tr_b16 v[44:45], v107 offset:49280
    ds_read_b64_tr_b16 v[46:47], v107 offset:49792
    s_waitcnt lgkmcnt(9)
    v_mfma_f32_16x16x32_bf16 v[16:19], v[12:15], v[32:35], 0
    v_mfma_f32_32x32x16_bf16 v[48:63], v[32:35], v[128:131], 0
    v_mov_b32 v66, 0
    v_mov_b32 v67, 0
    v_lshlrev_b32 v77, 3, v93
    s_waitcnt lgkmcnt(4)
    v_mfma_f32_16x16x32_bf16 v[20:23], v[12:15], v[136:139], 0
    v_mfma_f32_32x32x16_bf16 v[48:63], v[36:39], v[132:135], v[48:63]
    s_waitcnt lgkmcnt(2)
    v_mfma_f32_16x16x32_bf16 v[20:23], v[12:15], v[140:143], v[20:23]
    v_mfma_f32_32x32x16_bf16 v[48:63], v[40:43], v[136:139], v[48:63]
    s_add_u32 s41, s36, 2
    s_and_b32 s41, s41, 7
    s_add_u32 m0, s39, 114944
    s_mul_i32 s43, s41, 196608
    buffer_load_dwordx4 v81, s[12:15], s43 offen lds
    s_add_u32 s41, s36, 3
    s_and_b32 s41, s41, 7
    s_add_u32 m0, s38, 0
    s_lshl_b32 s42, s41, 7
    buffer_load_dwordx4 v80, s[8:11], s42 offen lds
    s_add_u32 s42, s42, 14336
    buffer_load_dwordx4 v80, s[8:11], s42 offen offset:2048 lds
    s_waitcnt vmcnt(9)
    s_waitcnt vmcnt(7)
    s_waitcnt vmcnt(5)
    s_barrier
    ds_read_b128 v[144:147], v100 offset:0
    ds_read_b64_tr_b16 v[40:41], v108 offset:0
    ds_read_b64_tr_b16 v[42:43], v108 offset:512
    ds_read_b128 v[148:151], v101 offset:0
    ds_read_b128 v[152:155], v102 offset:0
    ds_read_b128 v[156:159], v103 offset:0
    s_waitcnt lgkmcnt(6)
    v_mfma_f32_32x32x16_bf16 v[48:63], v[44:47], v[140:143], v[48:63]
    s_add_u32 s41, s36, 3
    s_and_b32 s41, s41, 7
    s_add_u32 m0, s39, 16384
    s_mul_i32 s43, s41, 196608
    buffer_load_dwordx4 v81, s[12:15], s43 offen lds
    ds_read_b64_tr_b16 v[44:45], v109 offset:0
    ds_read_b64_tr_b16 v[46:47], v109 offset:512
    v_mfma_f32_32x32x16_bf16 v[112:127], v[136:139], v[136:139], 0
    s_add_u32 s41, s36, 4
    s_and_b32 s41, s41, 7
    s_add_u32 m0, s38, 24640
    s_lshl_b32 s42, s41, 7
    buffer_load_dwordx4 v80, s[8:11], s42 offen lds
    ds_read_b64_tr_b16 v[32:33], v110 offset:0
    ds_read_b64_tr_b16 v[34:35], v110 offset:512
    v_mfma_f32_32x32x16_bf16 v[112:127], v[140:143], v[140:143], v[112:127]
    s_add_u32 s42, s42, 14336
    buffer_load_dwordx4 v80, s[8:11], s42 offen offset:2048 lds
    ds_read_b64_tr_b16 v[36:37], v111 offset:0
    ds_read_b64_tr_b16 v[38:39], v111 offset:512
    s_waitcnt lgkmcnt(9)
    v_mfma_f32_16x16x32_bf16 v[16:19], v[12:15], v[40:43], v[16:19]
    v_mfma_f32_32x32x16_bf16 v[48:63], v[40:43], v[144:147], v[48:63]
    ds_read_b128 v[168:171], v102 offset:24640
    ds_read_b128 v[172:175], v103 offset:24640
    s_waitcnt lgkmcnt(6)
    v_mfma_f32_16x16x32_bf16 v[20:23], v[12:15], v[152:155], v[20:23]
    v_mfma_f32_32x32x16_bf16 v[48:63], v[44:47], v[148:151], v[48:63]
    ds_read_b128 v[160:163], v100 offset:24640
    ds_read_b128 v[164:167], v101 offset:24640
    s_waitcnt lgkmcnt(6)
    v_mfma_f32_16x16x32_bf16 v[20:23], v[12:15], v[156:159], v[20:23]
    v_mfma_f32_32x32x16_bf16 v[48:63], v[32:35], v[152:155], v[48:63]
    s_waitcnt vmcnt(5)
    s_waitcnt vmcnt(3)
    s_barrier
    ds_read_b64_tr_b16 v[32:33], v108 offset:24640
    ds_read_b64_tr_b16 v[34:35], v108 offset:25152
    s_waitcnt lgkmcnt(5)
    v_mfma_f32_16x16x32_bf16 v[20:23], v[12:15], v[168:171], v[20:23]
    v_mfma_f32_32x32x16_bf16 v[48:63], v[36:39], v[156:159], v[48:63]
    v_mov_b32 v95, s100
    s_add_u32 s41, s36, 4
    s_and_b32 s41, s41, 7
    s_add_u32 m0, s39, 41024
    s_mul_i32 s43, s41, 196608
    buffer_load_dwordx4 v81, s[12:15], s43 offen lds
    ds_write_b32 v92, v91
    ds_read_b64_tr_b16 v[36:37], v109 offset:24640
    ds_read_b64_tr_b16 v[38:39], v109 offset:25152
    s_waitcnt lgkmcnt(7)
    v_mfma_f32_16x16x32_bf16 v[20:23], v[12:15], v[172:175], v[20:23]
    v_mfma_f32_32x32x16_bf16 v[112:127], v[152:155], v[152:155], v[112:127]
    v_xor_b32 v91, 0x80008000, v91
    s_add_u32 s41, s36, 5
    s_and_b32 s41, s41, 7
    s_add_u32 m0, s38, 49280
    s_lshl_b32 s42, s41, 7
    buffer_load_dwordx4 v80, s[8:11], s42 offen lds
    ds_read_b128 v[184:187], v98 offset:0
    ds_read_b128 v[188:191], v99 offset:0
    ds_read_b64_tr_b16 v[40:41], v110 offset:24640
    ds_read_b64_tr_b16 v[42:43], v110 offset:25152
    v_mfma_f32_32x32x16_bf16 v[112:127], v[156:159], v[156:159], v[112:127]
    s_add_u32 s42, s42, 14336
    buffer_load_dwordx4 v80, s[8:11], s42 offen offset:2048 lds
    ds_read_b128 v[176:179], v96 offset:0
    ds_read_b128 v[180:183], v97 offset:0
    ds_read_b64_tr_b16 v[44:45], v111 offset:24640
    ds_read_b64_tr_b16 v[46:47], v111 offset:25152
    s_waitcnt lgkmcnt(11)
    v_mfma_f32_16x16x32_bf16 v[16:19], v[12:15], v[32:35], v[16:19]
    v_mfma_f32_32x32x16_bf16 v[48:63], v[32:35], v[160:163], v[48:63]
    ds_write_b32 v92, v91 offset:2048
    s_waitcnt lgkmcnt(8)
    v_mfma_f32_16x16x32_bf16 v[20:23], v[12:15], v[184:187], v[20:23]
    v_mfma_f32_32x32x16_bf16 v[48:63], v[36:39], v[164:167], v[48:63]
    s_waitcnt lgkmcnt(5)
    v_mfma_f32_16x16x32_bf16 v[20:23], v[12:15], v[188:191], v[20:23]
    v_mfma_f32_32x32x16_bf16 v[48:63], v[40:43], v[168:171], v[48:63]
    s_waitcnt lgkmcnt(1)
    v_mfma_f32_32x32x16_bf16 v[48:63], v[44:47], v[172:175], v[48:63]
    v_mfma_f32_32x32x16_bf16 v[112:127], v[168:171], v[168:171], v[112:127]
    s_waitcnt vmcnt(5)
    s_waitcnt vmcnt(3)
    s_barrier
    ds_read_b64_tr_b16 v[32:33], v104 offset:0
    ds_read_b64_tr_b16 v[34:35], v104 offset:512
    v_mfma_f32_32x32x16_bf16 v[112:127], v[172:175], v[172:175], v[112:127]
    s_add_u32 s41, s36, 5
    s_and_b32 s41, s41, 7
    s_add_u32 m0, s39, 65664
    s_mul_i32 s43, s41, 196608
    buffer_load_dwordx4 v81, s[12:15], s43 offen lds
    ds_read_b64_tr_b16 v[36:37], v105 offset:0
    ds_read_b64_tr_b16 v[38:39], v105 offset:512
    v_mfma_f32_32x32x16_bf16 v[112:127], v[184:187], v[184:187], v[112:127]
    s_add_u32 s41, s36, 6
    s_and_b32 s41, s41, 7
    s_add_u32 m0, s38, 73920
    s_lshl_b32 s42, s41, 7
    buffer_load_dwordx4 v80, s[8:11], s42 offen lds
    ds_read_b128 v[200:203], v98 offset:24640
    ds_read_b128 v[204:207], v99 offset:24640
    ds_read_b64_tr_b16 v[40:41], v106 offset:0
    ds_read_b64_tr_b16 v[42:43], v106 offset:512
    v_mfma_f32_32x32x16_bf16 v[112:127], v[188:191], v[188:191], v[112:127]
    s_add_u32 s42, s42, 14336
    buffer_load_dwordx4 v80, s[8:11], s42 offen offset:2048 lds
    ds_read_b128 v[192:195], v96 offset:24640
    ds_read_b128 v[196:199], v97 offset:24640
    ds_read_b64_tr_b16 v[44:45], v107 offset:0
    ds_read_b64_tr_b16 v[46:47], v107 offset:512
    s_waitcnt lgkmcnt(10)
    v_mfma_f32_16x16x32_bf16 v[16:19], v[12:15], v[32:35], v[16:19]
    v_mfma_f32_32x32x16_bf16 v[48:63], v[32:35], v[176:179], v[48:63]
    s_waitcnt lgkmcnt(7)
    v_mfma_f32_16x16x32_bf16 v[20:23], v[12:15], v[200:203], v[20:23]
    v_mfma_f32_32x32x16_bf16 v[48:63], v[36:39], v[180:183], v[48:63]
    s_waitcnt lgkmcnt(4)
    v_mfma_f32_16x16x32_bf16 v[20:23], v[12:15], v[204:207], v[20:23]
    v_mfma_f32_32x32x16_bf16 v[48:63], v[40:43], v[184:187], v[48:63]
    s_waitcnt vmcnt(5)
    s_waitcnt vmcnt(3)
    s_barrier
    ds_read_b64_tr_b16 v[40:41], v104 offset:24640
    ds_read_b64_tr_b16 v[42:43], v104 offset:25152
    s_waitcnt lgkmcnt(2)
    v_mfma_f32_32x32x16_bf16 v[48:63], v[44:47], v[188:191], v[48:63]
    s_add_u32 s41, s36, 6
    s_and_b32 s41, s41, 7
    s_add_u32 m0, s39, 90304
    s_mul_i32 s43, s41, 196608
    buffer_load_dwordx4 v81, s[12:15], s43 offen lds
    ds_read_b64_tr_b16 v[44:45], v105 offset:24640
    ds_read_b64_tr_b16 v[46:47], v105 offset:25152
    v_mfma_f32_32x32x16_bf16 v[112:127], v[200:203], v[200:203], v[112:127]
    s_add_u32 s41, s36, 7
    s_and_b32 s41, s41, 7
    s_add_u32 m0, s38, 98560
    s_lshl_b32 s42, s41, 7
    buffer_load_dwordx4 v80, s[8:11], s42 offen lds
    ds_read_b128 v[216:219], v98 offset:49280
    ds_read_b128 v[220:223], v99 offset:49280
    ds_read_b64_tr_b16 v[32:33], v106 offset:24640
    ds_read_b64_tr_b16 v[34:35], v106 offset:25152
    v_mfma_f32_32x32x16_bf16 v[112:127], v[204:207], v[204:207], v[112:127]
    s_add_u32 s42, s42, 14336
    buffer_load_dwordx4 v80, s[8:11], s42 offen offset:2048 lds
    ds_read_b128 v[208:211], v96 offset:49280
    ds_read_b128 v[212:215], v97 offset:49280
    ds_read_b64_tr_b16 v[36:37], v107 offset:24640
    ds_read_b64_tr_b16 v[38:39], v107 offset:25152
    s_waitcnt lgkmcnt(10)
    v_mfma_f32_16x16x32_bf16 v[16:19], v[12:15], v[40:43], v[16:19]
    v_mfma_f32_32x32x16_bf16 v[48:63], v[40:43], v[192:195], v[48:63]
    s_waitcnt lgkmcnt(7)
    v_mfma_f32_16x16x32_bf16 v[20:23], v[12:15], v[216:219], v[20:23]
    v_mfma_f32_32x32x16_bf16 v[48:63], v[44:47], v[196:199], v[48:63]
    s_waitcnt lgkmcnt(4)
    v_mfma_f32_16x16x32_bf16 v[20:23], v[12:15], v[220:223], v[20:23]
    v_mfma_f32_32x32x16_bf16 v[48:63], v[32:35], v[200:203], v[48:63]
    s_waitcnt vmcnt(5)
    s_waitcnt vmcnt(3)
    s_barrier
    ds_read_b64_tr_b16 v[32:33], v104 offset:49280
    ds_read_b64_tr_b16 v[34:35], v104 offset:49792
    s_waitcnt lgkmcnt(2)
    v_mfma_f32_32x32x16_bf16 v[48:63], v[36:39], v[204:207], v[48:63]
    s_add_u32 s41, s36, 7
    s_and_b32 s41, s41, 7
    s_add_u32 m0, s39, 114944
    s_mul_i32 s43, s41, 196608
    buffer_load_dwordx4 v81, s[12:15], s43 offen lds
    s_mov_b32 s12, s46
    s_mov_b32 s13, s47
    s_mov_b32 s14, 2097152
    s_mov_b32 s46, 524288
    s_mov_b32 s47, 0x20000
    ds_read_b64_tr_b16 v[36:37], v105 offset:49280
    ds_read_b64_tr_b16 v[38:39], v105 offset:49792
    v_mfma_f32_32x32x16_bf16 v[112:127], v[216:219], v[216:219], v[112:127]
    s_add_u32 s41, s36, 8
    s_and_b32 s41, s41, 7
    s_add_u32 m0, s40, 0
    s_mul_i32 s43, s41, 176128
    buffer_load_dwordx4 v1, s[20:23], s43 offen lds
    ds_read_b128 v[232:235], v102 offset:0
    ds_read_b128 v[236:239], v103 offset:0
    ds_read_b64_tr_b16 v[40:41], v106 offset:49280
    ds_read_b64_tr_b16 v[42:43], v106 offset:49792
    v_mfma_f32_32x32x16_bf16 v[112:127], v[220:223], v[220:223], v[112:127]
    buffer_load_dwordx4 v2, s[20:23], s43 offen offset:1024 lds
    ds_read_b128 v[224:227], v100 offset:0
    ds_read_b128 v[228:231], v101 offset:0
    ds_read_b64_tr_b16 v[44:45], v107 offset:49280
    ds_read_b64_tr_b16 v[46:47], v107 offset:49792
    s_waitcnt lgkmcnt(10)
    v_mfma_f32_16x16x32_bf16 v[16:19], v[12:15], v[32:35], v[16:19]
    v_mfma_f32_32x32x16_bf16 v[48:63], v[32:35], v[208:211], v[48:63]
    s_waitcnt lgkmcnt(7)
    v_mfma_f32_16x16x32_bf16 v[20:23], v[12:15], v[232:235], v[20:23]
    v_mfma_f32_32x32x16_bf16 v[48:63], v[36:39], v[212:215], v[48:63]
    s_waitcnt lgkmcnt(4)
    v_mfma_f32_16x16x32_bf16 v[20:23], v[12:15], v[236:239], v[20:23]
    v_mfma_f32_32x32x16_bf16 v[48:63], v[40:43], v[216:219], v[48:63]
    s_waitcnt vmcnt(5)
    s_waitcnt vmcnt(3)
    s_barrier
    ds_read_b64_tr_b16 v[40:41], v108 offset:0
    ds_read_b64_tr_b16 v[42:43], v108 offset:512
    s_waitcnt lgkmcnt(2)
    v_mfma_f32_32x32x16_bf16 v[48:63], v[44:47], v[220:223], v[48:63]
    s_cmp_eq_u32 s37, 0
    s_cselect_b32 exec_lo, 1, 0
    s_mov_b32 exec_hi, 0
    s_and_b32 s59, s2, 7
    s_lshl_b32 s59, s59, 5
    buffer_atomic_add v95, off, s[4:7], s59 sc1
    s_mov_b64 exec, -1
    v_mfma_f32_32x32x16_bf16 v[112:127], v[232:235], v[232:235], v[112:127]
    buffer_load_dwordx4 v3, s[20:23], s43 offen offset:2048 lds
    ds_read_b128 v[248:251], v102 offset:24640
    ds_read_b128 v[252:255], v103 offset:24640
    v_mfma_f32_32x32x16_bf16 v[112:127], v[236:239], v[236:239], v[112:127]
    ds_read_b128 v[240:243], v100 offset:24640
    ds_read_b128 v[244:247], v101 offset:24640
    s_lshl3_add_u32 s56, s2, s32
    s_sub_u32 s56, s56, 1024
    s_lshl_b32 s57, s56, 9
    s_mov_b64 exec, 15
    buffer_load_dword v26, v93, s[44:47], s57 offen
    s_mov_b64 exec, -1
    ds_read_b64_tr_b16 v[36:37], v109 offset:0
    ds_read_b64_tr_b16 v[38:39], v109 offset:512
    s_waitcnt lgkmcnt(6)
    v_mfma_f32_16x16x32_bf16 v[16:19], v[12:15], v[40:43], v[16:19]
    v_mfma_f32_32x32x16_bf16 v[48:63], v[40:43], v[224:227], v[48:63]
    s_add_u32 s41, s36, 9
    s_and_b32 s41, s41, 7
    s_add_u32 m0, s40, 24640
    s_mul_i32 s43, s41, 176128
    buffer_load_dwordx4 v1, s[20:23], s43 offen lds
    ds_read_b64_tr_b16 v[40:41], v110 offset:0
    ds_read_b64_tr_b16 v[42:43], v110 offset:512
    s_waitcnt lgkmcnt(7)
    v_mfma_f32_16x16x32_bf16 v[20:23], v[12:15], v[248:251], v[20:23]
    v_mfma_f32_32x32x16_bf16 v[112:127], v[248:251], v[248:251], v[112:127]
    buffer_load_dwordx4 v2, s[20:23], s43 offen offset:1024 lds
    ds_read_b64_tr_b16 v[44:45], v111 offset:0
    ds_read_b64_tr_b16 v[46:47], v111 offset:512
    s_waitcnt lgkmcnt(8)
    v_mfma_f32_16x16x32_bf16 v[20:23], v[12:15], v[252:255], v[20:23]
    v_mfma_f32_32x32x16_bf16 v[112:127], v[252:255], v[252:255], v[112:127]
    s_mul_i32 s57, s56, 1408
    s_mov_b64 exec, 0x7ff
    buffer_load_dword v31, v93, s[48:51], s57 offen
    s_mov_b64 exec, -1
    s_waitcnt vmcnt(8)
    s_barrier
    ds_read_b64_tr_b16 v[32:33], v108 offset:24640
    ds_read_b64_tr_b16 v[34:35], v108 offset:25152
    s_waitcnt lgkmcnt(6)
    v_mfma_f32_32x32x16_bf16 v[48:63], v[36:39], v[228:231], v[48:63]
    v_mov_b32 v64, v20
    buffer_load_dwordx4 v3, s[20:23], s43 offen offset:2048 lds
    ds_read_b64_tr_b16 v[36:37], v109 offset:24640
    ds_read_b64_tr_b16 v[38:39], v109 offset:25152
    s_waitcnt lgkmcnt(6)
    v_mfma_f32_32x32x16_bf16 v[48:63], v[40:43], v[232:235], v[48:63]
    v_cndmask_b32 v112, v112, v113, s[0:1]
    v_cndmask_b32 v114, v114, v115, s[0:1]
    v_cndmask_b32 v116, v116, v117, s[0:1]
    v_cndmask_b32 v118, v118, v119, s[0:1]
    ds_read_b64_tr_b16 v[40:41], v110 offset:24640
    ds_read_b64_tr_b16 v[42:43], v110 offset:25152
    s_waitcnt lgkmcnt(6)
    v_mfma_f32_32x32x16_bf16 v[48:63], v[44:47], v[236:239], v[48:63]
    v_cndmask_b32 v120, v120, v121, s[0:1]
    v_cndmask_b32 v122, v122, v123, s[0:1]
    v_cndmask_b32 v124, v124, v125, s[0:1]
    v_cndmask_b32 v126, v126, v127, s[0:1]
    s_add_u32 s41, s36, 10
    s_and_b32 s41, s41, 7
    s_add_u32 m0, s40, 49280
    s_mul_i32 s43, s41, 176128
    buffer_load_dwordx4 v1, s[20:23], s43 offen lds
    ds_read_b64_tr_b16 v[44:45], v111 offset:24640
    ds_read_b64_tr_b16 v[46:47], v111 offset:25152
    s_waitcnt lgkmcnt(6)
    v_mfma_f32_16x16x32_bf16 v[16:19], v[12:15], v[32:35], v[16:19]
    v_mfma_f32_32x32x16_bf16 v[48:63], v[32:35], v[240:243], v[48:63]
    v_cndmask_b32 v112, v112, v114, s[28:29]
    v_cndmask_b32 v116, v116, v118, s[28:29]
    v_cndmask_b32 v120, v120, v122, s[28:29]
    v_cndmask_b32 v124, v124, v126, s[28:29]
    buffer_load_dwordx4 v2, s[20:23], s43 offen offset:1024 lds
    s_waitcnt vmcnt(7)
    s_barrier
    ds_read_b64_tr_b16 v[32:33], v4 offset:96
    ds_read_b64_tr_b16 v[34:35], v4 offset:864
    s_waitcnt lgkmcnt(6)
    v_mfma_f32_32x32x16_bf16 v[48:63], v[36:39], v[244:247], v[48:63]
    v_and_b32 v73, s55, v16
    v_sub_f32 v74, v16, v73
    v_cvt_pk_bf16_f32 v73, v73, v74
    v_cndmask_b32 v112, v112, v116, s[30:31]
    v_cndmask_b32 v120, v120, v124, s[30:31]
    v_cndmask_b32 v112, v112, v120, s[16:17]
    ds_write_b32 v72, v73 offset:34432
    ds_read_b64_tr_b16 v[36:37], v4 offset:128
    ds_read_b64_tr_b16 v[38:39], v4 offset:896
    s_waitcnt lgkmcnt(7)
    v_mfma_f32_32x32x16_bf16 v[48:63], v[40:43], v[248:251], v[48:63]
    v_cndmask_b32 v65, 0, v112, s[18:19]
    s_nop 1
    v_permlane32_swap_b32 v64, v65
    v_add_f32 v64, v64, v65
    v_mov_b32 v65, 0
    buffer_load_dwordx4 v3, s[20:23], s43 offen offset:2048 lds
    ds_write_b32 v70, v64
    ds_read_b64_tr_b16 v[40:41], v4 offset:160
    ds_read_b64_tr_b16 v[42:43], v4 offset:928
    s_waitcnt lgkmcnt(8)
    v_mfma_f32_32x32x16_bf16 v[48:63], v[44:47], v[252:255], v[48:63]
    v_mov_b32 v64, 0
    ds_read_b64_tr_b16 v[44:45], v5 offset:96
    ds_read_b64_tr_b16 v[46:47], v5 offset:864
    s_waitcnt lgkmcnt(8)
    v_mfma_f32_16x16x32_bf16 v[16:19], v[12:15], v[32:35], 0
    v_mfma_f32_32x32x16_bf16 v[80:95], v[32:35], v[128:131], 0
    ds_read_b64_tr_b16 v[32:33], v5 offset:128
    ds_read_b64_tr_b16 v[34:35], v5 offset:896
    s_waitcnt lgkmcnt(7)
    s_nop 3
    v_mfma_f32_16x16x32_bf16 v[18:21], v[12:15], v[36:39], 0
    v_mfma_f32_32x32x16_bf16 v[96:111], v[36:39], v[128:131], 0
    s_add_u32 s41, s36, 11
    s_and_b32 s41, s41, 7
    s_add_u32 m0, s40, 73920
    s_mul_i32 s43, s41, 176128
    buffer_load_dwordx4 v1, s[20:23], s43 offen lds
    ds_read_b64_tr_b16 v[36:37], v5 offset:160
    ds_read_b64_tr_b16 v[38:39], v5 offset:928
    s_waitcnt lgkmcnt(6)
    v_mfma_f32_16x16x32_bf16 v[20:23], v[12:15], v[40:43], 0
    v_mfma_f32_32x32x16_bf16 v[112:127], v[40:43], v[128:131], 0
    buffer_store_dwordx4 v[64:67], v0, s[24:27], s52 offen offset:0
    ds_read_b64_tr_b16 v[40:41], v6 offset:96
    ds_read_b64_tr_b16 v[42:43], v6 offset:864
    s_waitcnt lgkmcnt(6)
    v_mfma_f32_32x32x16_bf16 v[80:95], v[44:47], v[132:135], v[80:95]
    buffer_store_dwordx4 v[64:67], v0, s[24:27], s52 offen offset:1024
    ds_read_b64_tr_b16 v[44:45], v6 offset:128
    ds_read_b64_tr_b16 v[46:47], v6 offset:896
    s_waitcnt lgkmcnt(6)
    v_mfma_f32_32x32x16_bf16 v[96:111], v[32:35], v[132:135], v[96:111]
    buffer_load_dwordx4 v2, s[20:23], s43 offen offset:1024 lds
    ds_read_b64_tr_b16 v[32:33], v6 offset:160
    ds_read_b64_tr_b16 v[34:35], v6 offset:928
    s_waitcnt lgkmcnt(6)
    v_mfma_f32_32x32x16_bf16 v[112:127], v[36:39], v[132:135], v[112:127]
    buffer_store_dwordx4 v[64:67], v0, s[24:27], s52 offen offset:2048
    ds_read_b64_tr_b16 v[36:37], v7 offset:96
    ds_read_b64_tr_b16 v[38:39], v7 offset:864
    s_waitcnt lgkmcnt(6)
    v_mfma_f32_32x32x16_bf16 v[80:95], v[40:43], v[136:139], v[80:95]
    buffer_store_dwordx4 v[64:67], v0, s[24:27], s35 offen offset:0
    ds_read_b64_tr_b16 v[40:41], v7 offset:128
    ds_read_b64_tr_b16 v[42:43], v7 offset:896
    s_waitcnt lgkmcnt(6)
    v_mfma_f32_32x32x16_bf16 v[96:111], v[44:47], v[136:139], v[96:111]
    buffer_load_dwordx4 v3, s[20:23], s43 offen offset:2048 lds
    ds_read_b64_tr_b16 v[44:45], v7 offset:160
    ds_read_b64_tr_b16 v[46:47], v7 offset:928
    s_waitcnt lgkmcnt(6)
    v_mfma_f32_32x32x16_bf16 v[112:127], v[32:35], v[136:139], v[112:127]
    buffer_store_dwordx4 v[64:67], v0, s[24:27], s35 offen offset:1024
    s_waitcnt vmcnt(11)
    s_barrier
    ds_read_b128 v[8:11], v71
    ds_read_b64_tr_b16 v[32:33], v4 offset:24736
    ds_read_b64_tr_b16 v[34:35], v4 offset:25504
    s_waitcnt lgkmcnt(7)
    v_mfma_f32_32x32x16_bf16 v[80:95], v[36:39], v[140:143], v[80:95]
    ds_read_b128 v[36:39], v0 offset:34432
    s_waitcnt lgkmcnt(6)
    v_mfma_f32_32x32x16_bf16 v[96:111], v[40:43], v[140:143], v[96:111]
    ds_read_b64_tr_b16 v[40:41], v4 offset:24768
    ds_read_b64_tr_b16 v[42:43], v4 offset:25536
    s_waitcnt lgkmcnt(5)
    v_mfma_f32_32x32x16_bf16 v[112:127], v[44:47], v[140:143], v[112:127]
    v_add_f32 v8, v8, v10
    v_add_f32 v24, v9, v11
    v_mul_f32 v25, 0xbb000000, v8
    v_mul_f32 v24, 0x3b000000, v24
    v_cvt_pk_bf16_f32 v8, v25, v25
    v_cvt_pk_bf16_f32 v9, v25, v25
    s_add_u32 s41, s36, 12
    s_and_b32 s41, s41, 7
    s_add_u32 m0, s40, 98560
    s_mul_i32 s43, s41, 176128
    buffer_load_dwordx4 v1, s[20:23], s43 offen lds
    ds_read_b64_tr_b16 v[44:45], v4 offset:24800
    ds_read_b64_tr_b16 v[46:47], v4 offset:25568
    s_waitcnt lgkmcnt(5)
    v_mfma_f32_16x16x32_bf16 v[16:19], v[12:15], v[32:35], v[16:19]
    v_mfma_f32_32x32x16_bf16 v[80:95], v[32:35], v[144:147], v[80:95]
    v_cvt_pk_bf16_f32 v10, v25, v25
    v_cvt_pk_bf16_f32 v11, v25, v25
    v_fma_f32 v24, -v25, v25, v24
    v_max_f32 v24, 0, v24
    v_add_f32 v24, 0x3727c5ac, v24
    ds_read_b64_tr_b16 v[32:33], v5 offset:24736
    ds_read_b64_tr_b16 v[34:35], v5 offset:25504
    s_waitcnt lgkmcnt(6)
    v_mfma_f32_32x32x16_bf16 v[48:63], v[36:39], v[8:11], v[48:63]
    v_rsq_f32 v26, v24
    s_nop 0
    v_mul_f32 v25, v24, v26
    v_mul_f32 v24, 0xbfb8aa3b, v26
    ds_read_b64_tr_b16 v[36:37], v5 offset:24768
    ds_read_b64_tr_b16 v[38:39], v5 offset:25536
    s_waitcnt lgkmcnt(6)
    v_mfma_f32_16x16x32_bf16 v[18:21], v[12:15], v[40:43], v[18:21]
    v_mfma_f32_32x32x16_bf16 v[96:111], v[40:43], v[144:147], v[96:111]
    ds_read_b64_tr_b16 v[40:41], v5 offset:24800
    ds_read_b64_tr_b16 v[42:43], v5 offset:25568
    s_waitcnt lgkmcnt(6)
    s_nop 1
    v_mfma_f32_16x16x32_bf16 v[20:23], v[12:15], v[44:47], v[20:23]
    v_mfma_f32_32x32x16_bf16 v[112:127], v[44:47], v[144:147], v[112:127]
    v_cvt_pk_bf16_f32 v48, v48, v49
    v_cvt_pk_bf16_f32 v49, v50, v51
    v_cvt_pk_bf16_f32 v50, v52, v53
    v_cvt_pk_bf16_f32 v51, v54, v55
    v_cvt_pk_bf16_f32 v52, v56, v57
    v_cvt_pk_bf16_f32 v53, v58, v59
    ds_read_b64_tr_b16 v[44:45], v6 offset:24736
    ds_read_b64_tr_b16 v[46:47], v6 offset:25504
    s_waitcnt lgkmcnt(6)
    v_mfma_f32_32x32x16_bf16 v[80:95], v[32:35], v[148:151], v[80:95]
    v_cvt_pk_bf16_f32 v54, v60, v61
    v_cvt_pk_bf16_f32 v55, v62, v63
    s_add_u32 m0, s40, 98560
    s_nop 0
    buffer_load_dwordx4 v2, s[20:23], s43 offen offset:1024 lds
    ds_read_b64_tr_b16 v[32:33], v6 offset:24768
    ds_read_b64_tr_b16 v[34:35], v6 offset:25536
    s_waitcnt lgkmcnt(6)
    v_mfma_f32_32x32x16_bf16 v[96:111], v[36:39], v[148:151], v[96:111]
    s_and_b32 s56, s2, 0x78
    s_add_u32 s56, s56, s32
    s_mul_i32 s57, s56, 11264
    s_mov_b64 exec, 0x7ff
    buffer_load_dword v79, v77, s[48:51], s57 offen offset:384
    s_lshl_b32 s57, s56, 12
    s_mov_b64 exec, 15
    buffer_load_dword v78, v77, s[44:47], s57 offen offset:384
    s_mov_b64 exec, -1
    s_and_b32 s56, s2, 0x38
    s_cmp_eq_u32 s56, 24
    s_cselect_b32 s58, 0xa0, 0
    s_xor_b32 s58, s58, s2
    s_and_b32 s56, s2, 7
    s_lshr_b32 s57, s58, 6
    s_lshl2_add_u32 s56, s56, s57
    s_bfe_u32 s57, s58, 0x30003
    s_lshl_b32 s57, s57, 7
    s_lshl3_add_u32 s31, s56, s32
    s_lshl_b32 s31, s31, 7
    s_add_u32 s31, s31, 13631488
    s_lshl_b32 s0, s56, 16
    s_add_u32 s0, s0, s57
    s_lshl_b32 s58, s37, 13
    s_add_u32 s0, s0, s58
    s_add_u32 s0, s0, 32768
    s_mul_i32 s29, s56, 241664
    s_mul_i32 s58, s32, 6144
    s_add_u32 s28, s29, s58
    s_add_u32 s28, s28, 32768
    s_mul_i32 s58, s32, 5
    s_min_u32 s58, s58, 33
    s_add_u32 s58, s58, 48
    s_lshl_b32 s18, s58, 14
    s_add_u32 s18, s18, s57
    s_lshl_b32 s58, s58, 10
    s_add_u32 s30, s29, s58
    s_add_u32 s30, s30, 32768
    s_lshl_b32 s58, s32, 12
    s_add_u32 s29, s29, s58
    s_mul_i32 s16, s32, 98304
    s_add_u32 s16, s16, s57
    s_lshl_b32 s17, s32, 16
    s_add_u32 s17, s17, s57
    s_cmp_eq_u32 s32, 7
    s_cselect_b32 s19, 0x2000000, s18
    s_cmp_lt_u32 s37, 2
    s_cselect_b32 s1, 0, 16512
    s_lshl_b32 s58, s37, 14
    s_add_u32 s1, s1, s58
    s_add_u32 s1, s1, 73920
    s_sub_u32 s1, s1, 122880
    s_lshr_b32 s56, s32, 1
    s_lshl_b32 s56, s56, 11
    s_and_b32 s58, s32, 1
    s_lshl_b32 s58, s58, 5
    s_add_u32 s58, s58, s56
    s_add_u32 s58, s58, 106688
    s_sub_u32 s56, s56, 16192
    ds_read_b64_tr_b16 v[36:37], v6 offset:24800
    ds_read_b64_tr_b16 v[38:39], v6 offset:25568
    s_waitcnt lgkmcnt(6)
    v_mfma_f32_32x32x16_bf16 v[112:127], v[40:43], v[148:151], v[112:127]
    ds_read_b64_tr_b16 v[40:41], v7 offset:24736
    ds_read_b64_tr_b16 v[42:43], v7 offset:25504
    s_waitcnt lgkmcnt(6)
    v_mfma_f32_32x32x16_bf16 v[80:95], v[44:47], v[152:155], v[80:95]
    ds_read_b64_tr_b16 v[44:45], v7 offset:24768
    ds_read_b64_tr_b16 v[46:47], v7 offset:25536
    s_waitcnt lgkmcnt(6)
    v_mfma_f32_32x32x16_bf16 v[96:111], v[32:35], v[152:155], v[96:111]
    s_add_u32 m0, s40, 98560
    s_nop 0
    buffer_load_dwordx4 v3, s[20:23], s43 offen offset:2048 lds
    ds_read_b64_tr_b16 v[32:33], v7 offset:24800
    ds_read_b64_tr_b16 v[34:35], v7 offset:25568
    s_waitcnt lgkmcnt(6)
    v_mfma_f32_32x32x16_bf16 v[112:127], v[36:39], v[152:155], v[112:127]
    ds_read_b64_tr_b16 v[36:37], v27 offset:0
    ds_read_b64_tr_b16 v[38:39], v27 offset:128
    s_waitcnt lgkmcnt(6)
    v_mfma_f32_32x32x16_bf16 v[80:95], v[40:43], v[156:159], v[80:95]
    s_waitcnt vmcnt(13)
    s_barrier
    ds_read_b64_tr_b16 v[40:41], v4 offset:49376
    ds_read_b64_tr_b16 v[42:43], v4 offset:50144
    s_waitcnt lgkmcnt(6)
    v_mfma_f32_32x32x16_bf16 v[96:111], v[44:47], v[156:159], v[96:111]
    s_lshl1_add_u32 m0, s39, 123200
    s_add_u32 s42, s16, 0
    buffer_load_dwordx4 v28, s[48:51], s42 offen lds
    ds_read_b64_tr_b16 v[44:45], v4 offset:49408
    ds_read_b64_tr_b16 v[46:47], v4 offset:50176
    s_waitcnt lgkmcnt(6)
    v_mfma_f32_32x32x16_bf16 v[112:127], v[32:35], v[156:159], v[112:127]
    s_lshl1_add_u32 m0, s39, 123200
    s_add_u32 s42, s16, 7168
    buffer_load_dwordx4 v28, s[48:51], s42 offen offset:1024 lds
    ds_read_b64_tr_b16 v[32:33], v4 offset:49440
    ds_read_b64_tr_b16 v[34:35], v4 offset:50208
    s_waitcnt vmcnt(3) lgkmcnt(6)
    v_mfma_f32_32x32x16_bf16 v[64:79], v[36:39], v[48:51], 0
    v_add_u32 v4, 73920, v4
    s_add_u32 s41, s36, 13
    s_and_b32 s41, s41, 7
    s_add_u32 m0, s40, 0
    s_mul_i32 s43, s41, 176128
    buffer_load_dwordx4 v1, s[20:23], s43 offen lds
    ds_read_b64_tr_b16 v[36:37], v5 offset:49376
    ds_read_b64_tr_b16 v[38:39], v5 offset:50144
    s_waitcnt lgkmcnt(6)
    v_mfma_f32_16x16x32_bf16 v[16:19], v[12:15], v[40:43], v[16:19]
    v_mfma_f32_32x32x16_bf16 v[80:95], v[40:43], v[160:163], v[80:95]
    s_lshl1_add_u32 m0, s39, 139584
    s_add_u32 s42, s16, 49152
    buffer_load_dwordx4 v28, s[48:51], s42 offen lds
    ds_read_b64_tr_b16 v[40:41], v5 offset:49408
    ds_read_b64_tr_b16 v[42:43], v5 offset:50176
    s_waitcnt lgkmcnt(6)
    v_mfma_f32_16x16x32_bf16 v[18:21], v[12:15], v[44:47], v[18:21]
    v_mfma_f32_32x32x16_bf16 v[96:111], v[44:47], v[160:163], v[96:111]
    v_max_f32 v26, v64, v65
    v_max_f32 v31, v66, v67
    v_max3_f32 v26, v26, v68, v69
    v_max3_f32 v31, v31, v70, v71
    v_max3_f32 v26, v26, v72, v73
    v_max3_f32 v31, v31, v74, v75
    s_lshl1_add_u32 m0, s39, 139584
    s_add_u32 s42, s16, 56320
    buffer_load_dwordx4 v28, s[48:51], s42 offen offset:1024 lds
    ds_read_b64_tr_b16 v[44:45], v5 offset:49440
    ds_read_b64_tr_b16 v[46:47], v5 offset:50208
    s_waitcnt lgkmcnt(6)
    v_mfma_f32_16x16x32_bf16 v[20:23], v[12:15], v[32:35], v[20:23]
    v_mfma_f32_32x32x16_bf16 v[112:127], v[32:35], v[160:163], v[112:127]
    v_add_u32 v5, 73920, v5
    v_max3_f32 v26, v26, v76, v77
    v_max3_f32 v31, v31, v78, v79
    v_max_f32 v26, v26, v31
    v_mul_f32 v26, v26, v24
    ds_read_b64_tr_b16 v[32:33], v6 offset:49376
    ds_read_b64_tr_b16 v[34:35], v6 offset:50144
    s_waitcnt lgkmcnt(6)
    v_mfma_f32_32x32x16_bf16 v[80:95], v[36:39], v[164:167], v[80:95]
    v_fma_f32 v64, v64, -v24, v26
    v_fma_f32 v65, v65, -v24, v26
    v_fma_f32 v66, v66, -v24, v26
    v_fma_f32 v67, v67, -v24, v26
    s_add_u32 m0, s40, 0
    s_nop 0
    buffer_load_dwordx4 v2, s[20:23], s43 offen offset:1024 lds
    ds_read_b64_tr_b16 v[36:37], v6 offset:49408
    ds_read_b64_tr_b16 v[38:39], v6 offset:50176
    s_waitcnt lgkmcnt(6)
    v_mfma_f32_32x32x16_bf16 v[96:111], v[40:43], v[164:167], v[96:111]
    v_exp_f32 v64, v64
    v_fma_f32 v68, v68, -v24, v26
    v_fma_f32 v69, v69, -v24, v26
    v_fma_f32 v70, v70, -v24, v26
    v_fma_f32 v71, v71, -v24, v26
    ds_read_b64_tr_b16 v[40:41], v6 offset:49440
    ds_read_b64_tr_b16 v[42:43], v6 offset:50208
    s_waitcnt lgkmcnt(6)
    v_mfma_f32_32x32x16_bf16 v[112:127], v[44:47], v[164:167], v[112:127]
    v_add_u32 v6, 73920, v6
    v_exp_f32 v65, v65
    v_fma_f32 v72, v72, -v24, v26
    v_fma_f32 v73, v73, -v24, v26
    v_fma_f32 v74, v74, -v24, v26
    ds_read_b64_tr_b16 v[44:45], v7 offset:49376
    ds_read_b64_tr_b16 v[46:47], v7 offset:50144
    s_waitcnt lgkmcnt(6)
    v_mfma_f32_32x32x16_bf16 v[80:95], v[32:35], v[168:171], v[80:95]
    v_exp_f32 v66, v66
    v_fma_f32 v75, v75, -v24, v26
    v_fma_f32 v76, v76, -v24, v26
    v_fma_f32 v77, v77, -v24, v26
    v_fma_f32 v78, v78, -v24, v26
    ds_read_b64_tr_b16 v[32:33], v7 offset:49408
    ds_read_b64_tr_b16 v[34:35], v7 offset:50176
    s_waitcnt lgkmcnt(6)
    v_mfma_f32_32x32x16_bf16 v[96:111], v[36:39], v[168:171], v[96:111]
    v_add_f32 v31, v64, v65
    v_exp_f32 v67, v67
    v_fma_f32 v79, v79, -v24, v26
    v_add_f32 v31, v31, v66
    v_add_f32 v31, v31, v67
    s_add_u32 m0, s40, 0
    s_nop 0
    buffer_load_dwordx4 v3, s[20:23], s43 offen offset:2048 lds
    ds_read_b64_tr_b16 v[36:37], v7 offset:49440
    ds_read_b64_tr_b16 v[38:39], v7 offset:50208
    s_waitcnt lgkmcnt(6)
    v_mfma_f32_32x32x16_bf16 v[112:127], v[40:43], v[168:171], v[112:127]
    s_waitcnt vmcnt(5)
    ds_read_b64_tr_b16 v[128:129], v29 offset:32896
    ds_read_b64_tr_b16 v[130:131], v29 offset:33408
    ds_read_b64_tr_b16 v[132:133], v30 offset:32896
    ds_read_b64_tr_b16 v[134:135], v30 offset:33408
    s_barrier
    ds_read_b64_tr_b16 v[40:41], v4 offset:96
    ds_read_b64_tr_b16 v[42:43], v4 offset:864
    s_waitcnt lgkmcnt(10)
    v_mfma_f32_32x32x16_bf16 v[80:95], v[44:47], v[172:175], v[80:95]
    v_add_u32 v7, 73920, v7
    v_exp_f32 v68, v68
    v_exp_f32 v69, v69
    v_add_f32 v31, v31, v68
    ds_read_b64_tr_b16 v[44:45], v4 offset:128
    ds_read_b64_tr_b16 v[46:47], v4 offset:896
    s_waitcnt lgkmcnt(10)
    v_mfma_f32_32x32x16_bf16 v[96:111], v[32:35], v[172:175], v[96:111]
    v_exp_f32 v70, v70
    v_add_f32 v31, v31, v69
    v_exp_f32 v71, v71
    v_add_f32 v31, v31, v70
    s_waitcnt lgkmcnt(4)
    s_lshl1_add_u32 m0, s39, 123200
    s_add_u32 s42, s16, 16384
    buffer_load_dwordx4 v28, s[48:51], s42 offen lds
    ds_read_b64_tr_b16 v[32:33], v4 offset:160
    ds_read_b64_tr_b16 v[34:35], v4 offset:928
    v_mfma_f32_32x32x16_bf16 v[112:127], v[36:39], v[172:175], v[112:127]
    v_exp_f32 v72, v72
    v_add_f32 v31, v31, v71
    v_exp_f32 v73, v73
    v_add_f32 v31, v31, v72
    s_add_u32 s41, s36, 14
    s_and_b32 s41, s41, 7
    s_add_u32 m0, s40, 24640
    s_mul_i32 s43, s41, 176128
    buffer_load_dwordx4 v1, s[20:23], s43 offen lds
    s_waitcnt vmcnt(4)
    ds_read_b64_tr_b16 v[136:137], v29 offset:49280
    ds_read_b64_tr_b16 v[138:139], v29 offset:49792
    ds_read_b64_tr_b16 v[140:141], v30 offset:49280
    ds_read_b64_tr_b16 v[142:143], v30 offset:49792
    ds_read_b64_tr_b16 v[36:37], v5 offset:96
    ds_read_b64_tr_b16 v[38:39], v5 offset:864
    s_waitcnt lgkmcnt(10)
    v_mfma_f32_16x16x32_bf16 v[16:19], v[12:15], v[40:43], v[16:19]
    v_mfma_f32_32x32x16_bf16 v[80:95], v[40:43], v[176:179], v[80:95]
    v_exp_f32 v74, v74
    v_add_f32 v31, v31, v73
    v_exp_f32 v75, v75
    v_add_f32 v31, v31, v74
    s_lshl1_add_u32 m0, s39, 123200
    s_add_u32 s42, s16, 23552
    buffer_load_dwordx4 v28, s[48:51], s42 offen offset:1024 lds
    ds_read_b64_tr_b16 v[40:41], v5 offset:128
    ds_read_b64_tr_b16 v[42:43], v5 offset:896
    s_waitcnt lgkmcnt(10)
    v_mfma_f32_16x16x32_bf16 v[18:21], v[12:15], v[44:47], v[18:21]
    v_mfma_f32_32x32x16_bf16 v[96:111], v[44:47], v[176:179], v[96:111]
    v_exp_f32 v76, v76
    v_add_f32 v31, v31, v75
    v_exp_f32 v77, v77
    v_add_f32 v31, v31, v76
    s_waitcnt lgkmcnt(4)
    s_lshl1_add_u32 m0, s39, 139584
    s_add_u32 s42, s16, 65536
    buffer_load_dwordx4 v28, s[48:51], s42 offen lds
    ds_read_b64_tr_b16 v[44:45], v5 offset:160
    ds_read_b64_tr_b16 v[46:47], v5 offset:928
    v_mfma_f32_16x16x32_bf16 v[20:23], v[12:15], v[32:35], v[20:23]
    v_mfma_f32_32x32x16_bf16 v[112:127], v[32:35], v[176:179], v[112:127]
    v_exp_f32 v78, v78
    v_add_f32 v31, v31, v77
    v_exp_f32 v79, v79
    v_add_f32 v31, v31, v78
    s_lshl1_add_u32 m0, s39, 139584
    s_add_u32 s42, s16, 72704
    buffer_load_dwordx4 v28, s[48:51], s42 offen offset:1024 lds
    ds_read_b64_tr_b16 v[32:33], v6 offset:96
    ds_read_b64_tr_b16 v[34:35], v6 offset:864
    s_waitcnt lgkmcnt(6)
    v_mfma_f32_32x32x16_bf16 v[80:95], v[36:39], v[180:183], v[80:95]
    v_add_f32 v31, v31, v79
    v_rcp_f32 v31, v31
    s_nop 0
    v_mul_f32 v64, v64, v31
    v_mul_f32 v65, v65, v31
    s_add_u32 m0, s40, 24640
    s_nop 0
    buffer_load_dwordx4 v2, s[20:23], s43 offen offset:1024 lds
    ds_read_b64_tr_b16 v[36:37], v6 offset:128
    ds_read_b64_tr_b16 v[38:39], v6 offset:896
    s_waitcnt lgkmcnt(6)
    v_mfma_f32_32x32x16_bf16 v[96:111], v[40:43], v[180:183], v[96:111]
    v_cvt_pk_bf16_f32 v56, v64, v65
    v_mul_f32 v66, v66, v31
    v_mul_f32 v67, v67, v31
    v_cvt_pk_bf16_f32 v57, v66, v67
    v_mul_f32 v68, v68, v31
    v_mul_f32 v69, v69, v31
    ds_read_b64_tr_b16 v[40:41], v27 offset:512
    ds_read_b64_tr_b16 v[42:43], v27 offset:640
    s_waitcnt lgkmcnt(6)
    v_mfma_f32_32x32x16_bf16 v[112:127], v[44:47], v[180:183], v[112:127]
    v_cvt_pk_bf16_f32 v58, v68, v69
    v_mul_f32 v70, v70, v31
    v_mul_f32 v71, v71, v31
    v_cvt_pk_bf16_f32 v59, v70, v71
    v_mul_f32 v72, v72, v31
    v_mul_f32 v73, v73, v31
    ds_read_b64_tr_b16 v[44:45], v6 offset:160
    ds_read_b64_tr_b16 v[46:47], v6 offset:928
    s_waitcnt lgkmcnt(6)
    v_mfma_f32_32x32x16_bf16 v[80:95], v[32:35], v[184:187], v[80:95]
    v_cvt_pk_bf16_f32 v60, v72, v73
    v_mul_f32 v74, v74, v31
    v_mul_f32 v75, v75, v31
    v_cvt_pk_bf16_f32 v61, v74, v75
    v_mul_f32 v76, v76, v31
    v_mul_f32 v77, v77, v31
    ds_read_b64_tr_b16 v[32:33], v7 offset:96
    ds_read_b64_tr_b16 v[34:35], v7 offset:864
    s_waitcnt lgkmcnt(6)
    v_mfma_f32_32x32x16_bf16 v[96:111], v[36:39], v[184:187], v[96:111]
    v_cvt_pk_bf16_f32 v62, v76, v77
    v_mul_f32 v78, v78, v31
    v_mul_f32 v79, v79, v31
    v_cvt_pk_bf16_f32 v63, v78, v79
    s_add_u32 m0, s40, 24640
    s_nop 0
    buffer_load_dwordx4 v3, s[20:23], s43 offen offset:2048 lds
    ds_read_b64_tr_b16 v[36:37], v7 offset:128
    ds_read_b64_tr_b16 v[38:39], v7 offset:896
    s_waitcnt lgkmcnt(6)
    v_mfma_f32_32x32x16_bf16 v[64:79], v[40:43], v[52:55], 0
    ds_read_b64_tr_b16 v[40:41], v7 offset:160
    ds_read_b64_tr_b16 v[42:43], v7 offset:928
    s_waitcnt lgkmcnt(6)
    v_mfma_f32_32x32x16_bf16 v[112:127], v[44:47], v[184:187], v[112:127]
    s_barrier
    ds_read_b64_tr_b16 v[44:45], v4 offset:24736
    ds_read_b64_tr_b16 v[46:47], v4 offset:25504
    s_waitcnt lgkmcnt(6)
    v_mfma_f32_32x32x16_bf16 v[80:95], v[32:35], v[188:191], v[80:95]
    s_nop 2
    v_max_f32 v26, v64, v65
    v_max_f32 v31, v66, v67
    v_max3_f32 v26, v26, v68, v69
    v_max3_f32 v31, v31, v70, v71
    v_max3_f32 v26, v26, v72, v73
    v_max3_f32 v31, v31, v74, v75
    s_waitcnt vmcnt(4)
    ds_read_b64_tr_b16 v[144:145], v29 offset:32896
    ds_read_b64_tr_b16 v[146:147], v29 offset:33408
    ds_read_b64_tr_b16 v[148:149], v30 offset:32896
    ds_read_b64_tr_b16 v[150:151], v30 offset:33408
    ds_read_b64_tr_b16 v[32:33], v4 offset:24768
    ds_read_b64_tr_b16 v[34:35], v4 offset:25536
    s_waitcnt lgkmcnt(10)
    v_mfma_f32_32x32x16_bf16 v[96:111], v[36:39], v[188:191], v[96:111]
    v_max3_f32 v26, v26, v76, v77
    v_max3_f32 v31, v31, v78, v79
    v_max_f32 v26, v26, v31
    v_mul_f32 v26, v26, v24
    ds_read_b64_tr_b16 v[36:37], v4 offset:24800
    ds_read_b64_tr_b16 v[38:39], v4 offset:25568
    s_waitcnt lgkmcnt(10)
    v_mfma_f32_32x32x16_bf16 v[112:127], v[40:43], v[188:191], v[112:127]
    v_subrev_u32 v4, 73920, v4
    v_fma_f32 v64, v64, -v24, v26
    v_fma_f32 v65, v65, -v24, v26
    v_fma_f32 v66, v66, -v24, v26
    v_fma_f32 v67, v67, -v24, v26
    s_add_u32 s41, s36, 15
    s_and_b32 s41, s41, 7
    s_add_u32 m0, s40, 49280
    s_mul_i32 s43, s41, 176128
    buffer_load_dwordx4 v1, s[20:23], s43 offen lds
    s_waitcnt vmcnt(3)
    ds_read_b64_tr_b16 v[152:153], v29 offset:49280
    ds_read_b64_tr_b16 v[154:155], v29 offset:49792
    ds_read_b64_tr_b16 v[156:157], v30 offset:49280
    ds_read_b64_tr_b16 v[158:159], v30 offset:49792
    ds_read_b64_tr_b16 v[40:41], v5 offset:24736
    ds_read_b64_tr_b16 v[42:43], v5 offset:25504
    s_waitcnt lgkmcnt(14)
    v_mfma_f32_16x16x32_bf16 v[16:19], v[12:15], v[44:47], v[16:19]
    v_mfma_f32_32x32x16_bf16 v[80:95], v[44:47], v[192:195], v[80:95]
    v_exp_f32 v64, v64
    v_fma_f32 v68, v68, -v24, v26
    v_fma_f32 v69, v69, -v24, v26
    v_fma_f32 v70, v70, -v24, v26
    v_fma_f32 v71, v71, -v24, v26
    s_waitcnt lgkmcnt(10)
    s_lshl1_add_u32 m0, s39, 123200
    s_add_u32 s42, s16, 32768
    buffer_load_dwordx4 v28, s[48:51], s42 offen lds
    ds_read_b64_tr_b16 v[44:45], v5 offset:24768
    ds_read_b64_tr_b16 v[46:47], v5 offset:25536
    s_waitcnt lgkmcnt(10)
    v_mfma_f32_16x16x32_bf16 v[18:21], v[12:15], v[32:35], v[18:21]
    v_mfma_f32_32x32x16_bf16 v[96:111], v[32:35], v[192:195], v[96:111]
    v_exp_f32 v65, v65
    v_fma_f32 v72, v72, -v24, v26
    v_fma_f32 v73, v73, -v24, v26
    v_fma_f32 v74, v74, -v24, v26
    v_fma_f32 v75, v75, -v24, v26
    s_lshl1_add_u32 m0, s39, 123200
    s_add_u32 s42, s16, 39936
    buffer_load_dwordx4 v28, s[48:51], s42 offen offset:1024 lds
    ds_read_b64_tr_b16 v[32:33], v5 offset:24800
    ds_read_b64_tr_b16 v[34:35], v5 offset:25568
    s_waitcnt lgkmcnt(10)
    v_mfma_f32_16x16x32_bf16 v[20:23], v[12:15], v[36:39], v[20:23]
    v_mfma_f32_32x32x16_bf16 v[112:127], v[36:39], v[192:195], v[112:127]
    v_subrev_u32 v5, 73920, v5
    v_exp_f32 v66, v66
    v_fma_f32 v76, v76, -v24, v26
    v_fma_f32 v77, v77, -v24, v26
    v_fma_f32 v78, v78, -v24, v26
    s_waitcnt lgkmcnt(6)
    s_lshl1_add_u32 m0, s39, 139584
    s_add_u32 s42, s16, 81920
    buffer_load_dwordx4 v28, s[48:51], s42 offen lds
    ds_read_b64_tr_b16 v[36:37], v6 offset:24736
    ds_read_b64_tr_b16 v[38:39], v6 offset:25504
    s_waitcnt lgkmcnt(6)
    v_mfma_f32_32x32x16_bf16 v[80:95], v[40:43], v[196:199], v[80:95]
    v_add_f32 v31, v64, v65
    v_exp_f32 v67, v67
    v_fma_f32 v79, v79, -v24, v26
    v_add_f32 v31, v31, v66
    v_add_f32 v31, v31, v67
    s_add_u32 m0, s40, 49280
    s_nop 0
    buffer_load_dwordx4 v2, s[20:23], s43 offen offset:1024 lds
    ds_read_b64_tr_b16 v[40:41], v6 offset:24768
    ds_read_b64_tr_b16 v[42:43], v6 offset:25536
    s_waitcnt lgkmcnt(6)
    v_mfma_f32_32x32x16_bf16 v[96:111], v[44:47], v[196:199], v[96:111]
    v_exp_f32 v68, v68
    v_exp_f32 v69, v69
    v_add_f32 v31, v31, v68
    v_add_f32 v31, v31, v69
    s_lshl1_add_u32 m0, s39, 139584
    s_add_u32 s42, s16, 89088
    buffer_load_dwordx4 v28, s[48:51], s42 offen offset:1024 lds
    ds_read_b64_tr_b16 v[44:45], v6 offset:24800
    ds_read_b64_tr_b16 v[46:47], v6 offset:25568
    s_waitcnt lgkmcnt(6)
    v_mfma_f32_32x32x16_bf16 v[112:127], v[32:35], v[196:199], v[112:127]
    v_subrev_u32 v6, 73920, v6
    v_exp_f32 v70, v70
    v_exp_f32 v71, v71
    v_add_f32 v31, v31, v70
    ds_read_b64_tr_b16 v[32:33], v7 offset:24736
    ds_read_b64_tr_b16 v[34:35], v7 offset:25504
    s_waitcnt lgkmcnt(6)
    v_mfma_f32_32x32x16_bf16 v[80:95], v[36:39], v[200:203], v[80:95]
    v_exp_f32 v72, v72
    v_add_f32 v31, v31, v71
    v_exp_f32 v73, v73
    v_add_f32 v31, v31, v72
    ds_read_b64_tr_b16 v[36:37], v7 offset:24768
    ds_read_b64_tr_b16 v[38:39], v7 offset:25536
    s_waitcnt lgkmcnt(6)
    v_mfma_f32_32x32x16_bf16 v[96:111], v[40:43], v[200:203], v[96:111]
    v_exp_f32 v74, v74
    v_add_f32 v31, v31, v73
    v_exp_f32 v75, v75
    v_add_f32 v31, v31, v74
    s_add_u32 m0, s40, 49280
    s_nop 0
    buffer_load_dwordx4 v3, s[20:23], s43 offen offset:2048 lds
    ds_read_b64_tr_b16 v[40:41], v7 offset:24800
    ds_read_b64_tr_b16 v[42:43], v7 offset:25568
    s_waitcnt lgkmcnt(6)
    v_mfma_f32_32x32x16_bf16 v[112:127], v[44:47], v[200:203], v[112:127]
    s_barrier
    ds_read_b64_tr_b16 v[44:45], v4 offset:96
    ds_read_b64_tr_b16 v[46:47], v4 offset:864
    s_waitcnt lgkmcnt(6)
    v_mfma_f32_32x32x16_bf16 v[80:95], v[32:35], v[204:207], v[80:95]
    v_subrev_u32 v7, 73920, v7
    v_exp_f32 v76, v76
    v_add_f32 v31, v31, v75
    v_exp_f32 v77, v77
    s_lshl1_add_u32 m0, s39, 73920
    s_add_u32 s42, s18, 49152
    buffer_load_dwordx4 v28, s[48:51], s42 offen lds
    s_cmp_eq_u32 s19, 0x2000000
    s_cselect_b32 s36, 2.0, s30
    ds_read_b64_tr_b16 v[32:33], v4 offset:128
    ds_read_b64_tr_b16 v[34:35], v4 offset:896
    s_waitcnt lgkmcnt(6)
    v_mfma_f32_32x32x16_bf16 v[96:111], v[36:39], v[204:207], v[96:111]
    v_add_f32 v31, v31, v76
    v_exp_f32 v78, v78
    v_add_f32 v31, v31, v77
    v_exp_f32 v79, v79
    s_lshl1_add_u32 m0, s39, 73920
    s_add_u32 s42, s18, 56320
    buffer_load_dwordx4 v28, s[48:51], s42 offen offset:1024 lds
    ds_read_b64_tr_b16 v[36:37], v4 offset:160
    ds_read_b64_tr_b16 v[38:39], v4 offset:928
    s_waitcnt lgkmcnt(6)
    v_mfma_f32_32x32x16_bf16 v[112:127], v[40:43], v[204:207], v[112:127]
    v_add_f32 v31, v31, v78
    v_add_f32 v31, v31, v79
    v_rcp_f32 v31, v31
    v_bfe_u32 v52, v0, 4, 6
    v_mul_f32 v64, v64, v31
    s_waitcnt vmcnt(6)
    ds_read_b64_tr_b16 v[160:161], v29 offset:32896
    ds_read_b64_tr_b16 v[162:163], v29 offset:33408
    ds_read_b64_tr_b16 v[164:165], v30 offset:32896
    ds_read_b64_tr_b16 v[166:167], v30 offset:33408
    ds_read_b64_tr_b16 v[40:41], v5 offset:96
    ds_read_b64_tr_b16 v[42:43], v5 offset:864
    s_waitcnt lgkmcnt(10)
    v_mfma_f32_16x16x32_bf16 v[16:19], v[12:15], v[44:47], v[16:19]
    v_mfma_f32_32x32x16_bf16 v[80:95], v[44:47], v[208:211], v[80:95]
    v_mul_f32 v65, v65, v31
    v_cvt_pk_bf16_f32 v64, v64, v65
    v_mul_f32 v66, v66, v31
    v_mul_f32 v67, v67, v31
    v_cvt_pk_bf16_f32 v65, v66, v67
    v_mul_f32 v68, v68, v31
    ds_read_b64_tr_b16 v[44:45], v6 offset:96
    ds_read_b64_tr_b16 v[46:47], v6 offset:864
    s_waitcnt lgkmcnt(10)
    v_mfma_f32_16x16x32_bf16 v[18:21], v[12:15], v[32:35], v[18:21]
    v_mfma_f32_32x32x16_bf16 v[96:111], v[32:35], v[208:211], v[96:111]
    v_mul_f32 v69, v69, v31
    v_cvt_pk_bf16_f32 v66, v68, v69
    v_mul_f32 v70, v70, v31
    v_mul_f32 v71, v71, v31
    v_cvt_pk_bf16_f32 v67, v70, v71
    v_mul_f32 v72, v72, v31
    s_waitcnt lgkmcnt(4)
    s_lshl1_add_u32 m0, s39, 123200
    s_add_u32 s42, s17, 0
    buffer_load_dwordx4 v28, s[44:47], s42 offen lds
    ds_read_b64_tr_b16 v[32:33], v7 offset:96
    ds_read_b64_tr_b16 v[34:35], v7 offset:864
    v_mfma_f32_16x16x32_bf16 v[20:23], v[12:15], v[36:39], v[20:23]
    v_mfma_f32_32x32x16_bf16 v[112:127], v[36:39], v[208:211], v[112:127]
    s_waitcnt vmcnt(4)
    ds_read_b64_tr_b16 v[168:169], v29 offset:49280
    ds_read_b64_tr_b16 v[170:171], v29 offset:49792
    ds_read_b64_tr_b16 v[172:173], v30 offset:49280
    ds_read_b64_tr_b16 v[174:175], v30 offset:49792
    s_lshl1_add_u32 m0, s39, 123200
    s_add_u32 s42, s17, 7168
    buffer_load_dwordx4 v28, s[44:47], s42 offen offset:1024 lds
    s_waitcnt vmcnt(4)
    s_barrier
    ds_read_b64_tr_b16 v[36:37], v4 offset:24736
    ds_read_b64_tr_b16 v[38:39], v4 offset:25504
    s_waitcnt lgkmcnt(10)
    v_mfma_f32_32x32x16_bf16 v[80:95], v[40:43], v[212:215], v[80:95]
    v_mul_f32 v73, v73, v31
    v_cvt_pk_bf16_f32 v68, v72, v73
    v_mul_f32 v74, v74, v31
    v_mul_f32 v75, v75, v31
    v_cvt_pk_bf16_f32 v69, v74, v75
    v_mul_f32 v76, v76, v31
    s_lshl1_add_u32 m0, s39, 90304
    s_add_u32 s42, s19, 16384
    buffer_load_dwordx4 v28, s[48:51], s42 offen lds
    ds_read_b64_tr_b16 v[40:41], v4 offset:24768
    ds_read_b64_tr_b16 v[42:43], v4 offset:25536
    s_waitcnt lgkmcnt(10)
    v_mfma_f32_32x32x16_bf16 v[80:95], v[44:47], v[216:219], v[80:95]
    v_mul_f32 v77, v77, v31
    v_cvt_pk_bf16_f32 v70, v76, v77
    v_mul_f32 v78, v78, v31
    v_mul_f32 v79, v79, v31
    v_cvt_pk_bf16_f32 v71, v78, v79
    v_lshrrev_b32 v31, 2, v0
    s_waitcnt lgkmcnt(4)
    s_lshl1_add_u32 m0, s39, 139584
    s_add_u32 s42, s17, 16384
    buffer_load_dwordx4 v28, s[44:47], s42 offen lds
    ds_read_b64_tr_b16 v[44:45], v4 offset:24800
    ds_read_b64_tr_b16 v[46:47], v4 offset:25568
    v_mfma_f32_32x32x16_bf16 v[80:95], v[32:35], v[220:223], v[80:95]
    v_and_b32 v31, 28, v31
    v_and_b32 v49, 15, v52
    v_lshrrev_b32 v50, 1, v52
    v_and_b32 v50, 8, v50
    v_xor_b32 v50, v49, v50
    v_and_b32 v51, 1, v50
    s_lshl1_add_u32 m0, s39, 139584
    s_add_u32 s42, s17, 23552
    buffer_load_dwordx4 v28, s[44:47], s42 offen offset:1024 lds
    ds_read_b64_tr_b16 v[32:33], v4 offset:49376
    ds_read_b64_tr_b16 v[34:35], v4 offset:50144
    s_waitcnt lgkmcnt(6)
    v_mfma_f32_16x16x32_bf16 v[16:19], v[12:15], v[36:39], v[16:19]
    v_mfma_f32_32x32x16_bf16 v[80:95], v[36:39], v[224:227], v[80:95]
    v_lshlrev_b32 v51, 4, v51
    v_mov_b32 v49, 0x3f80
    v_lshlrev_b32 v51, v51, v49
    v_lshrrev_b32 v50, 1, v50
    v_cmp_eq_u32 vcc, 0, v50
    s_nop 1
    v_cndmask_b32 v72, 0, v51, vcc
    s_lshl1_add_u32 m0, s39, 90304
    s_add_u32 s42, s19, 23552
    buffer_load_dwordx4 v28, s[48:51], s42 offen offset:1024 lds
    ds_read_b64_tr_b16 v[36:37], v4 offset:49408
    ds_read_b64_tr_b16 v[38:39], v4 offset:50176
    s_waitcnt lgkmcnt(6)
    v_mfma_f32_16x16x32_bf16 v[18:21], v[12:15], v[40:43], v[18:21]
    v_mfma_f32_32x32x16_bf16 v[96:111], v[40:43], v[224:227], v[96:111]
    v_cmp_eq_u32 vcc, 1, v50
    v_add_u32 v2, s56, v0
    s_nop 0
    v_cndmask_b32 v73, 0, v51, vcc
    v_cmp_eq_u32 vcc, 2, v50
    s_nop 1
    v_cndmask_b32 v74, 0, v51, vcc
    v_cmp_eq_u32 vcc, 3, v50
    ds_read_b64_tr_b16 v[40:41], v4 offset:49440
    ds_read_b64_tr_b16 v[42:43], v4 offset:50208
    s_waitcnt lgkmcnt(6)
    v_mfma_f32_16x16x32_bf16 v[20:23], v[12:15], v[44:47], v[20:23]
    v_mfma_f32_32x32x16_bf16 v[112:127], v[44:47], v[224:227], v[112:127]
    v_and_b32 v49, 7, v52
    v_lshlrev_b32 v49, 7, v49
    v_cndmask_b32 v75, 0, v51, vcc
    v_and_b32 v50, 16, v52
    v_lshl_add_u32 v49, v50, 2, v49
    v_and_b32 v50, 8, v52
    ds_read_b64_tr_b16 v[44:45], v5 offset:24736
    ds_read_b64_tr_b16 v[46:47], v5 offset:25504
    s_waitcnt lgkmcnt(6)
    v_mfma_f32_16x16x32_bf16 v[16:19], v[12:15], v[32:35], v[16:19]
    v_mfma_f32_32x32x16_bf16 v[80:95], v[32:35], v[240:243], v[80:95]
    v_add_u32 v49, v49, v50
    v_lshrrev_b32 v50, 1, v52
    v_and_b32 v50, 16, v50
    v_add3_u32 v1, v49, v50, s58
    v_and_b32 v49, 19, v52
    v_bfe_u32 v50, v52, 2, 1
    ds_read_b64_tr_b16 v[32:33], v6 offset:24736
    ds_read_b64_tr_b16 v[34:35], v6 offset:25504
    s_waitcnt lgkmcnt(6)
    v_mfma_f32_16x16x32_bf16 v[18:21], v[12:15], v[36:39], v[18:21]
    v_mfma_f32_32x32x16_bf16 v[96:111], v[36:39], v[240:243], v[96:111]
    v_lshlrev_b32 v26, 3, v31
    v_lshrrev_b32 v48, 6, v0
    v_lshl_or_b32 v49, v50, 3, v49
    v_bfe_u32 v50, v52, 3, 1
    v_lshl_or_b32 v49, v50, 2, v49
    v_lshlrev_b32 v49, 6, v49
    buffer_load_dword v27, v26, s[4:7], 0 offen
    ds_read_b64_tr_b16 v[36:37], v7 offset:24736
    ds_read_b64_tr_b16 v[38:39], v7 offset:25504
    s_waitcnt lgkmcnt(6)
    v_mfma_f32_16x16x32_bf16 v[20:23], v[12:15], v[40:43], v[20:23]
    v_mfma_f32_32x32x16_bf16 v[112:127], v[40:43], v[240:243], v[112:127]
    v_and_b32 v50, 32, v52
    v_add_u32 v49, v49, v50
    v_add_u32 v3, 110784, v49
    v_and_b32 v48, 12, v48
    v_xor_b32 v48, s3, v48
    v_or_b32 v48, v48, v0
    ds_read_b64_tr_b16 v[40:41], v5 offset:49376
    ds_read_b64_tr_b16 v[42:43], v5 offset:50144
    s_waitcnt lgkmcnt(6)
    v_mfma_f32_32x32x16_bf16 v[80:95], v[44:47], v[228:231], v[80:95]
    v_and_b32 v50, s55, v16
    v_sub_f32 v51, v16, v50
    v_cvt_pk_bf16_f32 v50, v50, v51
    v_and_b32 v52, s55, v18
    v_sub_f32 v53, v18, v52
    v_cvt_pk_bf16_f32 v52, v52, v53
    ds_write_b32 v48, v50 offset:36480
    ds_write_b32 v48, v52 offset:37504
    s_waitcnt vmcnt(5)
    ds_read_b64_tr_b16 v[176:177], v29 offset:32896
    ds_read_b64_tr_b16 v[178:179], v29 offset:33408
    ds_read_b64_tr_b16 v[44:45], v6 offset:49376
    ds_read_b64_tr_b16 v[46:47], v6 offset:50144
    s_waitcnt lgkmcnt(10)
    v_mfma_f32_32x32x16_bf16 v[80:95], v[32:35], v[232:235], v[80:95]
    v_and_b32 v54, s55, v20
    v_sub_f32 v55, v20, v54
    v_cvt_pk_bf16_f32 v54, v54, v55
    ds_write_b32 v48, v54 offset:38528
    ds_read_b64_tr_b16 v[180:181], v30 offset:32896
    ds_read_b64_tr_b16 v[182:183], v30 offset:33408
    s_waitcnt lgkmcnt(2)
    s_barrier
    ds_read_b128 v[32:35], v0 offset:36480
    v_mfma_f32_32x32x16_bf16 v[80:95], v[36:39], v[236:239], v[80:95]
    ds_read_b64_tr_b16 v[36:37], v7 offset:49376
    ds_read_b64_tr_b16 v[38:39], v7 offset:50144
    v_mfma_f32_32x32x16_bf16 v[80:95], v[40:43], v[244:247], v[80:95]
    s_waitcnt vmcnt(2)
    ds_read_b64_tr_b16 v[184:185], v29 offset:49280
    ds_read_b64_tr_b16 v[186:187], v29 offset:49792
    ds_read_b64_tr_b16 v[188:189], v30 offset:49280
    ds_read_b64_tr_b16 v[190:191], v30 offset:49792
    s_waitcnt lgkmcnt(7)
    s_lshl1_add_u32 m0, s39, 123200
    s_add_u32 s42, s17, 32768
    buffer_load_dwordx4 v28, s[44:47], s42 offen lds
    ds_read_b64_tr_b16 v[40:41], v5 offset:128
    ds_read_b64_tr_b16 v[42:43], v5 offset:896
    v_mfma_f32_32x32x16_bf16 v[80:95], v[44:47], v[248:251], v[80:95]
    s_lshl1_add_u32 m0, s39, 123200
    s_add_u32 s42, s17, 39936
    buffer_load_dwordx4 v28, s[44:47], s42 offen offset:1024 lds
    ds_read_b64_tr_b16 v[44:45], v6 offset:128
    ds_read_b64_tr_b16 v[46:47], v6 offset:896
    s_waitcnt lgkmcnt(10)
    v_mfma_f32_32x32x16_bf16 v[80:95], v[32:35], v[8:11], v[80:95]
    s_waitcnt lgkmcnt(4)
    s_lshl1_add_u32 m0, s39, 139584
    s_add_u32 s42, s17, 49152
    buffer_load_dwordx4 v28, s[44:47], s42 offen lds
    ds_read_b64_tr_b16 v[32:33], v7 offset:128
    ds_read_b64_tr_b16 v[34:35], v7 offset:896
    v_mfma_f32_32x32x16_bf16 v[80:95], v[36:39], v[252:255], v[80:95]
    s_lshl1_add_u32 m0, s39, 139584
    s_add_u32 s42, s17, 56320
    buffer_load_dwordx4 v28, s[44:47], s42 offen offset:1024 lds
    s_and_b32 s101, s2, 7
    s_waitcnt vmcnt(4)
    v_readlane_b32 s101, v27, s101
    v_and_b32 v27, 0xff, v27
    v_cmp_gt_u32 vcc, 32, v27
    s_lshl_b32 s57, s100, 5
    s_sub_u32 s101, s101, s57
    s_cbranch_vccnz L_parallel_sum__linear_kernel_hedgehog__glu_gated_glu__prompt_kernel_11_cp
L_parallel_sum__linear_kernel_hedgehog__glu_gated_glu__prompt_kernel_11_cb:
    ds_read_b64_tr_b16 v[36:37], v5 offset:24768
    ds_read_b64_tr_b16 v[38:39], v5 offset:25536
    s_waitcnt lgkmcnt(6)
    v_mfma_f32_32x32x16_bf16 v[96:111], v[40:43], v[212:215], v[96:111]
    ds_read_b64_tr_b16 v[40:41], v6 offset:24768
    ds_read_b64_tr_b16 v[42:43], v6 offset:25536
    s_waitcnt lgkmcnt(6)
    v_mfma_f32_32x32x16_bf16 v[96:111], v[44:47], v[216:219], v[96:111]
    v_mul_f32 v80, v80, v24
    v_mul_f32 v81, v81, v24
    v_mul_f32 v82, v82, v24
    v_mul_f32 v83, v83, v24
    v_mul_f32 v84, v84, v24
    v_mul_f32 v85, v85, v24
    ds_read_b64_tr_b16 v[44:45], v7 offset:24768
    ds_read_b64_tr_b16 v[46:47], v7 offset:25536
    s_waitcnt lgkmcnt(6)
    v_mfma_f32_32x32x16_bf16 v[96:111], v[32:35], v[220:223], v[96:111]
    v_mul_f32 v86, v86, v24
    v_mul_f32 v87, v87, v24
    v_exp_f32 v80, v80
    v_exp_f32 v81, v81
    ds_read_b64_tr_b16 v[32:33], v5 offset:49408
    ds_read_b64_tr_b16 v[34:35], v5 offset:50176
    s_waitcnt lgkmcnt(6)
    v_mfma_f32_32x32x16_bf16 v[96:111], v[36:39], v[228:231], v[96:111]
    v_exp_f32 v82, v82
    v_exp_f32 v83, v83
    v_exp_f32 v84, v84
    ds_read_b64_tr_b16 v[36:37], v6 offset:49408
    ds_read_b64_tr_b16 v[38:39], v6 offset:50176
    s_waitcnt lgkmcnt(6)
    v_mfma_f32_32x32x16_bf16 v[96:111], v[40:43], v[232:235], v[96:111]
    v_exp_f32 v85, v85
    v_exp_f32 v86, v86
    v_exp_f32 v87, v87
    ds_read_b64_tr_b16 v[40:41], v7 offset:49408
    ds_read_b64_tr_b16 v[42:43], v7 offset:50176
    s_waitcnt lgkmcnt(6)
    v_mfma_f32_32x32x16_bf16 v[96:111], v[44:47], v[236:239], v[96:111]
    v_fma_f32 v80, v80, v25, v25
    v_fma_f32 v81, v81, v25, v25
    v_fma_f32 v82, v82, v25, v25
    v_fma_f32 v83, v83, v25, v25
    ds_read_b128 v[44:47], v0 offset:37504
    s_waitcnt lgkmcnt(5)
    v_mfma_f32_32x32x16_bf16 v[96:111], v[32:35], v[244:247], v[96:111]
    v_rcp_f32 v80, v80
    v_fma_f32 v84, v84, v25, v25
    v_fma_f32 v85, v85, v25, v25
    v_fma_f32 v86, v86, v25, v25
    v_fma_f32 v87, v87, v25, v25
    ds_read_b64_tr_b16 v[32:33], v5 offset:160
    ds_read_b64_tr_b16 v[34:35], v5 offset:928
    s_waitcnt lgkmcnt(5)
    v_mfma_f32_32x32x16_bf16 v[96:111], v[36:39], v[248:251], v[96:111]
    v_rcp_f32 v81, v81
    v_rcp_f32 v82, v82
    v_rcp_f32 v83, v83
    s_waitcnt vmcnt(2)
    ds_read_b64_tr_b16 v[192:193], v29 offset:32896
    ds_read_b64_tr_b16 v[194:195], v29 offset:33408
    ds_read_b64_tr_b16 v[196:197], v30 offset:32896
    ds_read_b64_tr_b16 v[198:199], v30 offset:33408
    ds_read_b64_tr_b16 v[36:37], v6 offset:160
    ds_read_b64_tr_b16 v[38:39], v6 offset:928
    s_waitcnt lgkmcnt(9)
    v_mfma_f32_32x32x16_bf16 v[96:111], v[40:43], v[252:255], v[96:111]
    v_rcp_f32 v84, v84
    v_rcp_f32 v85, v85
    v_rcp_f32 v86, v86
    ds_read_b64_tr_b16 v[40:41], v7 offset:160
    ds_read_b64_tr_b16 v[42:43], v7 offset:928
    s_waitcnt lgkmcnt(10)
    v_mfma_f32_32x32x16_bf16 v[96:111], v[44:47], v[8:11], v[96:111]
    v_rcp_f32 v87, v87
    v_mul_f32 v80, v80, v88
    v_mul_f32 v81, v81, v89
    v_mul_f32 v82, v82, v90
    v_mul_f32 v83, v83, v91
    s_waitcnt vmcnt(0)
    ds_read_b64_tr_b16 v[200:201], v29 offset:49280
    ds_read_b64_tr_b16 v[202:203], v29 offset:49792
    ds_read_b64_tr_b16 v[204:205], v30 offset:49280
    ds_read_b64_tr_b16 v[206:207], v30 offset:49792
    s_waitcnt lgkmcnt(8)
    s_lshl1_add_u32 m0, s39, 123200
    s_add_u32 s42, s18, 32768
    buffer_load_dwordx4 v28, s[48:51], s42 offen lds
    ds_read_b64_tr_b16 v[44:45], v5 offset:24800
    ds_read_b64_tr_b16 v[46:47], v5 offset:25568
    v_mfma_f32_32x32x16_bf16 v[112:127], v[32:35], v[212:215], v[112:127]
    v_mul_f32 v84, v84, v92
    v_mul_f32 v85, v85, v93
    v_mul_f32 v86, v86, v94
    v_mul_f32 v87, v87, v95
    v_cvt_pk_bf16_f32 v80, v80, v81
    v_cvt_pk_bf16_f32 v81, v82, v83
    s_lshl1_add_u32 m0, s39, 123200
    s_add_u32 s42, s18, 39936
    buffer_load_dwordx4 v28, s[48:51], s42 offen offset:1024 lds
    ds_read_b64_tr_b16 v[32:33], v6 offset:24800
    ds_read_b64_tr_b16 v[34:35], v6 offset:25568
    s_waitcnt lgkmcnt(10)
    v_mfma_f32_32x32x16_bf16 v[112:127], v[36:39], v[216:219], v[112:127]
    v_cvt_pk_bf16_f32 v82, v84, v85
    v_cvt_pk_bf16_f32 v83, v86, v87
    v_mul_f32 v96, v96, v24
    v_mul_f32 v97, v97, v24
    v_mul_f32 v98, v98, v24
    v_mul_f32 v99, v99, v24
    s_cmp_lg_u32 s101, 0
    s_cbranch_scc1 L_parallel_sum__linear_kernel_hedgehog__glu_gated_glu__prompt_kernel_11_ss1
    buffer_store_dwordx4 v[80:83], v0, s[24:27], s52 offen offset:0
L_parallel_sum__linear_kernel_hedgehog__glu_gated_glu__prompt_kernel_11_sb1:
    ds_read_b64_tr_b16 v[36:37], v7 offset:24800
    ds_read_b64_tr_b16 v[38:39], v7 offset:25568
    s_waitcnt lgkmcnt(10)
    v_mfma_f32_32x32x16_bf16 v[112:127], v[40:43], v[220:223], v[112:127]
    v_mul_f32 v100, v100, v24
    v_mul_f32 v101, v101, v24
    v_mul_f32 v102, v102, v24
    v_mul_f32 v103, v103, v24
    v_exp_f32 v96, v96
    s_waitcnt lgkmcnt(6)
    s_lshl1_add_u32 m0, s39, 139584
    s_add_u32 s42, s19, 0
    buffer_load_dwordx4 v28, s[48:51], s42 offen lds
    ds_read_b64_tr_b16 v[40:41], v5 offset:49440
    ds_read_b64_tr_b16 v[42:43], v5 offset:50208
    s_waitcnt lgkmcnt(6)
    v_mfma_f32_32x32x16_bf16 v[112:127], v[44:47], v[228:231], v[112:127]
    v_exp_f32 v97, v97
    v_exp_f32 v98, v98
    v_exp_f32 v99, v99
    s_lshl1_add_u32 m0, s39, 139584
    s_add_u32 s42, s19, 7168
    buffer_load_dwordx4 v28, s[48:51], s42 offen offset:1024 lds
    ds_read_b64_tr_b16 v[44:45], v6 offset:49440
    ds_read_b64_tr_b16 v[46:47], v6 offset:50208
    s_waitcnt lgkmcnt(6)
    v_mfma_f32_32x32x16_bf16 v[112:127], v[32:35], v[232:235], v[112:127]
    v_exp_f32 v100, v100
    v_exp_f32 v101, v101
    v_exp_f32 v102, v102
    buffer_load_dwordx4 v[76:79], v0, s[24:27], s54 offen sc1
    ds_read_b64_tr_b16 v[32:33], v7 offset:49440
    ds_read_b64_tr_b16 v[34:35], v7 offset:50208
    s_waitcnt lgkmcnt(6)
    v_mfma_f32_32x32x16_bf16 v[112:127], v[36:39], v[236:239], v[112:127]
    v_exp_f32 v103, v103
    v_fma_f32 v96, v96, v25, v25
    v_fma_f32 v97, v97, v25, v25
    v_fma_f32 v98, v98, v25, v25
    v_fma_f32 v99, v99, v25, v25
    ds_read_b128 v[36:39], v0 offset:38528
    s_waitcnt lgkmcnt(5)
    v_mfma_f32_32x32x16_bf16 v[112:127], v[40:43], v[244:247], v[112:127]
    v_rcp_f32 v96, v96
    v_fma_f32 v100, v100, v25, v25
    v_fma_f32 v101, v101, v25, v25
    v_fma_f32 v102, v102, v25, v25
    v_fma_f32 v103, v103, v25, v25
    s_waitcnt lgkmcnt(3)
    v_mfma_f32_32x32x16_bf16 v[112:127], v[44:47], v[248:251], v[112:127]
    v_rcp_f32 v97, v97
    v_rcp_f32 v98, v98
    v_rcp_f32 v99, v99
    s_waitcnt lgkmcnt(1)
    v_mfma_f32_32x32x16_bf16 v[112:127], v[32:35], v[252:255], v[112:127]
    v_rcp_f32 v100, v100
    v_rcp_f32 v101, v101
    v_rcp_f32 v102, v102
    s_waitcnt lgkmcnt(0)
    v_mfma_f32_32x32x16_bf16 v[112:127], v[36:39], v[8:11], v[112:127]
    v_rcp_f32 v103, v103
    v_mul_f32 v96, v96, v104
    v_mul_f32 v97, v97, v105
    v_mul_f32 v98, v98, v106
    v_mul_f32 v99, v99, v107
    v_mul_f32 v100, v100, v108
    v_mul_f32 v101, v101, v109
    v_mul_f32 v102, v102, v110
    v_mul_f32 v103, v103, v111
    v_cvt_pk_bf16_f32 v96, v96, v97
    v_cvt_pk_bf16_f32 v97, v98, v99
    v_cvt_pk_bf16_f32 v98, v100, v101
    v_cvt_pk_bf16_f32 v99, v102, v103
    s_cmp_lg_u32 s101, 0
    s_cbranch_scc1 L_parallel_sum__linear_kernel_hedgehog__glu_gated_glu__prompt_kernel_11_ss2
    buffer_store_dwordx4 v[96:99], v0, s[24:27], s52 offen offset:1024
L_parallel_sum__linear_kernel_hedgehog__glu_gated_glu__prompt_kernel_11_sb2:
    v_mul_f32 v112, v112, v24
    v_mul_f32 v113, v113, v24
    v_mul_f32 v114, v114, v24
    v_mul_f32 v115, v115, v24
    v_mul_f32 v116, v116, v24
    v_mul_f32 v117, v117, v24
    v_mul_f32 v118, v118, v24
    v_mul_f32 v119, v119, v24
    v_exp_f32 v112, v112
    v_exp_f32 v113, v113
    v_exp_f32 v114, v114
    v_exp_f32 v115, v115
    s_waitcnt vmcnt(1)
    v_cmp_eq_u32 vcc, -1, v76
    s_nop 1
    s_cbranch_vccnz L_parallel_sum__linear_kernel_hedgehog__glu_gated_glu__prompt_kernel_11_zp
L_parallel_sum__linear_kernel_hedgehog__glu_gated_glu__prompt_kernel_11_zb:
    buffer_load_dwordx4 v[80:83], v0, s[24:27], s53 offen offset:0
    buffer_load_dwordx4 v[84:87], v0, s[24:27], s53 offen offset:1024
    buffer_load_dwordx4 v[88:91], v0, s[24:27], s53 offen offset:2048
    buffer_load_dwordx4 v[92:95], v0, s[24:27], s53 offen offset:3072
    s_add_u32 s58, s53, 4096
    buffer_load_dwordx4 v[96:99], v0, s[24:27], s58 offen offset:0
    buffer_load_dwordx4 v[100:103], v0, s[24:27], s58 offen offset:1024
    buffer_load_dwordx4 v[104:107], v0, s[24:27], s58 offen offset:2048
    buffer_load_dwordx4 v[108:111], v0, s[24:27], s58 offen offset:3072
    v_exp_f32 v116, v116
    v_exp_f32 v117, v117
    v_exp_f32 v118, v118
    v_exp_f32 v119, v119
    v_fma_f32 v112, v112, v25, v25
    v_fma_f32 v113, v113, v25, v25
    v_fma_f32 v114, v114, v25, v25
    v_fma_f32 v115, v115, v25, v25
    v_fma_f32 v116, v116, v25, v25
    v_fma_f32 v117, v117, v25, v25
    v_fma_f32 v118, v118, v25, v25
    v_fma_f32 v119, v119, v25, v25
    v_rcp_f32 v112, v112
    v_rcp_f32 v113, v113
    v_rcp_f32 v114, v114
    v_rcp_f32 v115, v115
    v_rcp_f32 v116, v116
    v_rcp_f32 v117, v117
    v_rcp_f32 v118, v118
    v_rcp_f32 v119, v119
    v_mul_f32 v112, v112, v120
    v_mul_f32 v113, v113, v121
    v_mul_f32 v114, v114, v122
    v_mul_f32 v115, v115, v123
    v_mul_f32 v116, v116, v124
    v_mul_f32 v117, v117, v125
    v_mul_f32 v118, v118, v126
    v_mul_f32 v119, v119, v127
    v_cvt_pk_bf16_f32 v112, v112, v113
    v_cvt_pk_bf16_f32 v113, v114, v115
    v_cvt_pk_bf16_f32 v114, v116, v117
    v_cvt_pk_bf16_f32 v115, v118, v119
    buffer_load_dword v26, v31, s[24:27], s31 offen sc1
    s_cmp_lg_u32 s101, 0
    s_cbranch_scc1 L_parallel_sum__linear_kernel_hedgehog__glu_gated_glu__prompt_kernel_11_ss3
    buffer_store_dwordx4 v[112:115], v0, s[24:27], s52 offen offset:2048
L_parallel_sum__linear_kernel_hedgehog__glu_gated_glu__prompt_kernel_11_sb3:
    s_mov_b32 s56, 0
L_parallel_sum__linear_kernel_hedgehog__glu_gated_glu__prompt_kernel_11_pre:
    s_waitcnt vmcnt(9)
    v_mfma_f32_16x16x32_bf16 v[12:15], v[72:75], v[80:83], 0
    s_waitcnt vmcnt(8)
    v_mfma_f32_16x16x32_bf16 v[12:15], v[72:75], v[84:87], v[12:15]
    s_waitcnt vmcnt(7)
    v_mfma_f32_16x16x32_bf16 v[12:15], v[72:75], v[88:91], v[12:15]
    s_waitcnt vmcnt(6)
    v_mfma_f32_16x16x32_bf16 v[12:15], v[72:75], v[92:95], v[12:15]
    s_waitcnt vmcnt(5)
    v_mfma_f32_16x16x32_bf16 v[12:15], v[72:75], v[96:99], v[12:15]
    s_waitcnt vmcnt(4)
    v_mfma_f32_16x16x32_bf16 v[12:15], v[72:75], v[100:103], v[12:15]
    s_waitcnt vmcnt(3)
    v_mfma_f32_16x16x32_bf16 v[12:15], v[72:75], v[104:107], v[12:15]
    s_waitcnt vmcnt(2)
    v_mfma_f32_16x16x32_bf16 v[12:15], v[72:75], v[108:111], v[12:15]
    ds_write_b128 v2, v[76:79] offset:1024
    v_mfma_f32_16x16x32_bf16 v[80:83], v[72:75], v[76:79], v[12:15]
    s_nop 5
    v_cvt_pk_bf16_f32 v84, v12, v13
    v_cvt_pk_bf16_f32 v85, v14, v15
    ds_write_b64 v1, v[84:85]
    v_cmp_u_f32 vcc, v80, v80
    s_nop 1
    s_cbranch_vccnz L_parallel_sum__linear_kernel_hedgehog__glu_gated_glu__prompt_kernel_11_rt
L_parallel_sum__linear_kernel_hedgehog__glu_gated_glu__prompt_kernel_11_go:
    v_mov_b32 v27, 3
    s_waitcnt vmcnt(0)
    s_mov_b64 exec, 1
    s_cmp_lg_u32 s101, 0
    s_cbranch_scc1 L_parallel_sum__linear_kernel_hedgehog__glu_gated_glu__prompt_kernel_11_ss4
    buffer_store_dword v27, off, s[24:27], s33
L_parallel_sum__linear_kernel_hedgehog__glu_gated_glu__prompt_kernel_11_sb4:
    s_mov_b64 exec, -1
    s_waitcnt lgkmcnt(0)
    s_barrier
    ds_read_b128 v[80:83], v3 offset:0
    ds_read_b128 v[84:87], v3 offset:16
    ds_read_b128 v[88:91], v3 offset:2048
    ds_read_b128 v[92:95], v3 offset:2064
    s_waitcnt lgkmcnt(3)
    v_mfma_f32_32x32x16_bf16 v[208:223], v[80:83], v[56:59], 0
    s_waitcnt lgkmcnt(2)
    v_mfma_f32_32x32x16_bf16 v[208:223], v[84:87], v[60:63], v[208:223]
    s_waitcnt lgkmcnt(1)
    v_mfma_f32_32x32x16_bf16 v[224:239], v[88:91], v[64:67], 0
    s_waitcnt lgkmcnt(0)
    v_mfma_f32_32x32x16_bf16 v[224:239], v[92:95], v[68:71], v[224:239]
    buffer_load_dword v26, v31, s[24:27], s31 offen sc1
    s_lshl1_add_u32 m0, s39, 49152
    s_add_u32 s42, s18, 65536
    buffer_load_dwordx4 v28, s[48:51], s42 offen lds
    s_lshl1_add_u32 m0, s39, 49152
    s_add_u32 s42, s18, 72704
    buffer_load_dwordx4 v28, s[48:51], s42 offen offset:1024 lds
    s_nop 0
    v_add_f32 v216, v216, v220
    v_add_f32 v217, v217, v221
    v_add_f32 v218, v218, v222
    v_add_f32 v219, v219, v223
    v_add_f32 v216, v216, v217
    v_add_f32 v218, v218, v219
    v_add_f32 v216, v216, v218
    v_mov_b32 v217, v216
    s_nop 1
    v_permlane32_swap_b32 v216, v217
    v_add_f32 v216, v216, v217
    v_add_f32 v216, 0x358637bd, v216
    v_rcp_f32 v216, v216
    s_nop 0
    v_mul_f32 v208, v208, v216
    v_mul_f32 v209, v209, v216
    v_mul_f32 v210, v210, v216
    v_mul_f32 v211, v211, v216
    v_mul_f32 v212, v212, v216
    v_mul_f32 v213, v213, v216
    v_mul_f32 v214, v214, v216
    v_mul_f32 v215, v215, v216
    v_cvt_pk_bf16_f32 v208, v208, v209
    v_cvt_pk_bf16_f32 v209, v210, v211
    v_cvt_pk_bf16_f32 v210, v212, v213
    v_cvt_pk_bf16_f32 v211, v214, v215
    s_cmp_lg_u32 s101, 0
    s_cbranch_scc1 L_parallel_sum__linear_kernel_hedgehog__glu_gated_glu__prompt_kernel_11_ss5
    buffer_store_dwordx4 v[208:211], v0, s[24:27], s35 offen offset:0
L_parallel_sum__linear_kernel_hedgehog__glu_gated_glu__prompt_kernel_11_sb5:
    v_add_f32 v232, v232, v236
    v_add_f32 v233, v233, v237
    v_add_f32 v234, v234, v238
    v_add_f32 v235, v235, v239
    v_add_f32 v232, v232, v233
    v_add_f32 v234, v234, v235
    v_add_f32 v232, v232, v234
    v_mov_b32 v233, v232
    s_nop 1
    v_permlane32_swap_b32 v232, v233
    v_add_f32 v232, v232, v233
    v_add_f32 v232, 0x358637bd, v232
    v_rcp_f32 v232, v232
    s_nop 0
    v_mul_f32 v224, v224, v232
    v_mul_f32 v225, v225, v232
    v_mul_f32 v226, v226, v232
    v_mul_f32 v227, v227, v232
    v_mul_f32 v228, v228, v232
    v_mul_f32 v229, v229, v232
    v_mul_f32 v230, v230, v232
    v_mul_f32 v231, v231, v232
    v_cvt_pk_bf16_f32 v224, v224, v225
    v_cvt_pk_bf16_f32 v225, v226, v227
    v_cvt_pk_bf16_f32 v226, v228, v229
    v_cvt_pk_bf16_f32 v227, v230, v231
    s_cmp_lg_u32 s101, 0
    s_cbranch_scc1 L_parallel_sum__linear_kernel_hedgehog__glu_gated_glu__prompt_kernel_11_ss6
    buffer_store_dwordx4 v[224:227], v0, s[24:27], s35 offen offset:1024
L_parallel_sum__linear_kernel_hedgehog__glu_gated_glu__prompt_kernel_11_sb6:
    s_waitcnt vmcnt(4)
    v_cmp_gt_u32 vcc, 3, v26
    s_and_b32 s57, vcc_lo, 240
    s_cbranch_scc1 L_parallel_sum__linear_kernel_hedgehog__glu_gated_glu__prompt_kernel_11_fp1
L_parallel_sum__linear_kernel_hedgehog__glu_gated_glu__prompt_kernel_11_fb1:
    s_add_u32 s42, s28, 0
    buffer_load_dwordx4 v[96:99], v0, s[24:27], s42 offen
    s_add_u32 s42, s28, 120832
    buffer_load_dwordx4 v[100:103], v0, s[24:27], s42 offen
    v_mov_b32 v27, 4
    s_waitcnt vmcnt(2)
    s_mov_b64 exec, 1
    s_cmp_lg_u32 s101, 0
    s_cbranch_scc1 L_parallel_sum__linear_kernel_hedgehog__glu_gated_glu__prompt_kernel_11_ss7
    buffer_store_dword v27, off, s[24:27], s33
L_parallel_sum__linear_kernel_hedgehog__glu_gated_glu__prompt_kernel_11_sb7:
    s_mov_b64 exec, -1
    s_add_u32 s42, s28, 3072
    buffer_load_dwordx4 v[104:107], v0, s[24:27], s42 offen
    s_add_u32 s42, s28, 123904
    buffer_load_dwordx4 v[108:111], v0, s[24:27], s42 offen
    s_add_u32 s42, s28, 1024
    buffer_load_dwordx4 v[112:115], v0, s[24:27], s42 offen
    s_add_u32 s42, s28, 121856
    buffer_load_dwordx4 v[116:119], v0, s[24:27], s42 offen
    s_add_u32 s42, s28, 4096
    buffer_load_dwordx4 v[120:123], v0, s[24:27], s42 offen
    s_add_u32 s42, s28, 124928
    buffer_load_dwordx4 v[124:127], v0, s[24:27], s42 offen
    s_add_u32 s42, s28, 2048
    buffer_load_dwordx4 v[80:83], v0, s[24:27], s42 offen
    s_add_u32 s42, s28, 122880
    buffer_load_dwordx4 v[84:87], v0, s[24:27], s42 offen
    s_add_u32 s42, s28, 5120
    buffer_load_dwordx4 v[88:91], v0, s[24:27], s42 offen
    s_add_u32 s42, s28, 125952
    buffer_load_dwordx4 v[92:95], v0, s[24:27], s42 offen
    buffer_load_dword v26, v31, s[24:27], s31 offen sc1
    s_waitcnt vmcnt(13)
    v_mfma_f32_32x32x16_bf16 v[208:223], v[128:131], v[96:99], 0
    s_waitcnt vmcnt(12)
    v_mfma_f32_32x32x16_bf16 v[240:255], v[128:131], v[100:103], 0
    v_mfma_f32_32x32x16_bf16 v[224:239], v[132:135], v[96:99], 0
    v_mfma_f32_32x32x16_bf16 v[32:47], v[132:135], v[100:103], 0
    s_waitcnt vmcnt(10)
    v_mfma_f32_32x32x16_bf16 v[208:223], v[136:139], v[104:107], v[208:223]
    s_waitcnt vmcnt(9)
    v_mfma_f32_32x32x16_bf16 v[240:255], v[136:139], v[108:111], v[240:255]
    v_mfma_f32_32x32x16_bf16 v[224:239], v[140:143], v[104:107], v[224:239]
    v_mfma_f32_32x32x16_bf16 v[32:47], v[140:143], v[108:111], v[32:47]
    s_waitcnt vmcnt(8)
    v_mfma_f32_32x32x16_bf16 v[208:223], v[144:147], v[112:115], v[208:223]
    s_waitcnt vmcnt(7)
    v_mfma_f32_32x32x16_bf16 v[240:255], v[144:147], v[116:119], v[240:255]
    v_mfma_f32_32x32x16_bf16 v[224:239], v[148:151], v[112:115], v[224:239]
    v_mfma_f32_32x32x16_bf16 v[32:47], v[148:151], v[116:119], v[32:47]
    s_waitcnt vmcnt(6)
    v_mfma_f32_32x32x16_bf16 v[208:223], v[152:155], v[120:123], v[208:223]
    s_waitcnt vmcnt(5)
    v_mfma_f32_32x32x16_bf16 v[240:255], v[152:155], v[124:127], v[240:255]
    v_mfma_f32_32x32x16_bf16 v[224:239], v[156:159], v[120:123], v[224:239]
    v_mfma_f32_32x32x16_bf16 v[32:47], v[156:159], v[124:127], v[32:47]
    ds_read_b64_tr_b16 v[128:129], v29 offset:32896
    ds_read_b64_tr_b16 v[130:131], v29 offset:33408
    ds_read_b64_tr_b16 v[132:133], v30 offset:32896
    ds_read_b64_tr_b16 v[134:135], v30 offset:33408
    ds_read_b64_tr_b16 v[136:137], v29 offset:49280
    ds_read_b64_tr_b16 v[138:139], v29 offset:49792
    ds_read_b64_tr_b16 v[140:141], v30 offset:49280
    ds_read_b64_tr_b16 v[142:143], v30 offset:49792
    v_add_u32 v5, 4294950912, v29
    v_add_u32 v6, 4294950912, v30
    ds_read_b64_tr_b16 v[144:145], v5 offset:0
    ds_read_b64_tr_b16 v[146:147], v5 offset:512
    ds_read_b64_tr_b16 v[148:149], v6 offset:0
    ds_read_b64_tr_b16 v[150:151], v6 offset:512
    ds_read_b64_tr_b16 v[152:153], v29 offset:0
    ds_read_b64_tr_b16 v[154:155], v29 offset:512
    ds_read_b64_tr_b16 v[156:157], v30 offset:0
    ds_read_b64_tr_b16 v[158:159], v30 offset:512
    s_waitcnt vmcnt(0)
    v_cmp_gt_u32 vcc, 4, v26
    s_and_b32 s57, vcc_lo, 240
    s_cbranch_scc1 L_parallel_sum__linear_kernel_hedgehog__glu_gated_glu__prompt_kernel_11_fp2
L_parallel_sum__linear_kernel_hedgehog__glu_gated_glu__prompt_kernel_11_fb2:
    s_add_u32 s42, s29, 0
    buffer_load_dwordx4 v[48:51], v0, s[24:27], s42 offen
    s_add_u32 s42, s29, 120832
    buffer_load_dwordx4 v[52:55], v0, s[24:27], s42 offen
    v_mfma_f32_32x32x16_bf16 v[208:223], v[160:163], v[80:83], v[208:223]
    v_mfma_f32_32x32x16_bf16 v[240:255], v[160:163], v[84:87], v[240:255]
    v_mfma_f32_32x32x16_bf16 v[224:239], v[164:167], v[80:83], v[224:239]
    v_mfma_f32_32x32x16_bf16 v[32:47], v[164:167], v[84:87], v[32:47]
    s_add_u32 s42, s29, 1024
    buffer_load_dwordx4 v[56:59], v0, s[24:27], s42 offen
    s_add_u32 s42, s29, 121856
    buffer_load_dwordx4 v[60:63], v0, s[24:27], s42 offen
    s_add_u32 s42, s29, 2048
    buffer_load_dwordx4 v[64:67], v0, s[24:27], s42 offen
    s_add_u32 s42, s29, 122880
    buffer_load_dwordx4 v[68:71], v0, s[24:27], s42 offen
    v_mfma_f32_32x32x16_bf16 v[208:223], v[168:171], v[88:91], v[208:223]
    v_mfma_f32_32x32x16_bf16 v[240:255], v[168:171], v[92:95], v[240:255]
    v_mfma_f32_32x32x16_bf16 v[224:239], v[172:175], v[88:91], v[224:239]
    v_mfma_f32_32x32x16_bf16 v[32:47], v[172:175], v[92:95], v[32:47]
    s_add_u32 s42, s29, 3072
    buffer_load_dwordx4 v[72:75], v0, s[24:27], s42 offen
    s_add_u32 s42, s29, 123904
    buffer_load_dwordx4 v[76:79], v0, s[24:27], s42 offen
    v_add_u32 v5, 4294926144, v29
    v_add_u32 v6, 4294926144, v30
    ds_read_b64_tr_b16 v[160:161], v5 offset:0
    ds_read_b64_tr_b16 v[162:163], v5 offset:512
    ds_read_b64_tr_b16 v[164:165], v6 offset:0
    ds_read_b64_tr_b16 v[166:167], v6 offset:512
    v_and_b32 v4, 48, v0
    v_bfe_u32 v13, v0, 6, 2
    v_lshl_add_u32 v4, v13, 10, v4
    v_bfe_u32 v7, v0, 8, 1
    v_lshl_add_u32 v4, v7, 6, v4
    v_bfe_u32 v7, v0, 9, 1
    v_lshl_add_u32 v4, v7, 12, v4
    buffer_load_dwordx4 v[8:11], v4, s[8:11], s0 offen
    v_bfe_u32 v7, v0, 8, 2
    v_lshlrev_b32 v7, 11, v7
    v_lshl_add_u32 v7, v13, 4, v7
    v_lshl_add_u32 v7, s37, 7, v7
    v_bfe_u32 v13, v0, 4, 2
    v_mov_b32 v12, 73984
    v_mov_b32 v14, 90432
    v_cmp_eq_u32 vcc, 1, v13
    s_nop 1
    v_cndmask_b32 v12, v12, v14, vcc
    v_mov_b32 v14, 123264
    v_cmp_eq_u32 vcc, 2, v13
    s_nop 1
    v_cndmask_b32 v12, v12, v14, vcc
    v_mov_b32 v14, 139712
    v_cmp_eq_u32 vcc, 3, v13
    s_nop 1
    v_cndmask_b32 v12, v12, v14, vcc
    v_add_u32 v12, v12, v7
    v_and_b32 v14, 16, v0
    v_mov_b32 v7, 0x3f80
    v_lshlrev_b32 v14, v14, v7
    v_bfe_u32 v7, v0, 5, 3
    v_cmp_eq_u32 vcc, 0, v7
    s_nop 1
    v_cndmask_b32 v168, 0, v14, vcc
    v_cmp_eq_u32 vcc, 1, v7
    s_nop 1
    v_cndmask_b32 v169, 0, v14, vcc
    v_cmp_eq_u32 vcc, 2, v7
    s_nop 1
    v_cndmask_b32 v170, 0, v14, vcc
    v_cmp_eq_u32 vcc, 3, v7
    s_nop 1
    v_cndmask_b32 v171, 0, v14, vcc
    v_cmp_eq_u32 vcc, 4, v7
    s_nop 1
    v_cndmask_b32 v172, 0, v14, vcc
    v_cmp_eq_u32 vcc, 5, v7
    s_nop 1
    v_cndmask_b32 v173, 0, v14, vcc
    v_cmp_eq_u32 vcc, 6, v7
    s_nop 1
    v_cndmask_b32 v174, 0, v14, vcc
    v_cmp_eq_u32 vcc, 7, v7
    s_nop 1
    v_cndmask_b32 v175, 0, v14, vcc
    v_cmp_gt_u32 vcc, 3, v26
    s_and_b32 s57, vcc_lo, 15
    s_cbranch_scc1 L_parallel_sum__linear_kernel_hedgehog__glu_gated_glu__prompt_kernel_11_fp3
L_parallel_sum__linear_kernel_hedgehog__glu_gated_glu__prompt_kernel_11_fb3:
    s_add_u32 s42, s30, 2048
    buffer_load_dwordx4 v[96:99], v0, s[24:27], s42 offen
    s_add_u32 s42, s30, 122880
    buffer_load_dwordx4 v[100:103], v0, s[24:27], s42 offen
    s_waitcnt vmcnt(10)
    v_mfma_f32_32x32x16_bf16 v[208:223], v[176:179], v[48:51], v[208:223]
    s_waitcnt vmcnt(9)
    v_mfma_f32_32x32x16_bf16 v[240:255], v[176:179], v[52:55], v[240:255]
    v_mfma_f32_32x32x16_bf16 v[224:239], v[180:183], v[48:51], v[224:239]
    v_mfma_f32_32x32x16_bf16 v[32:47], v[180:183], v[52:55], v[32:47]
    s_add_u32 s42, s36, 0
    buffer_load_dwordx4 v[104:107], v0, s[24:27], s42 offen
    s_add_u32 s42, s36, 120832
    buffer_load_dwordx4 v[108:111], v0, s[24:27], s42 offen
    s_waitcnt vmcnt(10)
    v_mfma_f32_32x32x16_bf16 v[208:223], v[184:187], v[56:59], v[208:223]
    s_waitcnt vmcnt(9)
    v_mfma_f32_32x32x16_bf16 v[240:255], v[184:187], v[60:63], v[240:255]
    v_mfma_f32_32x32x16_bf16 v[224:239], v[188:191], v[56:59], v[224:239]
    v_mfma_f32_32x32x16_bf16 v[32:47], v[188:191], v[60:63], v[32:47]
    s_add_u32 s42, s30, 3072
    buffer_load_dwordx4 v[112:115], v0, s[24:27], s42 offen
    s_add_u32 s42, s30, 123904
    buffer_load_dwordx4 v[116:119], v0, s[24:27], s42 offen
    s_waitcnt vmcnt(10)
    v_mfma_f32_32x32x16_bf16 v[208:223], v[192:195], v[64:67], v[208:223]
    s_waitcnt vmcnt(9)
    v_mfma_f32_32x32x16_bf16 v[240:255], v[192:195], v[68:71], v[240:255]
    v_mfma_f32_32x32x16_bf16 v[224:239], v[196:199], v[64:67], v[224:239]
    v_mfma_f32_32x32x16_bf16 v[32:47], v[196:199], v[68:71], v[32:47]
    s_add_u32 s42, s36, 1024
    buffer_load_dwordx4 v[120:123], v0, s[24:27], s42 offen
    s_add_u32 s42, s36, 121856
    buffer_load_dwordx4 v[124:127], v0, s[24:27], s42 offen
    s_waitcnt vmcnt(10)
    v_mfma_f32_32x32x16_bf16 v[208:223], v[200:203], v[72:75], v[208:223]
    s_waitcnt vmcnt(9)
    v_mfma_f32_32x32x16_bf16 v[240:255], v[200:203], v[76:79], v[240:255]
    v_mfma_f32_32x32x16_bf16 v[224:239], v[204:207], v[72:75], v[224:239]
    v_mfma_f32_32x32x16_bf16 v[32:47], v[204:207], v[76:79], v[32:47]
    s_add_u32 s42, s30, 4096
    buffer_load_dwordx4 v[80:83], v0, s[24:27], s42 offen
    s_add_u32 s42, s30, 124928
    buffer_load_dwordx4 v[84:87], v0, s[24:27], s42 offen
    s_waitcnt vmcnt(9) lgkmcnt(15)
    v_mfma_f32_32x32x16_bf16 v[208:223], v[128:131], v[96:99], v[208:223]
    s_waitcnt vmcnt(8)
    v_mfma_f32_32x32x16_bf16 v[240:255], v[128:131], v[100:103], v[240:255]
    v_mfma_f32_32x32x16_bf16 v[224:239], v[132:135], v[96:99], v[224:239]
    v_mfma_f32_32x32x16_bf16 v[32:47], v[132:135], v[100:103], v[32:47]
    s_waitcnt vmcnt(7) lgkmcnt(14)
    v_mfma_f32_32x32x16_bf16 v[208:223], v[136:139], v[104:107], v[208:223]
    s_waitcnt vmcnt(6)
    v_mfma_f32_32x32x16_bf16 v[240:255], v[136:139], v[108:111], v[240:255]
    s_waitcnt lgkmcnt(12)
    v_mfma_f32_32x32x16_bf16 v[224:239], v[140:143], v[104:107], v[224:239]
    v_mfma_f32_32x32x16_bf16 v[32:47], v[140:143], v[108:111], v[32:47]
    s_waitcnt vmcnt(5) lgkmcnt(10)
    v_mfma_f32_32x32x16_bf16 v[208:223], v[144:147], v[112:115], v[208:223]
    s_waitcnt vmcnt(4)
    v_mfma_f32_32x32x16_bf16 v[240:255], v[144:147], v[116:119], v[240:255]
    s_waitcnt lgkmcnt(8)
    v_mfma_f32_32x32x16_bf16 v[224:239], v[148:151], v[112:115], v[224:239]
    v_mfma_f32_32x32x16_bf16 v[32:47], v[148:151], v[116:119], v[32:47]
    s_lshl_b32 s56, s39, 1
    s_sub_u32 s56, s56, 122880
    v_add_u32 v5, s56, v0
    v_add_u32 v6, 73920, v5
    v_add_u32 v7, 123200, v5
    s_waitcnt vmcnt(3) lgkmcnt(6)
    v_mfma_f32_32x32x16_bf16 v[208:223], v[152:155], v[120:123], v[208:223]
    s_waitcnt vmcnt(1) lgkmcnt(2)
    v_mfma_f32_32x32x16_bf16 v[208:223], v[160:163], v[80:83], v[208:223]
    v_mfma_f32_32x32x16_bf16 v[240:255], v[152:155], v[124:127], v[240:255]
    s_waitcnt vmcnt(0)
    v_mfma_f32_32x32x16_bf16 v[240:255], v[160:163], v[84:87], v[240:255]
    s_nop 8
    v_cvt_pk_bf16_f32 v208, v208, v209
    v_cvt_pk_bf16_f32 v209, v210, v211
    v_cvt_pk_bf16_f32 v210, v212, v213
    v_cvt_pk_bf16_f32 v211, v214, v215
    ds_write_b128 v5, v[208:211] offset:0
    v_cvt_pk_bf16_f32 v216, v216, v217
    v_cvt_pk_bf16_f32 v217, v218, v219
    v_cvt_pk_bf16_f32 v218, v220, v221
    v_cvt_pk_bf16_f32 v219, v222, v223
    ds_write_b128 v5, v[216:219] offset:16448
    v_mfma_f32_32x32x16_bf16 v[224:239], v[156:159], v[120:123], v[224:239]
    s_waitcnt lgkmcnt(2)
    v_mfma_f32_32x32x16_bf16 v[224:239], v[164:167], v[80:83], v[224:239]
    v_cvt_pk_bf16_f32 v240, v240, v241
    v_cvt_pk_bf16_f32 v241, v242, v243
    v_cvt_pk_bf16_f32 v242, v244, v245
    v_cvt_pk_bf16_f32 v243, v246, v247
    ds_write_b128 v6, v[240:243] offset:64
    v_cvt_pk_bf16_f32 v248, v248, v249
    v_cvt_pk_bf16_f32 v249, v250, v251
    v_cvt_pk_bf16_f32 v250, v252, v253
    v_cvt_pk_bf16_f32 v251, v254, v255
    ds_write_b128 v6, v[248:251] offset:16512
    v_mfma_f32_32x32x16_bf16 v[32:47], v[156:159], v[124:127], v[32:47]
    v_mfma_f32_32x32x16_bf16 v[32:47], v[164:167], v[84:87], v[32:47]
    v_cvt_pk_bf16_f32 v224, v224, v225
    v_cvt_pk_bf16_f32 v225, v226, v227
    v_cvt_pk_bf16_f32 v226, v228, v229
    v_cvt_pk_bf16_f32 v227, v230, v231
    ds_write_b128 v5, v[224:227] offset:32896
    v_cvt_pk_bf16_f32 v232, v232, v233
    v_cvt_pk_bf16_f32 v233, v234, v235
    v_cvt_pk_bf16_f32 v234, v236, v237
    v_cvt_pk_bf16_f32 v235, v238, v239
    ds_write_b128 v5, v[232:235] offset:49344
    v_lshlrev_b32 v16, 16, v8
    v_and_b32 v17, s55, v8
    v_lshlrev_b32 v18, 16, v9
    v_and_b32 v19, s55, v9
    v_lshlrev_b32 v20, 16, v10
    v_and_b32 v21, s55, v10
    v_lshlrev_b32 v22, 16, v11
    v_and_b32 v23, s55, v11
    v_cvt_pk_bf16_f32 v32, v32, v33
    v_cvt_pk_bf16_f32 v33, v34, v35
    v_cvt_pk_bf16_f32 v34, v36, v37
    v_cvt_pk_bf16_f32 v35, v38, v39
    ds_write_b128 v7, v[32:35] offset:64
    v_cvt_pk_bf16_f32 v40, v40, v41
    v_cvt_pk_bf16_f32 v41, v42, v43
    v_cvt_pk_bf16_f32 v42, v44, v45
    v_cvt_pk_bf16_f32 v43, v46, v47
    ds_write_b128 v7, v[40:43] offset:16512
    s_waitcnt lgkmcnt(0)
    s_barrier
    ds_read_b128 v[128:131], v12 offset:0
    ds_read_b128 v[132:135], v12 offset:512
    ds_read_b128 v[136:139], v12 offset:64
    ds_read_b128 v[140:143], v12 offset:576
    ds_read_b128 v[144:147], v12 offset:8192
    ds_read_b128 v[148:151], v12 offset:8704
    ds_read_b128 v[152:155], v12 offset:8256
    ds_read_b128 v[156:159], v12 offset:8768
    s_waitcnt lgkmcnt(7)
    v_mfma_f32_16x16x32_bf16 v[16:19], v[168:171], v[128:131], v[16:19]
    s_waitcnt lgkmcnt(6)
    v_mfma_f32_16x16x32_bf16 v[20:23], v[168:171], v[132:135], v[20:23]
    s_waitcnt lgkmcnt(5)
    v_mfma_f32_16x16x32_bf16 v[16:19], v[172:175], v[136:139], v[16:19]
    s_waitcnt lgkmcnt(4)
    v_mfma_f32_16x16x32_bf16 v[20:23], v[172:175], v[140:143], v[20:23]
    s_waitcnt lgkmcnt(3)
    v_mfma_f32_16x16x32_bf16 v[16:19], v[168:171], v[144:147], v[16:19]
    s_waitcnt lgkmcnt(2)
    v_mfma_f32_16x16x32_bf16 v[20:23], v[168:171], v[148:151], v[20:23]
    s_waitcnt lgkmcnt(1)
    v_mfma_f32_16x16x32_bf16 v[16:19], v[172:175], v[152:155], v[16:19]
    s_waitcnt lgkmcnt(0)
    v_mfma_f32_16x16x32_bf16 v[20:23], v[172:175], v[156:159], v[20:23]
    s_nop 5
    v_cvt_pk_bf16_f32 v16, v16, v17
    v_cvt_pk_bf16_f32 v17, v18, v19
    v_cvt_pk_bf16_f32 v18, v20, v21
    v_cvt_pk_bf16_f32 v19, v22, v23
    buffer_store_dwordx4 v[16:19], v4, s[12:15], s0 offen sc1
    s_endpgm
L_parallel_sum__linear_kernel_hedgehog__glu_gated_glu__prompt_kernel_00_ss1:
    s_nop 4
    buffer_store_dwordx2 v[56:57], v0, s[24:27], s52 offen offset:2048 sc1
    s_nop 4
    s_branch L_parallel_sum__linear_kernel_hedgehog__glu_gated_glu__prompt_kernel_00_sb1
L_parallel_sum__linear_kernel_hedgehog__glu_gated_glu__prompt_kernel_00_ss2:
    s_nop 4
    buffer_store_dwordx4 v[80:83], v0, s[24:27], s34 offen offset:0 sc1
    s_nop 4
    s_branch L_parallel_sum__linear_kernel_hedgehog__glu_gated_glu__prompt_kernel_00_sb2
L_parallel_sum__linear_kernel_hedgehog__glu_gated_glu__prompt_kernel_00_ss3:
    s_nop 4
    buffer_store_dwordx4 v[96:99], v0, s[24:27], s34 offen offset:1024 sc1
    s_nop 4
    s_branch L_parallel_sum__linear_kernel_hedgehog__glu_gated_glu__prompt_kernel_00_sb3
L_parallel_sum__linear_kernel_hedgehog__glu_gated_glu__prompt_kernel_00_ss4:
    s_nop 4
    buffer_store_dword v30, off, s[24:27], s33 sc1
    s_nop 4
    s_branch L_parallel_sum__linear_kernel_hedgehog__glu_gated_glu__prompt_kernel_00_sb4
L_parallel_sum__linear_kernel_hedgehog__glu_gated_glu__prompt_kernel_00_cp:
    s_mov_b32 s41, 0
L_parallel_sum__linear_kernel_hedgehog__glu_gated_glu__prompt_kernel_00_cpl:
    s_sleep 16
    buffer_load_dword v30, v29, s[4:7], 0 offen sc1
    s_and_b32 s101, s2, 7
    s_waitcnt vmcnt(0)
    v_readlane_b32 s101, v30, s101
    v_and_b32 v30, 0xff, v30
    v_cmp_gt_u32 vcc, 32, v30
    s_lshl_b32 s57, s100, 5
    s_sub_u32 s101, s101, s57
    s_cbranch_vccz L_parallel_sum__linear_kernel_hedgehog__glu_gated_glu__prompt_kernel_00_cb
    s_add_u32 s41, s41, 1
    s_cmp_lt_u32 s41, 20000
    s_cbranch_scc1 L_parallel_sum__linear_kernel_hedgehog__glu_gated_glu__prompt_kernel_00_cpl
    s_branch L_parallel_sum__linear_kernel_hedgehog__glu_gated_glu__prompt_kernel_00_cb
L_parallel_sum__linear_kernel_hedgehog__glu_gated_glu__prompt_kernel_00_fp1:
    s_mov_b32 s41, 0
L_parallel_sum__linear_kernel_hedgehog__glu_gated_glu__prompt_kernel_00_fp1l:
    s_sleep 2
    buffer_load_dword v29, v28, s[24:27], s31 offen sc1
    s_waitcnt vmcnt(0)
    v_cmp_gt_u32 vcc, 3, v29
    s_and_b32 s57, vcc_lo, 240
    s_cbranch_scc0 L_parallel_sum__linear_kernel_hedgehog__glu_gated_glu__prompt_kernel_00_fb1
    s_add_u32 s41, s41, 1
    s_cmp_lt_u32 s41, 20000
    s_cbranch_scc1 L_parallel_sum__linear_kernel_hedgehog__glu_gated_glu__prompt_kernel_00_fp1l
    s_branch L_parallel_sum__linear_kernel_hedgehog__glu_gated_glu__prompt_kernel_00_fb1
L_parallel_sum__linear_kernel_hedgehog__glu_gated_glu__prompt_kernel_00_fp2:
    s_mov_b32 s41, 0
L_parallel_sum__linear_kernel_hedgehog__glu_gated_glu__prompt_kernel_00_fp2l:
    s_sleep 2
    buffer_load_dword v29, v28, s[24:27], s31 offen sc1
    s_waitcnt vmcnt(0)
    v_cmp_gt_u32 vcc, 4, v29
    s_and_b32 s57, vcc_lo, 240
    s_cbranch_scc0 L_parallel_sum__linear_kernel_hedgehog__glu_gated_glu__prompt_kernel_00_fb2
    s_add_u32 s41, s41, 1
    s_cmp_lt_u32 s41, 20000
    s_cbranch_scc1 L_parallel_sum__linear_kernel_hedgehog__glu_gated_glu__prompt_kernel_00_fp2l
    s_branch L_parallel_sum__linear_kernel_hedgehog__glu_gated_glu__prompt_kernel_00_fb2
L_parallel_sum__linear_kernel_hedgehog__glu_gated_glu__prompt_kernel_00_fp3:
    s_mov_b32 s41, 0
L_parallel_sum__linear_kernel_hedgehog__glu_gated_glu__prompt_kernel_00_fp3l:
    s_sleep 2
    buffer_load_dword v29, v28, s[24:27], s31 offen sc1
    s_waitcnt vmcnt(0)
    v_cmp_gt_u32 vcc, 3, v29
    s_and_b32 s57, vcc_lo, 15
    s_cbranch_scc0 L_parallel_sum__linear_kernel_hedgehog__glu_gated_glu__prompt_kernel_00_fb3
    s_add_u32 s41, s41, 1
    s_cmp_lt_u32 s41, 20000
    s_cbranch_scc1 L_parallel_sum__linear_kernel_hedgehog__glu_gated_glu__prompt_kernel_00_fp3l
    s_branch L_parallel_sum__linear_kernel_hedgehog__glu_gated_glu__prompt_kernel_00_fb3
L_parallel_sum__linear_kernel_hedgehog__glu_gated_glu__prompt_kernel_01_ss1:
    s_nop 4
    buffer_store_dwordx2 v[56:57], v0, s[24:27], s52 offen offset:8 sc1
    s_nop 4
    s_branch L_parallel_sum__linear_kernel_hedgehog__glu_gated_glu__prompt_kernel_01_sb1
L_parallel_sum__linear_kernel_hedgehog__glu_gated_glu__prompt_kernel_01_ss2:
    s_nop 4
    buffer_store_dwordx4 v[80:83], v0, s[24:27], s52 offen offset:1024 sc1
    s_nop 4
    s_branch L_parallel_sum__linear_kernel_hedgehog__glu_gated_glu__prompt_kernel_01_sb2
L_parallel_sum__linear_kernel_hedgehog__glu_gated_glu__prompt_kernel_01_ss3:
    s_nop 4
    buffer_store_dwordx4 v[96:99], v0, s[24:27], s52 offen offset:2048 sc1
    s_nop 4
    s_branch L_parallel_sum__linear_kernel_hedgehog__glu_gated_glu__prompt_kernel_01_sb3
L_parallel_sum__linear_kernel_hedgehog__glu_gated_glu__prompt_kernel_01_ss4:
    s_nop 4
    buffer_store_dword v30, off, s[24:27], s33 sc1
    s_nop 4
    s_branch L_parallel_sum__linear_kernel_hedgehog__glu_gated_glu__prompt_kernel_01_sb4
L_parallel_sum__linear_kernel_hedgehog__glu_gated_glu__prompt_kernel_01_cp:
    s_mov_b32 s41, 0
L_parallel_sum__linear_kernel_hedgehog__glu_gated_glu__prompt_kernel_01_cpl:
    s_sleep 16
    buffer_load_dword v30, v29, s[4:7], 0 offen sc1
    s_and_b32 s101, s2, 7
    s_waitcnt vmcnt(0)
    v_readlane_b32 s101, v30, s101
    v_and_b32 v30, 0xff, v30
    v_cmp_gt_u32 vcc, 32, v30
    s_lshl_b32 s57, s100, 5
    s_sub_u32 s101, s101, s57
    s_cbranch_vccz L_parallel_sum__linear_kernel_hedgehog__glu_gated_glu__prompt_kernel_01_cb
    s_add_u32 s41, s41, 1
    s_cmp_lt_u32 s41, 20000
    s_cbranch_scc1 L_parallel_sum__linear_kernel_hedgehog__glu_gated_glu__prompt_kernel_01_cpl
    s_branch L_parallel_sum__linear_kernel_hedgehog__glu_gated_glu__prompt_kernel_01_cb
L_parallel_sum__linear_kernel_hedgehog__glu_gated_glu__prompt_kernel_01_fp1:
    s_mov_b32 s41, 0
L_parallel_sum__linear_kernel_hedgehog__glu_gated_glu__prompt_kernel_01_fp1l:
    s_sleep 2
    buffer_load_dword v29, v28, s[24:27], s31 offen sc1
    s_waitcnt vmcnt(0)
    v_cmp_gt_u32 vcc, 3, v29
    s_and_b32 s57, vcc_lo, 240
    s_cbranch_scc0 L_parallel_sum__linear_kernel_hedgehog__glu_gated_glu__prompt_kernel_01_fb1
    s_add_u32 s41, s41, 1
    s_cmp_lt_u32 s41, 20000
    s_cbranch_scc1 L_parallel_sum__linear_kernel_hedgehog__glu_gated_glu__prompt_kernel_01_fp1l
    s_branch L_parallel_sum__linear_kernel_hedgehog__glu_gated_glu__prompt_kernel_01_fb1
L_parallel_sum__linear_kernel_hedgehog__glu_gated_glu__prompt_kernel_01_fp2:
    s_mov_b32 s41, 0
L_parallel_sum__linear_kernel_hedgehog__glu_gated_glu__prompt_kernel_01_fp2l:
    s_sleep 2
    buffer_load_dword v29, v28, s[24:27], s31 offen sc1
    s_waitcnt vmcnt(0)
    v_cmp_gt_u32 vcc, 4, v29
    s_and_b32 s57, vcc_lo, 240
    s_cbranch_scc0 L_parallel_sum__linear_kernel_hedgehog__glu_gated_glu__prompt_kernel_01_fb2
    s_add_u32 s41, s41, 1
    s_cmp_lt_u32 s41, 20000
    s_cbranch_scc1 L_parallel_sum__linear_kernel_hedgehog__glu_gated_glu__prompt_kernel_01_fp2l
    s_branch L_parallel_sum__linear_kernel_hedgehog__glu_gated_glu__prompt_kernel_01_fb2
L_parallel_sum__linear_kernel_hedgehog__glu_gated_glu__prompt_kernel_01_fp3:
    s_mov_b32 s41, 0
L_parallel_sum__linear_kernel_hedgehog__glu_gated_glu__prompt_kernel_01_fp3l:
    s_sleep 2
    buffer_load_dword v29, v28, s[24:27], s31 offen sc1
    s_waitcnt vmcnt(0)
    v_cmp_gt_u32 vcc, 3, v29
    s_and_b32 s57, vcc_lo, 15
    s_cbranch_scc0 L_parallel_sum__linear_kernel_hedgehog__glu_gated_glu__prompt_kernel_01_fb3
    s_add_u32 s41, s41, 1
    s_cmp_lt_u32 s41, 20000
    s_cbranch_scc1 L_parallel_sum__linear_kernel_hedgehog__glu_gated_glu__prompt_kernel_01_fp3l
    s_branch L_parallel_sum__linear_kernel_hedgehog__glu_gated_glu__prompt_kernel_01_fb3
L_parallel_sum__linear_kernel_hedgehog__glu_gated_glu__prompt_kernel_10_ss1:
    s_nop 4
    buffer_store_dwordx4 v[80:83], v0, s[24:27], s52 offen offset:0 sc1
    s_nop 4
    s_branch L_parallel_sum__linear_kernel_hedgehog__glu_gated_glu__prompt_kernel_10_sb1
L_parallel_sum__linear_kernel_hedgehog__glu_gated_glu__prompt_kernel_10_ss2:
    s_nop 4
    buffer_store_dwordx4 v[96:99], v0, s[24:27], s52 offen offset:1024 sc1
    s_nop 4
    s_branch L_parallel_sum__linear_kernel_hedgehog__glu_gated_glu__prompt_kernel_10_sb2
L_parallel_sum__linear_kernel_hedgehog__glu_gated_glu__prompt_kernel_10_ss3:
    s_nop 4
    buffer_store_dwordx4 v[112:115], v0, s[24:27], s52 offen offset:2048 sc1
    s_nop 4
    s_branch L_parallel_sum__linear_kernel_hedgehog__glu_gated_glu__prompt_kernel_10_sb3
L_parallel_sum__linear_kernel_hedgehog__glu_gated_glu__prompt_kernel_10_ss4:
    s_nop 4
    buffer_store_dword v27, off, s[24:27], s33 sc1
    s_nop 4
    s_branch L_parallel_sum__linear_kernel_hedgehog__glu_gated_glu__prompt_kernel_10_sb4
L_parallel_sum__linear_kernel_hedgehog__glu_gated_glu__prompt_kernel_10_ss5:
    s_nop 4
    buffer_store_dwordx4 v[208:211], v0, s[24:27], s35 offen offset:0 sc1
    s_nop 4
    s_branch L_parallel_sum__linear_kernel_hedgehog__glu_gated_glu__prompt_kernel_10_sb5
L_parallel_sum__linear_kernel_hedgehog__glu_gated_glu__prompt_kernel_10_ss6:
    s_nop 4
    buffer_store_dwordx4 v[224:227], v0, s[24:27], s35 offen offset:1024 sc1
    s_nop 4
    s_branch L_parallel_sum__linear_kernel_hedgehog__glu_gated_glu__prompt_kernel_10_sb6
L_parallel_sum__linear_kernel_hedgehog__glu_gated_glu__prompt_kernel_10_ss7:
    s_nop 4
    buffer_store_dword v27, off, s[24:27], s33 sc1
    s_nop 4
    s_branch L_parallel_sum__linear_kernel_hedgehog__glu_gated_glu__prompt_kernel_10_sb7
L_parallel_sum__linear_kernel_hedgehog__glu_gated_glu__prompt_kernel_10_cp:
    s_mov_b32 s41, 0
L_parallel_sum__linear_kernel_hedgehog__glu_gated_glu__prompt_kernel_10_cpl:
    s_sleep 16
    buffer_load_dword v27, v26, s[4:7], 0 offen sc1
    s_and_b32 s101, s2, 7
    s_waitcnt vmcnt(0)
    v_readlane_b32 s101, v27, s101
    v_and_b32 v27, 0xff, v27
    v_cmp_gt_u32 vcc, 32, v27
    s_lshl_b32 s57, s100, 5
    s_sub_u32 s101, s101, s57
    s_cbranch_vccz L_parallel_sum__linear_kernel_hedgehog__glu_gated_glu__prompt_kernel_10_cb
    s_add_u32 s41, s41, 1
    s_cmp_lt_u32 s41, 20000
    s_cbranch_scc1 L_parallel_sum__linear_kernel_hedgehog__glu_gated_glu__prompt_kernel_10_cpl
    s_branch L_parallel_sum__linear_kernel_hedgehog__glu_gated_glu__prompt_kernel_10_cb
L_parallel_sum__linear_kernel_hedgehog__glu_gated_glu__prompt_kernel_10_fp1:
    v_mov_b32 v27, 4
    s_waitcnt vmcnt(0)
    s_mov_b64 exec, 1
    s_cmp_lg_u32 s101, 0
    s_cbranch_scc1 L_parallel_sum__linear_kernel_hedgehog__glu_gated_glu__prompt_kernel_10_fo0
    buffer_store_dword v27, off, s[24:27], s33
    s_branch L_parallel_sum__linear_kernel_hedgehog__glu_gated_glu__prompt_kernel_10_fq0
L_parallel_sum__linear_kernel_hedgehog__glu_gated_glu__prompt_kernel_10_fo0:
    buffer_store_dword v27, off, s[24:27], s33 sc1
L_parallel_sum__linear_kernel_hedgehog__glu_gated_glu__prompt_kernel_10_fq0:
    s_mov_b64 exec, -1
    s_mov_b32 s41, 0
L_parallel_sum__linear_kernel_hedgehog__glu_gated_glu__prompt_kernel_10_fp1l:
    s_sleep 2
    buffer_load_dword v26, v31, s[24:27], s31 offen sc1
    s_waitcnt vmcnt(0)
    v_cmp_gt_u32 vcc, 3, v26
    s_and_b32 s57, vcc_lo, 240
    s_cbranch_scc0 L_parallel_sum__linear_kernel_hedgehog__glu_gated_glu__prompt_kernel_10_fb1
    s_add_u32 s41, s41, 1
    s_cmp_lt_u32 s41, 20000
    s_cbranch_scc1 L_parallel_sum__linear_kernel_hedgehog__glu_gated_glu__prompt_kernel_10_fp1l
    s_branch L_parallel_sum__linear_kernel_hedgehog__glu_gated_glu__prompt_kernel_10_fb1
L_parallel_sum__linear_kernel_hedgehog__glu_gated_glu__prompt_kernel_10_fp2:
    s_mov_b32 s41, 0
L_parallel_sum__linear_kernel_hedgehog__glu_gated_glu__prompt_kernel_10_fp2l:
    s_sleep 2
    buffer_load_dword v26, v31, s[24:27], s31 offen sc1
    s_waitcnt vmcnt(0)
    v_cmp_gt_u32 vcc, 4, v26
    s_and_b32 s57, vcc_lo, 240
    s_cbranch_scc0 L_parallel_sum__linear_kernel_hedgehog__glu_gated_glu__prompt_kernel_10_fb2
    s_add_u32 s41, s41, 1
    s_cmp_lt_u32 s41, 20000
    s_cbranch_scc1 L_parallel_sum__linear_kernel_hedgehog__glu_gated_glu__prompt_kernel_10_fp2l
    s_branch L_parallel_sum__linear_kernel_hedgehog__glu_gated_glu__prompt_kernel_10_fb2
L_parallel_sum__linear_kernel_hedgehog__glu_gated_glu__prompt_kernel_10_fp3:
    s_mov_b32 s41, 0
L_parallel_sum__linear_kernel_hedgehog__glu_gated_glu__prompt_kernel_10_fp3l:
    s_sleep 2
    buffer_load_dword v26, v31, s[24:27], s31 offen sc1
    s_waitcnt vmcnt(0)
    v_cmp_gt_u32 vcc, 3, v26
    s_and_b32 s57, vcc_lo, 15
    s_cbranch_scc0 L_parallel_sum__linear_kernel_hedgehog__glu_gated_glu__prompt_kernel_10_fb3
    s_add_u32 s41, s41, 1
    s_cmp_lt_u32 s41, 20000
    s_cbranch_scc1 L_parallel_sum__linear_kernel_hedgehog__glu_gated_glu__prompt_kernel_10_fp3l
    s_branch L_parallel_sum__linear_kernel_hedgehog__glu_gated_glu__prompt_kernel_10_fb3
L_parallel_sum__linear_kernel_hedgehog__glu_gated_glu__prompt_kernel_10_zp:
    s_mov_b32 s41, 0
L_parallel_sum__linear_kernel_hedgehog__glu_gated_glu__prompt_kernel_10_zpl:
    s_sleep 8
    buffer_load_dwordx4 v[76:79], v0, s[24:27], s54 offen sc1
    s_waitcnt vmcnt(0)
    v_cmp_eq_u32 vcc, -1, v76
    s_nop 1
    s_cbranch_vccz L_parallel_sum__linear_kernel_hedgehog__glu_gated_glu__prompt_kernel_10_zb
    s_add_u32 s41, s41, 1
    s_cmp_lt_u32 s41, 20000
    s_cbranch_scc1 L_parallel_sum__linear_kernel_hedgehog__glu_gated_glu__prompt_kernel_10_zpl
    s_branch L_parallel_sum__linear_kernel_hedgehog__glu_gated_glu__prompt_kernel_10_zb
L_parallel_sum__linear_kernel_hedgehog__glu_gated_glu__prompt_kernel_10_rt:
    s_add_u32 s56, s56, 1
    s_cmp_ge_u32 s56, 20000
    s_cbranch_scc1 L_parallel_sum__linear_kernel_hedgehog__glu_gated_glu__prompt_kernel_10_go
    s_waitcnt lgkmcnt(0)
    buffer_load_dwordx4 v[76:79], v0, s[24:27], s54 offen sc1
    buffer_load_dwordx4 v[80:83], v0, s[24:27], s53 offen offset:0 sc1
    buffer_load_dwordx4 v[84:87], v0, s[24:27], s53 offen offset:1024 sc1
    buffer_load_dwordx4 v[88:91], v0, s[24:27], s53 offen offset:2048 sc1
    buffer_load_dwordx4 v[92:95], v0, s[24:27], s53 offen offset:3072 sc1
    s_add_u32 s58, s53, 4096
    buffer_load_dwordx4 v[96:99], v0, s[24:27], s58 offen offset:0 sc1
    buffer_load_dwordx4 v[100:103], v0, s[24:27], s58 offen offset:1024 sc1
    buffer_load_dwordx4 v[104:107], v0, s[24:27], s58 offen offset:2048 sc1
    buffer_load_dwordx4 v[108:111], v0, s[24:27], s58 offen offset:3072 sc1
    s_waitcnt vmcnt(0)
    s_branch L_parallel_sum__linear_kernel_hedgehog__glu_gated_glu__prompt_kernel_10_pre
L_parallel_sum__linear_kernel_hedgehog__glu_gated_glu__prompt_kernel_11_ss1:
    s_nop 4
    buffer_store_dwordx4 v[80:83], v0, s[24:27], s52 offen offset:0 sc1
    s_nop 4
    s_branch L_parallel_sum__linear_kernel_hedgehog__glu_gated_glu__prompt_kernel_11_sb1
L_parallel_sum__linear_kernel_hedgehog__glu_gated_glu__prompt_kernel_11_ss2:
    s_nop 4
    buffer_store_dwordx4 v[96:99], v0, s[24:27], s52 offen offset:1024 sc1
    s_nop 4
    s_branch L_parallel_sum__linear_kernel_hedgehog__glu_gated_glu__prompt_kernel_11_sb2
L_parallel_sum__linear_kernel_hedgehog__glu_gated_glu__prompt_kernel_11_ss3:
    s_nop 4
    buffer_store_dwordx4 v[112:115], v0, s[24:27], s52 offen offset:2048 sc1
    s_nop 4
    s_branch L_parallel_sum__linear_kernel_hedgehog__glu_gated_glu__prompt_kernel_11_sb3
L_parallel_sum__linear_kernel_hedgehog__glu_gated_glu__prompt_kernel_11_ss4:
    s_nop 4
    buffer_store_dword v27, off, s[24:27], s33 sc1
    s_nop 4
    s_branch L_parallel_sum__linear_kernel_hedgehog__glu_gated_glu__prompt_kernel_11_sb4
L_parallel_sum__linear_kernel_hedgehog__glu_gated_glu__prompt_kernel_11_ss5:
    s_nop 4
    buffer_store_dwordx4 v[208:211], v0, s[24:27], s35 offen offset:0 sc1
    s_nop 4
    s_branch L_parallel_sum__linear_kernel_hedgehog__glu_gated_glu__prompt_kernel_11_sb5
L_parallel_sum__linear_kernel_hedgehog__glu_gated_glu__prompt_kernel_11_ss6:
    s_nop 4
    buffer_store_dwordx4 v[224:227], v0, s[24:27], s35 offen offset:1024 sc1
    s_nop 4
    s_branch L_parallel_sum__linear_kernel_hedgehog__glu_gated_glu__prompt_kernel_11_sb6
L_parallel_sum__linear_kernel_hedgehog__glu_gated_glu__prompt_kernel_11_ss7:
    s_nop 4
    buffer_store_dword v27, off, s[24:27], s33 sc1
    s_nop 4
    s_branch L_parallel_sum__linear_kernel_hedgehog__glu_gated_glu__prompt_kernel_11_sb7
L_parallel_sum__linear_kernel_hedgehog__glu_gated_glu__prompt_kernel_11_cp:
    s_mov_b32 s41, 0
L_parallel_sum__linear_kernel_hedgehog__glu_gated_glu__prompt_kernel_11_cpl:
    s_sleep 16
    buffer_load_dword v27, v26, s[4:7], 0 offen sc1
    s_and_b32 s101, s2, 7
    s_waitcnt vmcnt(0)
    v_readlane_b32 s101, v27, s101
    v_and_b32 v27, 0xff, v27
    v_cmp_gt_u32 vcc, 32, v27
    s_lshl_b32 s57, s100, 5
    s_sub_u32 s101, s101, s57
    s_cbranch_vccz L_parallel_sum__linear_kernel_hedgehog__glu_gated_glu__prompt_kernel_11_cb
    s_add_u32 s41, s41, 1
    s_cmp_lt_u32 s41, 20000
    s_cbranch_scc1 L_parallel_sum__linear_kernel_hedgehog__glu_gated_glu__prompt_kernel_11_cpl
    s_branch L_parallel_sum__linear_kernel_hedgehog__glu_gated_glu__prompt_kernel_11_cb
L_parallel_sum__linear_kernel_hedgehog__glu_gated_glu__prompt_kernel_11_fp1:
    v_mov_b32 v27, 4
    s_waitcnt vmcnt(0)
    s_mov_b64 exec, 1
    s_cmp_lg_u32 s101, 0
    s_cbranch_scc1 L_parallel_sum__linear_kernel_hedgehog__glu_gated_glu__prompt_kernel_11_fo0
    buffer_store_dword v27, off, s[24:27], s33
    s_branch L_parallel_sum__linear_kernel_hedgehog__glu_gated_glu__prompt_kernel_11_fq0
L_parallel_sum__linear_kernel_hedgehog__glu_gated_glu__prompt_kernel_11_fo0:
    buffer_store_dword v27, off, s[24:27], s33 sc1
L_parallel_sum__linear_kernel_hedgehog__glu_gated_glu__prompt_kernel_11_fq0:
    s_mov_b64 exec, -1
    s_mov_b32 s41, 0
L_parallel_sum__linear_kernel_hedgehog__glu_gated_glu__prompt_kernel_11_fp1l:
    s_sleep 2
    buffer_load_dword v26, v31, s[24:27], s31 offen sc1
    s_waitcnt vmcnt(0)
    v_cmp_gt_u32 vcc, 3, v26
    s_and_b32 s57, vcc_lo, 240
    s_cbranch_scc0 L_parallel_sum__linear_kernel_hedgehog__glu_gated_glu__prompt_kernel_11_fb1
    s_add_u32 s41, s41, 1
    s_cmp_lt_u32 s41, 20000
    s_cbranch_scc1 L_parallel_sum__linear_kernel_hedgehog__glu_gated_glu__prompt_kernel_11_fp1l
    s_branch L_parallel_sum__linear_kernel_hedgehog__glu_gated_glu__prompt_kernel_11_fb1
L_parallel_sum__linear_kernel_hedgehog__glu_gated_glu__prompt_kernel_11_fp2:
    s_mov_b32 s41, 0
L_parallel_sum__linear_kernel_hedgehog__glu_gated_glu__prompt_kernel_11_fp2l:
    s_sleep 2
    buffer_load_dword v26, v31, s[24:27], s31 offen sc1
    s_waitcnt vmcnt(0)
    v_cmp_gt_u32 vcc, 4, v26
    s_and_b32 s57, vcc_lo, 240
    s_cbranch_scc0 L_parallel_sum__linear_kernel_hedgehog__glu_gated_glu__prompt_kernel_11_fb2
    s_add_u32 s41, s41, 1
    s_cmp_lt_u32 s41, 20000
    s_cbranch_scc1 L_parallel_sum__linear_kernel_hedgehog__glu_gated_glu__prompt_kernel_11_fp2l
    s_branch L_parallel_sum__linear_kernel_hedgehog__glu_gated_glu__prompt_kernel_11_fb2
L_parallel_sum__linear_kernel_hedgehog__glu_gated_glu__prompt_kernel_11_fp3:
    s_mov_b32 s41, 0
L_parallel_sum__linear_kernel_hedgehog__glu_gated_glu__prompt_kernel_11_fp3l:
    s_sleep 2
    buffer_load_dword v26, v31, s[24:27], s31 offen sc1
    s_waitcnt vmcnt(0)
    v_cmp_gt_u32 vcc, 3, v26
    s_and_b32 s57, vcc_lo, 15
    s_cbranch_scc0 L_parallel_sum__linear_kernel_hedgehog__glu_gated_glu__prompt_kernel_11_fb3
    s_add_u32 s41, s41, 1
    s_cmp_lt_u32 s41, 20000
    s_cbranch_scc1 L_parallel_sum__linear_kernel_hedgehog__glu_gated_glu__prompt_kernel_11_fp3l
    s_branch L_parallel_sum__linear_kernel_hedgehog__glu_gated_glu__prompt_kernel_11_fb3
L_parallel_sum__linear_kernel_hedgehog__glu_gated_glu__prompt_kernel_11_zp:
    s_mov_b32 s41, 0
L_parallel_sum__linear_kernel_hedgehog__glu_gated_glu__prompt_kernel_11_zpl:
    s_sleep 8
    buffer_load_dwordx4 v[76:79], v0, s[24:27], s54 offen sc1
    s_waitcnt vmcnt(0)
    v_cmp_eq_u32 vcc, -1, v76
    s_nop 1
    s_cbranch_vccz L_parallel_sum__linear_kernel_hedgehog__glu_gated_glu__prompt_kernel_11_zb
    s_add_u32 s41, s41, 1
    s_cmp_lt_u32 s41, 20000
    s_cbranch_scc1 L_parallel_sum__linear_kernel_hedgehog__glu_gated_glu__prompt_kernel_11_zpl
    s_branch L_parallel_sum__linear_kernel_hedgehog__glu_gated_glu__prompt_kernel_11_zb
L_parallel_sum__linear_kernel_hedgehog__glu_gated_glu__prompt_kernel_11_rt:
    s_add_u32 s56, s56, 1
    s_cmp_ge_u32 s56, 20000
    s_cbranch_scc1 L_parallel_sum__linear_kernel_hedgehog__glu_gated_glu__prompt_kernel_11_go
    s_waitcnt lgkmcnt(0)
    buffer_load_dwordx4 v[76:79], v0, s[24:27], s54 offen sc1
    buffer_load_dwordx4 v[80:83], v0, s[24:27], s53 offen offset:0 sc1
    buffer_load_dwordx4 v[84:87], v0, s[24:27], s53 offen offset:1024 sc1
    buffer_load_dwordx4 v[88:91], v0, s[24:27], s53 offen offset:2048 sc1
    buffer_load_dwordx4 v[92:95], v0, s[24:27], s53 offen offset:3072 sc1
    s_add_u32 s58, s53, 4096
    buffer_load_dwordx4 v[96:99], v0, s[24:27], s58 offen offset:0 sc1
    buffer_load_dwordx4 v[100:103], v0, s[24:27], s58 offen offset:1024 sc1
    buffer_load_dwordx4 v[104:107], v0, s[24:27], s58 offen offset:2048 sc1
    buffer_load_dwordx4 v[108:111], v0, s[24:27], s58 offen offset:3072 sc1
    s_waitcnt vmcnt(0)
    s_branch L_parallel_sum__linear_kernel_hedgehog__glu_gated_glu__prompt_kernel_11_pre
L_parallel_sum__linear_kernel_hedgehog__glu_gated_glu__prompt_kernel_end:
    s_endpgm
.section .rodata,"a"
.p2align 6
.amdhsa_kernel parallel_sum__linear_kernel_hedgehog__glu_gated_glu__prompt_kernel
  .amdhsa_next_free_vgpr 256
  .amdhsa_next_free_sgpr 102
  .amdhsa_accum_offset 256
  .amdhsa_group_segment_fixed_size 0
  .amdhsa_kernarg_size 88
  .amdhsa_user_sgpr_count 2
  .amdhsa_user_sgpr_kernarg_segment_ptr 1
  .amdhsa_system_sgpr_workgroup_id_x 1
.end_amdhsa_kernel
```
